```python
import torch

def _softmax(x, axis=-1):
    return torch.softmax(x, dim=axis)
def _gelu(x):
    return torch.nn.functional.gelu(x, approximate="tanh")
def _silu(x):
    return torch.nn.functional.silu(x)
def _sigmoid(x):
    return torch.sigmoid(x)
def _layernorm(x, axis=-1, eps=1e-5):
    m = x.mean(dim=axis, keepdim=True)
    v = x.var(dim=axis, keepdim=True, unbiased=False)
    return (x - m) / torch.sqrt(v + eps)
def _scatter_add(tgt, idx, src, axis=0):
    return tgt.clone().index_add_(axis, idx, src)
def _segment_sum(src, seg, n):
    out = torch.zeros((n,) + src.shape[1:], dtype=src.dtype)
    return out.index_add_(0, seg, src)
def _pad(x, pw):
    flat = tuple(v for pair in reversed(pw) for v in pair)
    return torch.nn.functional.pad(x, flat)

kernel_name = 'recurrent_scan__spectral_fnet__swiglu_ffn__prompt'

def setup_inputs():

    _w = (lambda a: (lambda t: t.to(torch.bfloat16) if t.is_floating_point() else t)(torch.as_tensor(a)))
    def _A_setup():
        B, S, D = 1, 2048, 1024
        ns = torch.arange(S)[:, None] * torch.arange(S)[None, :]
        nd = torch.arange(D)[:, None] * torch.arange(D)[None, :]
        Ws_re = torch.cos(-2.0 * torch.pi * ns / S).to(float)
        Ws_im = torch.sin(-2.0 * torch.pi * ns / S).to(float)
        Wd_re = torch.cos(-2.0 * torch.pi * nd / D).to(float)
        Wd_im = torch.sin(-2.0 * torch.pi * nd / D).to(float)
        return {
            "x": _w((lambda *s: torch.randn(*s, dtype=torch.bfloat16) * 0.05)(B, S, D)),
            "dft_seq_re": _w(Ws_re),
            "dft_seq_im": _w(Ws_im),
            "dft_hid_re": _w(Wd_re),
            "dft_hid_im": _w(Wd_im),
        }
    _A_in = _A_setup()

    def _B_setup():
        B, S, D, F = 1, 2048, 1024, 3584
        return {
            "x": _w((lambda *s: torch.randn(*s, dtype=torch.bfloat16) * 0.05)(B, S, D)),
            "w_gate": _w((lambda *s: torch.randn(*s, dtype=torch.bfloat16) * 0.05)(D, F)),
            "w_up": _w((lambda *s: torch.randn(*s, dtype=torch.bfloat16) * 0.05)(D, F)),
            "w_down": _w((lambda *s: torch.randn(*s, dtype=torch.bfloat16) * 0.05)(F, D)),
        }
    _B_in = _B_setup()

    return {
        "A_x": _A_in["x"],
        "A_dft_seq_re": _A_in["dft_seq_re"],
        "A_dft_seq_im": _A_in["dft_seq_im"],
        "A_dft_hid_re": _A_in["dft_hid_re"],
        "A_dft_hid_im": _A_in["dft_hid_im"],
        "B_x": _B_in["x"],
        "B_w_gate": _B_in["w_gate"],
        "B_w_up": _B_in["w_up"],
        "B_w_down": _B_in["w_down"],
    }

def reference(A_x, A_dft_seq_re, A_dft_seq_im, A_dft_hid_re, A_dft_hid_im, B_x, B_w_gate, B_w_up, B_w_down):
    def _A_ref(x, dft_seq_re, dft_seq_im, dft_hid_re, dft_hid_im):
        a = torch.einsum("bsd,ed->bse", x, dft_hid_re)
        b = torch.einsum("bsd,ed->bse", x, dft_hid_im)
        y = torch.einsum("ts,bse->bte", dft_seq_re, a) - torch.einsum("ts,bse->bte", dft_seq_im, b)
        return y

    def _B_ref(x, w_gate, w_up, w_down):
        g = _silu(x @ w_gate)
        u = x @ w_up
        return (g * u) @ w_down

    x = A_x
    xn = _layernorm(x, axis=-1)
    s = _A_ref(xn, A_dft_seq_re, A_dft_seq_im, A_dft_hid_re, A_dft_hid_im)
    g = _silu(_B_ref(xn, B_w_gate, B_w_up, B_w_down))
    return x + s * g
```

```asm
; @launch grid=(256,1,1) block=(512,1,1) lds=163840
.amdgcn_target "amdgcn-amd-amdhsa--gfx950"
.text
.globl recurrent_scan__spectral_fnet__swiglu_ffn__prompt_kernel
.p2align 8
.type recurrent_scan__spectral_fnet__swiglu_ffn__prompt_kernel,@function
recurrent_scan__spectral_fnet__swiglu_ffn__prompt_kernel:
    s_cmp_ge_u32 s2, 256
    s_cbranch_scc1 L_g1_end2
    s_lshr_b32 s3, s2, 3
    s_and_b32 s24, s2, 7
    s_cmp_ge_u32 s3, 28
    s_cbranch_scc1 L_g1_fft
    s_load_dwordx2 s[4:5], s[0:1], 88
    s_load_dwordx4 s[36:39], s[0:1], 48
    s_load_dwordx2 s[6:7], s[0:1], 0
    s_load_dwordx2 s[40:41], s[0:1], 80
    s_load_dwordx2 s[42:43], s[0:1], 64
    s_and_b32 s25, s24, 1
    s_lshl_b32 s25, s25, 2
    s_and_b32 s26, s3, 3
    s_add_u32 s25, s25, s26
    s_lshr_b32 s26, s24, 1
    s_mul_i32 s26, s26, 7
    s_lshr_b32 s27, s3, 2
    s_add_u32 s26, s26, s27
    v_lshrrev_b32 v1, 6, v0
    v_and_b32 v2, 63, v0
    v_readfirstlane_b32 s28, v1
    v_lshrrev_b32 v4, 3, v2
    v_lshl_add_u32 v4, v1, 5, v4
    v_lshlrev_b32 v4, 11, v4
    v_and_b32 v5, 7, v2
    v_lshrrev_b32 v6, 4, v2
    v_xor_b32 v5, v5, v6
    v_xor_b32 v7, 0, v5
    v_lshl_add_u32 v7, v7, 4, v4
    v_add_u32 v20, 0, v7
    v_xor_b32 v7, 4, v5
    v_lshl_add_u32 v7, v7, 4, v4
    v_add_u32 v21, 15360, v7
    v_xor_b32 v7, 0, v5
    v_lshl_add_u32 v7, v7, 4, v4
    v_add_u32 v22, 30720, v7
    v_xor_b32 v7, 4, v5
    v_lshl_add_u32 v7, v7, 4, v4
    v_add_u32 v23, 46080, v7
    v_lshrrev_b32 v4, 4, v2
    v_and_b32 v5, 15, v2
    v_lshlrev_b32 v6, 1, v4
    v_xor_b32 v5, v5, v6
    v_and_b32 v6, 3, v1
    v_lshl_add_u32 v6, v6, 4, v4
    s_movk_i32 s29, 7168
    v_mul_lo_u32 v6, v6, s29
    s_lshl_b32 s29, s26, 8
    v_add_u32 v6, s29, v6
    v_xor_b32 v7, 0, v5
    v_lshl_add_u32 v7, v7, 4, v6
    v_add_u32 v24, 0, v7
    v_xor_b32 v7, 0, v5
    v_lshl_add_u32 v7, v7, 4, v6
    v_add_u32 v25, 27648, v7
    v_xor_b32 v7, 8, v5
    v_lshl_add_u32 v7, v7, 4, v6
    v_add_u32 v26, 55296, v7
    v_xor_b32 v7, 8, v5
    v_lshl_add_u32 v7, v7, 4, v6
    v_add_u32 v27, 82944, v7
    s_lshl_b32 s30, s25, 19
    s_mov_b32 s31, 0
    s_lshl_b32 s32, s28, 12
    s_add_u32 s35, s32, 0x10000
    s_waitcnt lgkmcnt(0)
    s_mov_b32 s8, s6
    s_mov_b32 s9, s7
    s_mov_b32 s10, 0x400000
    s_mov_b32 s11, 0x00020000
    s_cmp_lt_u32 s28, 4
    s_cselect_b32 s12, s36, s38
    s_cselect_b32 s13, s37, s39
    s_mov_b32 s14, 7340032
    s_mov_b32 s15, 0x00020000
    s_mov_b32 m0, s35
    s_add_u32 s35, s35, 0x8000
    buffer_load_dwordx4 v24, s[12:15], s31 offen lds
    buffer_load_dwordx4 v25, s[12:15], s31 offen offset:1024 lds
    buffer_load_dwordx4 v26, s[12:15], s31 offen offset:2048 lds
    buffer_load_dwordx4 v27, s[12:15], s31 offen offset:3072 lds
    s_add_u32 s31, s31, 458752
    s_cmp_ge_u32 s35, 0x28000
    s_cselect_b32 s29, 0x18000, 0
    s_sub_u32 s35, s35, s29
    s_add_u32 m0, s32, 0
    s_nop 0
    buffer_load_dwordx4 v20, s[8:11], s30 offen lds
    buffer_load_dwordx4 v21, s[8:11], s30 offen offset:1024 lds
    buffer_load_dwordx4 v22, s[8:11], s30 offen offset:2048 lds
    buffer_load_dwordx4 v23, s[8:11], s30 offen offset:3072 lds
    s_add_u32 s30, s30, 128
    s_add_u32 s20, s4, 0x400000
    s_addc_u32 s21, s5, 0
    s_mov_b32 s22, 0xe00000
    s_mov_b32 s23, 0x00020000
    s_add_u32 s56, s4, 0x1f00000
    s_addc_u32 s57, s5, 0
    s_mov_b32 s58, 0x4000
    s_mov_b32 s59, 0x00020000
    s_mov_b32 s60, s40
    s_mov_b32 s61, s41
    s_mov_b32 s62, 0x100
    s_mov_b32 s63, 0x00020000
    s_mov_b32 s84, s42
    s_mov_b32 s85, s43
    s_mov_b32 s86, 0x700000
    s_mov_b32 s87, 0x00020000
    v_and_b32 v4, 15, v2
    v_lshrrev_b32 v5, 2, v1
    v_lshl_add_u32 v5, v5, 7, v4
    v_lshlrev_b32 v5, 7, v5
    v_bfe_u32 v4, v4, 1, 3
    v_lshrrev_b32 v6, 4, v2
    v_xor_b32 v4, v4, v6
    v_lshl_add_u32 v28, v4, 4, v5
    v_lshrrev_b32 v4, 4, v2
    v_bfe_u32 v5, v2, 2, 2
    v_and_b32 v6, 3, v2
    v_lshl_add_u32 v7, v4, 3, v5
    v_lshlrev_b32 v7, 8, v7
    v_lshl_add_u32 v7, v6, 3, v7
    v_add_u32 v7, 0x10000, v7
    v_and_b32 v4, 1, v4
    v_lshl_add_u32 v5, v4, 2, v5
    v_and_b32 v6, 3, v1
    v_lshlrev_b32 v6, 1, v6
    v_add_u32 v8, 0, v6
    v_xor_b32 v8, v8, v5
    v_lshl_add_u32 v29, v8, 5, v7
    v_add_u32 v8, 1, v6
    v_xor_b32 v8, v8, v5
    v_lshl_add_u32 v30, v8, 5, v7
    s_add_u32 m0, s32, 32768
    s_nop 0
    buffer_load_dwordx4 v20, s[8:11], s30 offen lds
    buffer_load_dwordx4 v21, s[8:11], s30 offen offset:1024 lds
    buffer_load_dwordx4 v22, s[8:11], s30 offen offset:2048 lds
    buffer_load_dwordx4 v23, s[8:11], s30 offen offset:3072 lds
    s_add_u32 s30, s30, 128
    s_mov_b32 m0, s35
    s_add_u32 s35, s35, 0x8000
    buffer_load_dwordx4 v24, s[12:15], s31 offen lds
    buffer_load_dwordx4 v25, s[12:15], s31 offen offset:1024 lds
    buffer_load_dwordx4 v26, s[12:15], s31 offen offset:2048 lds
    buffer_load_dwordx4 v27, s[12:15], s31 offen offset:3072 lds
    s_add_u32 s31, s31, 458752
    s_cmp_ge_u32 s35, 0x28000
    s_cselect_b32 s29, 0x18000, 0
    s_sub_u32 s35, s35, s29
    v_mov_b32 v96, 0
    v_mov_b32 v97, 0
    v_mov_b32 v98, 0
    v_mov_b32 v99, 0
    v_mov_b32 v100, 0
    v_mov_b32 v101, 0
    v_mov_b32 v102, 0
    v_mov_b32 v103, 0
    v_mov_b32 v104, 0
    v_mov_b32 v105, 0
    v_mov_b32 v106, 0
    v_mov_b32 v107, 0
    v_mov_b32 v108, 0
    v_mov_b32 v109, 0
    v_mov_b32 v110, 0
    v_mov_b32 v111, 0
    v_mov_b32 v112, 0
    v_mov_b32 v113, 0
    v_mov_b32 v114, 0
    v_mov_b32 v115, 0
    v_mov_b32 v116, 0
    v_mov_b32 v117, 0
    v_mov_b32 v118, 0
    v_mov_b32 v119, 0
    v_mov_b32 v120, 0
    v_mov_b32 v121, 0
    v_mov_b32 v122, 0
    v_mov_b32 v123, 0
    v_mov_b32 v124, 0
    v_mov_b32 v125, 0
    v_mov_b32 v126, 0
    v_mov_b32 v127, 0
    v_mov_b32 v128, 0
    v_mov_b32 v129, 0
    v_mov_b32 v130, 0
    v_mov_b32 v131, 0
    v_mov_b32 v132, 0
    v_mov_b32 v133, 0
    v_mov_b32 v134, 0
    v_mov_b32 v135, 0
    v_mov_b32 v136, 0
    v_mov_b32 v137, 0
    v_mov_b32 v138, 0
    v_mov_b32 v139, 0
    v_mov_b32 v140, 0
    v_mov_b32 v141, 0
    v_mov_b32 v142, 0
    v_mov_b32 v143, 0
    v_mov_b32 v144, 0
    v_mov_b32 v145, 0
    v_mov_b32 v146, 0
    v_mov_b32 v147, 0
    v_mov_b32 v148, 0
    v_mov_b32 v149, 0
    v_mov_b32 v150, 0
    v_mov_b32 v151, 0
    v_mov_b32 v152, 0
    v_mov_b32 v153, 0
    v_mov_b32 v154, 0
    v_mov_b32 v155, 0
    v_mov_b32 v156, 0
    v_mov_b32 v157, 0
    v_mov_b32 v158, 0
    v_mov_b32 v159, 0
    v_mov_b32 v160, 0
    v_mov_b32 v161, 0
    v_mov_b32 v162, 0
    v_mov_b32 v163, 0
    v_mov_b32 v164, 0
    v_mov_b32 v165, 0
    v_mov_b32 v166, 0
    v_mov_b32 v167, 0
    v_mov_b32 v168, 0
    v_mov_b32 v169, 0
    v_mov_b32 v170, 0
    v_mov_b32 v171, 0
    v_mov_b32 v172, 0
    v_mov_b32 v173, 0
    v_mov_b32 v174, 0
    v_mov_b32 v175, 0
    v_mov_b32 v176, 0
    v_mov_b32 v177, 0
    v_mov_b32 v178, 0
    v_mov_b32 v179, 0
    v_mov_b32 v180, 0
    v_mov_b32 v181, 0
    v_mov_b32 v182, 0
    v_mov_b32 v183, 0
    v_mov_b32 v184, 0
    v_mov_b32 v185, 0
    v_mov_b32 v186, 0
    v_mov_b32 v187, 0
    v_mov_b32 v188, 0
    v_mov_b32 v189, 0
    v_mov_b32 v190, 0
    v_mov_b32 v191, 0
    v_mov_b32 v192, 0
    v_mov_b32 v193, 0
    v_mov_b32 v194, 0
    v_mov_b32 v195, 0
    v_mov_b32 v196, 0
    v_mov_b32 v197, 0
    v_mov_b32 v198, 0
    v_mov_b32 v199, 0
    v_mov_b32 v200, 0
    v_mov_b32 v201, 0
    v_mov_b32 v202, 0
    v_mov_b32 v203, 0
    v_mov_b32 v204, 0
    v_mov_b32 v205, 0
    v_mov_b32 v206, 0
    v_mov_b32 v207, 0
    v_mov_b32 v208, 0
    v_mov_b32 v209, 0
    v_mov_b32 v210, 0
    v_mov_b32 v211, 0
    v_mov_b32 v212, 0
    v_mov_b32 v213, 0
    v_mov_b32 v214, 0
    v_mov_b32 v215, 0
    v_mov_b32 v216, 0
    v_mov_b32 v217, 0
    v_mov_b32 v218, 0
    v_mov_b32 v219, 0
    v_mov_b32 v220, 0
    v_mov_b32 v221, 0
    v_mov_b32 v222, 0
    v_mov_b32 v223, 0
    v_mov_b32 v0, 0
    v_mov_b32 v1, 0
    v_mov_b32 v2, 0
    v_mov_b32 v3, 0
    v_mov_b32 v4, 0
    v_mov_b32 v5, 0
    v_mov_b32 v6, 0
    v_mov_b32 v7, 0
    v_mov_b32 v8, 0
    v_mov_b32 v9, 0
    v_mov_b32 v10, 0
    v_mov_b32 v11, 0
    v_mov_b32 v12, 0
    v_mov_b32 v13, 0
    v_mov_b32 v14, 0
    v_mov_b32 v15, 0
    v_mov_b32 v16, 0x3f803f80
    v_mov_b32 v17, 0x3f803f80
    v_mov_b32 v18, 0x3f803f80
    v_mov_b32 v19, 0x3f803f80
    s_lshr_b32 s27, s28, 2
    s_mov_b32 s33, 0
    s_mov_b32 s68, 0xffff0000
    s_mov_b32 s69, 0x8000
    s_waitcnt vmcnt(8)
    s_barrier
    ds_read_b64_tr_b16 v[32:33], v29 offset:0
    ds_read_b64_tr_b16 v[34:35], v29 offset:1024
    ds_read_b128 v[64:67], v28 offset:0
    ds_read_b128 v[68:71], v28 offset:2048
    ds_read_b128 v[72:75], v28 offset:4096
    ds_read_b128 v[76:79], v28 offset:6144
    ds_read_b128 v[80:83], v28 offset:8192
    ds_read_b128 v[84:87], v28 offset:10240
    ds_read_b128 v[88:91], v28 offset:12288
    ds_read_b128 v[92:95], v28 offset:14336
    ds_read_b64_tr_b16 v[36:37], v30 offset:0
    ds_read_b64_tr_b16 v[38:39], v30 offset:1024
    ds_read_b64_tr_b16 v[40:41], v29 offset:16384
    ds_read_b64_tr_b16 v[42:43], v29 offset:17408
    ds_read_b64_tr_b16 v[44:45], v30 offset:16384
    ds_read_b64_tr_b16 v[46:47], v30 offset:17408
    s_waitcnt lgkmcnt(0)
    s_cmp_lg_u32 s27, 0
    s_cbranch_scc1 L_ones_recurr_1
    v_mfma_f32_16x16x32_bf16 v[0:3], v[32:35], v[16:19], v[0:3]
    v_mfma_f32_16x16x32_bf16 v[4:7], v[36:39], v[16:19], v[4:7]
    v_mfma_f32_16x16x32_bf16 v[8:11], v[40:43], v[16:19], v[8:11]
    v_mfma_f32_16x16x32_bf16 v[12:15], v[44:47], v[16:19], v[12:15]
L_ones_recurr_1:
    v_mfma_f32_16x16x32_bf16 v[96:99], v[32:35], v[64:67], v[96:99]
    s_mov_b32 m0, s35
    s_add_u32 s35, s35, 0x8000
    buffer_load_dwordx4 v24, s[12:15], s31 offen lds
    v_xor_b32 v28, 64, v28
    v_mfma_f32_16x16x32_bf16 v[100:103], v[32:35], v[68:71], v[100:103]
    ds_read_b64_tr_b16 v[48:49], v29 offset:8192
    v_mfma_f32_16x16x32_bf16 v[104:107], v[32:35], v[72:75], v[104:107]
    ds_read_b64_tr_b16 v[50:51], v29 offset:9216
    v_mfma_f32_16x16x32_bf16 v[108:111], v[32:35], v[76:79], v[108:111]
    ds_read_b128 a[0:3], v28 offset:0
    v_mfma_f32_16x16x32_bf16 v[112:115], v[32:35], v[80:83], v[112:115]
    ds_read_b128 a[4:7], v28 offset:2048
    v_mfma_f32_16x16x32_bf16 v[116:119], v[32:35], v[84:87], v[116:119]
    ds_read_b128 a[8:11], v28 offset:4096
    v_mfma_f32_16x16x32_bf16 v[120:123], v[32:35], v[88:91], v[120:123]
    buffer_load_dwordx4 v25, s[12:15], s31 offen offset:1024 lds
    ds_read_b128 a[12:15], v28 offset:6144
    v_mfma_f32_16x16x32_bf16 v[124:127], v[32:35], v[92:95], v[124:127]
    ds_read_b128 a[16:19], v28 offset:8192
    v_mfma_f32_16x16x32_bf16 v[128:131], v[36:39], v[64:67], v[128:131]
    ds_read_b128 a[20:23], v28 offset:10240
    v_mfma_f32_16x16x32_bf16 v[132:135], v[36:39], v[68:71], v[132:135]
    ds_read_b128 a[24:27], v28 offset:12288
    v_mfma_f32_16x16x32_bf16 v[136:139], v[36:39], v[72:75], v[136:139]
    ds_read_b128 a[28:31], v28 offset:14336
    v_mfma_f32_16x16x32_bf16 v[140:143], v[36:39], v[76:79], v[140:143]
    ds_read_b64_tr_b16 v[52:53], v30 offset:8192
    v_mfma_f32_16x16x32_bf16 v[144:147], v[36:39], v[80:83], v[144:147]
    buffer_load_dwordx4 v26, s[12:15], s31 offen offset:2048 lds
    ds_read_b64_tr_b16 v[54:55], v30 offset:9216
    v_mfma_f32_16x16x32_bf16 v[148:151], v[36:39], v[84:87], v[148:151]
    ds_read_b64_tr_b16 v[56:57], v29 offset:24576
    v_mfma_f32_16x16x32_bf16 v[152:155], v[36:39], v[88:91], v[152:155]
    ds_read_b64_tr_b16 v[58:59], v29 offset:25600
    v_mfma_f32_16x16x32_bf16 v[156:159], v[36:39], v[92:95], v[156:159]
    ds_read_b64_tr_b16 v[60:61], v30 offset:24576
    v_mfma_f32_16x16x32_bf16 v[160:163], v[40:43], v[64:67], v[160:163]
    ds_read_b64_tr_b16 v[62:63], v30 offset:25600
    v_mfma_f32_16x16x32_bf16 v[164:167], v[40:43], v[68:71], v[164:167]
    v_mfma_f32_16x16x32_bf16 v[168:171], v[40:43], v[72:75], v[168:171]
    buffer_load_dwordx4 v27, s[12:15], s31 offen offset:3072 lds
    s_add_u32 s31, s31, 458752
    s_cmp_ge_u32 s35, 0x28000
    s_cselect_b32 s29, 0x18000, 0
    s_sub_u32 s35, s35, s29
    v_mfma_f32_16x16x32_bf16 v[172:175], v[40:43], v[76:79], v[172:175]
    v_mfma_f32_16x16x32_bf16 v[176:179], v[40:43], v[80:83], v[176:179]
    v_mfma_f32_16x16x32_bf16 v[180:183], v[40:43], v[84:87], v[180:183]
    v_mfma_f32_16x16x32_bf16 v[184:187], v[40:43], v[88:91], v[184:187]
    v_mfma_f32_16x16x32_bf16 v[188:191], v[40:43], v[92:95], v[188:191]
    v_mfma_f32_16x16x32_bf16 v[192:195], v[44:47], v[64:67], v[192:195]
    v_mfma_f32_16x16x32_bf16 v[196:199], v[44:47], v[68:71], v[196:199]
    v_mfma_f32_16x16x32_bf16 v[200:203], v[44:47], v[72:75], v[200:203]
    v_mfma_f32_16x16x32_bf16 v[204:207], v[44:47], v[76:79], v[204:207]
    v_mfma_f32_16x16x32_bf16 v[208:211], v[44:47], v[80:83], v[208:211]
    v_mfma_f32_16x16x32_bf16 v[212:215], v[44:47], v[84:87], v[212:215]
    v_mfma_f32_16x16x32_bf16 v[216:219], v[44:47], v[88:91], v[216:219]
    v_mfma_f32_16x16x32_bf16 v[220:223], v[44:47], v[92:95], v[220:223]
    s_waitcnt vmcnt(4) lgkmcnt(0)
    s_barrier
    s_cmp_lg_u32 s27, 1
    s_cbranch_scc1 L_ones_recurr_2
    v_mfma_f32_16x16x32_bf16 v[0:3], v[48:51], v[16:19], v[0:3]
    v_mfma_f32_16x16x32_bf16 v[4:7], v[52:55], v[16:19], v[4:7]
    v_mfma_f32_16x16x32_bf16 v[8:11], v[56:59], v[16:19], v[8:11]
    v_mfma_f32_16x16x32_bf16 v[12:15], v[60:63], v[16:19], v[12:15]
L_ones_recurr_2:
    v_mfma_f32_16x16x32_bf16 v[96:99], v[48:51], a[0:3], v[96:99]
    v_xor_b32 v28, 0x8040, v28
    s_add_u32 s33, s33, 0x8000
    s_cmp_eq_u32 s33, 0x18000
    s_cselect_b32 s29, s68, s69
    s_cselect_b32 s33, 0, s33
    v_add_u32 v29, s29, v29
    v_add_u32 v30, s29, v30
    v_mfma_f32_16x16x32_bf16 v[100:103], v[48:51], a[4:7], v[100:103]
    s_add_u32 m0, s32, 0
    s_nop 0
    buffer_load_dwordx4 v20, s[8:11], s30 offen lds
    v_mfma_f32_16x16x32_bf16 v[104:107], v[48:51], a[8:11], v[104:107]
    ds_read_b64_tr_b16 v[32:33], v29 offset:0
    v_mfma_f32_16x16x32_bf16 v[108:111], v[48:51], a[12:15], v[108:111]
    ds_read_b64_tr_b16 v[34:35], v29 offset:1024
    v_mfma_f32_16x16x32_bf16 v[112:115], v[48:51], a[16:19], v[112:115]
    ds_read_b128 v[64:67], v28 offset:0
    v_mfma_f32_16x16x32_bf16 v[116:119], v[48:51], a[20:23], v[116:119]
    buffer_load_dwordx4 v21, s[8:11], s30 offen offset:1024 lds
    ds_read_b128 v[68:71], v28 offset:2048
    v_mfma_f32_16x16x32_bf16 v[120:123], v[48:51], a[24:27], v[120:123]
    ds_read_b128 v[72:75], v28 offset:4096
    v_mfma_f32_16x16x32_bf16 v[124:127], v[48:51], a[28:31], v[124:127]
    ds_read_b128 v[76:79], v28 offset:6144
    v_mfma_f32_16x16x32_bf16 v[128:131], v[52:55], a[0:3], v[128:131]
    ds_read_b128 v[80:83], v28 offset:8192
    v_mfma_f32_16x16x32_bf16 v[132:135], v[52:55], a[4:7], v[132:135]
    buffer_load_dwordx4 v22, s[8:11], s30 offen offset:2048 lds
    ds_read_b128 v[84:87], v28 offset:10240
    v_mfma_f32_16x16x32_bf16 v[136:139], v[52:55], a[8:11], v[136:139]
    ds_read_b128 v[88:91], v28 offset:12288
    v_mfma_f32_16x16x32_bf16 v[140:143], v[52:55], a[12:15], v[140:143]
    ds_read_b128 v[92:95], v28 offset:14336
    v_mfma_f32_16x16x32_bf16 v[144:147], v[52:55], a[16:19], v[144:147]
    ds_read_b64_tr_b16 v[36:37], v30 offset:0
    v_mfma_f32_16x16x32_bf16 v[148:151], v[52:55], a[20:23], v[148:151]
    buffer_load_dwordx4 v23, s[8:11], s30 offen offset:3072 lds
    s_add_u32 s30, s30, 128
    ds_read_b64_tr_b16 v[38:39], v30 offset:1024
    v_mfma_f32_16x16x32_bf16 v[152:155], v[52:55], a[24:27], v[152:155]
    ds_read_b64_tr_b16 v[40:41], v29 offset:16384
    v_mfma_f32_16x16x32_bf16 v[156:159], v[52:55], a[28:31], v[156:159]
    ds_read_b64_tr_b16 v[42:43], v29 offset:17408
    v_mfma_f32_16x16x32_bf16 v[160:163], v[56:59], a[0:3], v[160:163]
    ds_read_b64_tr_b16 v[44:45], v30 offset:16384
    v_mfma_f32_16x16x32_bf16 v[164:167], v[56:59], a[4:7], v[164:167]
    s_mov_b32 m0, s35
    s_add_u32 s35, s35, 0x8000
    buffer_load_dwordx4 v24, s[12:15], s31 offen lds
    ds_read_b64_tr_b16 v[46:47], v30 offset:17408
    v_mfma_f32_16x16x32_bf16 v[168:171], v[56:59], a[8:11], v[168:171]
    v_mfma_f32_16x16x32_bf16 v[172:175], v[56:59], a[12:15], v[172:175]
    v_mfma_f32_16x16x32_bf16 v[176:179], v[56:59], a[16:19], v[176:179]
    v_mfma_f32_16x16x32_bf16 v[180:183], v[56:59], a[20:23], v[180:183]
    buffer_load_dwordx4 v25, s[12:15], s31 offen offset:1024 lds
    v_mfma_f32_16x16x32_bf16 v[184:187], v[56:59], a[24:27], v[184:187]
    v_mfma_f32_16x16x32_bf16 v[188:191], v[56:59], a[28:31], v[188:191]
    v_mfma_f32_16x16x32_bf16 v[192:195], v[60:63], a[0:3], v[192:195]
    v_mfma_f32_16x16x32_bf16 v[196:199], v[60:63], a[4:7], v[196:199]
    buffer_load_dwordx4 v26, s[12:15], s31 offen offset:2048 lds
    v_mfma_f32_16x16x32_bf16 v[200:203], v[60:63], a[8:11], v[200:203]
    v_mfma_f32_16x16x32_bf16 v[204:207], v[60:63], a[12:15], v[204:207]
    v_mfma_f32_16x16x32_bf16 v[208:211], v[60:63], a[16:19], v[208:211]
    v_mfma_f32_16x16x32_bf16 v[212:215], v[60:63], a[20:23], v[212:215]
    buffer_load_dwordx4 v27, s[12:15], s31 offen offset:3072 lds
    s_add_u32 s31, s31, 458752
    s_cmp_ge_u32 s35, 0x28000
    s_cselect_b32 s29, 0x18000, 0
    s_sub_u32 s35, s35, s29
    v_mfma_f32_16x16x32_bf16 v[216:219], v[60:63], a[24:27], v[216:219]
    v_mfma_f32_16x16x32_bf16 v[220:223], v[60:63], a[28:31], v[220:223]
    s_waitcnt lgkmcnt(0)
    s_cmp_lg_u32 s27, 0
    s_cbranch_scc1 L_ones_recurr_3
    v_mfma_f32_16x16x32_bf16 v[0:3], v[32:35], v[16:19], v[0:3]
    v_mfma_f32_16x16x32_bf16 v[4:7], v[36:39], v[16:19], v[4:7]
    v_mfma_f32_16x16x32_bf16 v[8:11], v[40:43], v[16:19], v[8:11]
    v_mfma_f32_16x16x32_bf16 v[12:15], v[44:47], v[16:19], v[12:15]
L_ones_recurr_3:
    v_mfma_f32_16x16x32_bf16 v[96:99], v[32:35], v[64:67], v[96:99]
    v_xor_b32 v28, 64, v28
    v_mfma_f32_16x16x32_bf16 v[100:103], v[32:35], v[68:71], v[100:103]
    ds_read_b64_tr_b16 v[48:49], v29 offset:8192
    v_mfma_f32_16x16x32_bf16 v[104:107], v[32:35], v[72:75], v[104:107]
    ds_read_b64_tr_b16 v[50:51], v29 offset:9216
    v_mfma_f32_16x16x32_bf16 v[108:111], v[32:35], v[76:79], v[108:111]
    ds_read_b128 a[0:3], v28 offset:0
    v_mfma_f32_16x16x32_bf16 v[112:115], v[32:35], v[80:83], v[112:115]
    ds_read_b128 a[4:7], v28 offset:2048
    v_mfma_f32_16x16x32_bf16 v[116:119], v[32:35], v[84:87], v[116:119]
    ds_read_b128 a[8:11], v28 offset:4096
    v_mfma_f32_16x16x32_bf16 v[120:123], v[32:35], v[88:91], v[120:123]
    ds_read_b128 a[12:15], v28 offset:6144
    v_mfma_f32_16x16x32_bf16 v[124:127], v[32:35], v[92:95], v[124:127]
    ds_read_b128 a[16:19], v28 offset:8192
    v_mfma_f32_16x16x32_bf16 v[128:131], v[36:39], v[64:67], v[128:131]
    ds_read_b128 a[20:23], v28 offset:10240
    v_mfma_f32_16x16x32_bf16 v[132:135], v[36:39], v[68:71], v[132:135]
    ds_read_b128 a[24:27], v28 offset:12288
    v_mfma_f32_16x16x32_bf16 v[136:139], v[36:39], v[72:75], v[136:139]
    ds_read_b128 a[28:31], v28 offset:14336
    v_mfma_f32_16x16x32_bf16 v[140:143], v[36:39], v[76:79], v[140:143]
    ds_read_b64_tr_b16 v[52:53], v30 offset:8192
    v_mfma_f32_16x16x32_bf16 v[144:147], v[36:39], v[80:83], v[144:147]
    ds_read_b64_tr_b16 v[54:55], v30 offset:9216
    v_mfma_f32_16x16x32_bf16 v[148:151], v[36:39], v[84:87], v[148:151]
    ds_read_b64_tr_b16 v[56:57], v29 offset:24576
    v_mfma_f32_16x16x32_bf16 v[152:155], v[36:39], v[88:91], v[152:155]
    ds_read_b64_tr_b16 v[58:59], v29 offset:25600
    v_mfma_f32_16x16x32_bf16 v[156:159], v[36:39], v[92:95], v[156:159]
    ds_read_b64_tr_b16 v[60:61], v30 offset:24576
    v_mfma_f32_16x16x32_bf16 v[160:163], v[40:43], v[64:67], v[160:163]
    ds_read_b64_tr_b16 v[62:63], v30 offset:25600
    v_mfma_f32_16x16x32_bf16 v[164:167], v[40:43], v[68:71], v[164:167]
    v_mfma_f32_16x16x32_bf16 v[168:171], v[40:43], v[72:75], v[168:171]
    v_mfma_f32_16x16x32_bf16 v[172:175], v[40:43], v[76:79], v[172:175]
    v_mfma_f32_16x16x32_bf16 v[176:179], v[40:43], v[80:83], v[176:179]
    v_mfma_f32_16x16x32_bf16 v[180:183], v[40:43], v[84:87], v[180:183]
    v_mfma_f32_16x16x32_bf16 v[184:187], v[40:43], v[88:91], v[184:187]
    v_mfma_f32_16x16x32_bf16 v[188:191], v[40:43], v[92:95], v[188:191]
    v_mfma_f32_16x16x32_bf16 v[192:195], v[44:47], v[64:67], v[192:195]
    v_mfma_f32_16x16x32_bf16 v[196:199], v[44:47], v[68:71], v[196:199]
    v_mfma_f32_16x16x32_bf16 v[200:203], v[44:47], v[72:75], v[200:203]
    v_mfma_f32_16x16x32_bf16 v[204:207], v[44:47], v[76:79], v[204:207]
    v_mfma_f32_16x16x32_bf16 v[208:211], v[44:47], v[80:83], v[208:211]
    v_mfma_f32_16x16x32_bf16 v[212:215], v[44:47], v[84:87], v[212:215]
    v_mfma_f32_16x16x32_bf16 v[216:219], v[44:47], v[88:91], v[216:219]
    v_mfma_f32_16x16x32_bf16 v[220:223], v[44:47], v[92:95], v[220:223]
    s_waitcnt vmcnt(4) lgkmcnt(0)
    s_barrier
    s_cmp_lg_u32 s27, 1
    s_cbranch_scc1 L_ones_recurr_4
    v_mfma_f32_16x16x32_bf16 v[0:3], v[48:51], v[16:19], v[0:3]
    v_mfma_f32_16x16x32_bf16 v[4:7], v[52:55], v[16:19], v[4:7]
    v_mfma_f32_16x16x32_bf16 v[8:11], v[56:59], v[16:19], v[8:11]
    v_mfma_f32_16x16x32_bf16 v[12:15], v[60:63], v[16:19], v[12:15]
L_ones_recurr_4:
    v_mfma_f32_16x16x32_bf16 v[96:99], v[48:51], a[0:3], v[96:99]
    v_xor_b32 v28, 0x8040, v28
    s_add_u32 s33, s33, 0x8000
    s_cmp_eq_u32 s33, 0x18000
    s_cselect_b32 s29, s68, s69
    s_cselect_b32 s33, 0, s33
    v_add_u32 v29, s29, v29
    v_add_u32 v30, s29, v30
    v_mfma_f32_16x16x32_bf16 v[100:103], v[48:51], a[4:7], v[100:103]
    s_add_u32 m0, s32, 32768
    s_nop 0
    buffer_load_dwordx4 v20, s[8:11], s30 offen lds
    v_mfma_f32_16x16x32_bf16 v[104:107], v[48:51], a[8:11], v[104:107]
    ds_read_b64_tr_b16 v[32:33], v29 offset:0
    v_mfma_f32_16x16x32_bf16 v[108:111], v[48:51], a[12:15], v[108:111]
    ds_read_b64_tr_b16 v[34:35], v29 offset:1024
    v_mfma_f32_16x16x32_bf16 v[112:115], v[48:51], a[16:19], v[112:115]
    ds_read_b128 v[64:67], v28 offset:0
    v_mfma_f32_16x16x32_bf16 v[116:119], v[48:51], a[20:23], v[116:119]
    buffer_load_dwordx4 v21, s[8:11], s30 offen offset:1024 lds
    ds_read_b128 v[68:71], v28 offset:2048
    v_mfma_f32_16x16x32_bf16 v[120:123], v[48:51], a[24:27], v[120:123]
    ds_read_b128 v[72:75], v28 offset:4096
    v_mfma_f32_16x16x32_bf16 v[124:127], v[48:51], a[28:31], v[124:127]
    ds_read_b128 v[76:79], v28 offset:6144
    v_mfma_f32_16x16x32_bf16 v[128:131], v[52:55], a[0:3], v[128:131]
    ds_read_b128 v[80:83], v28 offset:8192
    v_mfma_f32_16x16x32_bf16 v[132:135], v[52:55], a[4:7], v[132:135]
    buffer_load_dwordx4 v22, s[8:11], s30 offen offset:2048 lds
    ds_read_b128 v[84:87], v28 offset:10240
    v_mfma_f32_16x16x32_bf16 v[136:139], v[52:55], a[8:11], v[136:139]
    ds_read_b128 v[88:91], v28 offset:12288
    v_mfma_f32_16x16x32_bf16 v[140:143], v[52:55], a[12:15], v[140:143]
    ds_read_b128 v[92:95], v28 offset:14336
    v_mfma_f32_16x16x32_bf16 v[144:147], v[52:55], a[16:19], v[144:147]
    ds_read_b64_tr_b16 v[36:37], v30 offset:0
    v_mfma_f32_16x16x32_bf16 v[148:151], v[52:55], a[20:23], v[148:151]
    buffer_load_dwordx4 v23, s[8:11], s30 offen offset:3072 lds
    s_add_u32 s30, s30, 128
    ds_read_b64_tr_b16 v[38:39], v30 offset:1024
    v_mfma_f32_16x16x32_bf16 v[152:155], v[52:55], a[24:27], v[152:155]
    ds_read_b64_tr_b16 v[40:41], v29 offset:16384
    v_mfma_f32_16x16x32_bf16 v[156:159], v[52:55], a[28:31], v[156:159]
    ds_read_b64_tr_b16 v[42:43], v29 offset:17408
    v_mfma_f32_16x16x32_bf16 v[160:163], v[56:59], a[0:3], v[160:163]
    ds_read_b64_tr_b16 v[44:45], v30 offset:16384
    v_mfma_f32_16x16x32_bf16 v[164:167], v[56:59], a[4:7], v[164:167]
    s_mov_b32 m0, s35
    s_add_u32 s35, s35, 0x8000
    buffer_load_dwordx4 v24, s[12:15], s31 offen lds
    ds_read_b64_tr_b16 v[46:47], v30 offset:17408
    v_mfma_f32_16x16x32_bf16 v[168:171], v[56:59], a[8:11], v[168:171]
    v_mfma_f32_16x16x32_bf16 v[172:175], v[56:59], a[12:15], v[172:175]
    v_mfma_f32_16x16x32_bf16 v[176:179], v[56:59], a[16:19], v[176:179]
    v_mfma_f32_16x16x32_bf16 v[180:183], v[56:59], a[20:23], v[180:183]
    buffer_load_dwordx4 v25, s[12:15], s31 offen offset:1024 lds
    v_mfma_f32_16x16x32_bf16 v[184:187], v[56:59], a[24:27], v[184:187]
    v_mfma_f32_16x16x32_bf16 v[188:191], v[56:59], a[28:31], v[188:191]
    v_mfma_f32_16x16x32_bf16 v[192:195], v[60:63], a[0:3], v[192:195]
    v_mfma_f32_16x16x32_bf16 v[196:199], v[60:63], a[4:7], v[196:199]
    buffer_load_dwordx4 v26, s[12:15], s31 offen offset:2048 lds
    v_mfma_f32_16x16x32_bf16 v[200:203], v[60:63], a[8:11], v[200:203]
    v_mfma_f32_16x16x32_bf16 v[204:207], v[60:63], a[12:15], v[204:207]
    v_mfma_f32_16x16x32_bf16 v[208:211], v[60:63], a[16:19], v[208:211]
    v_mfma_f32_16x16x32_bf16 v[212:215], v[60:63], a[20:23], v[212:215]
    buffer_load_dwordx4 v27, s[12:15], s31 offen offset:3072 lds
    s_add_u32 s31, s31, 458752
    s_cmp_ge_u32 s35, 0x28000
    s_cselect_b32 s29, 0x18000, 0
    s_sub_u32 s35, s35, s29
    v_mfma_f32_16x16x32_bf16 v[216:219], v[60:63], a[24:27], v[216:219]
    v_mfma_f32_16x16x32_bf16 v[220:223], v[60:63], a[28:31], v[220:223]
    s_mov_b32 s34, 5
L_g1_loop:
    s_waitcnt lgkmcnt(0)
    s_cmp_lg_u32 s27, 0
    s_cbranch_scc1 L_ones_recurr_5
    v_mfma_f32_16x16x32_bf16 v[0:3], v[32:35], v[16:19], v[0:3]
    v_mfma_f32_16x16x32_bf16 v[4:7], v[36:39], v[16:19], v[4:7]
    v_mfma_f32_16x16x32_bf16 v[8:11], v[40:43], v[16:19], v[8:11]
    v_mfma_f32_16x16x32_bf16 v[12:15], v[44:47], v[16:19], v[12:15]
L_ones_recurr_5:
    v_mfma_f32_16x16x32_bf16 v[96:99], v[32:35], v[64:67], v[96:99]
    v_xor_b32 v28, 64, v28
    v_mfma_f32_16x16x32_bf16 v[100:103], v[32:35], v[68:71], v[100:103]
    ds_read_b64_tr_b16 v[48:49], v29 offset:8192
    v_mfma_f32_16x16x32_bf16 v[104:107], v[32:35], v[72:75], v[104:107]
    ds_read_b64_tr_b16 v[50:51], v29 offset:9216
    v_mfma_f32_16x16x32_bf16 v[108:111], v[32:35], v[76:79], v[108:111]
    ds_read_b128 a[0:3], v28 offset:0
    v_mfma_f32_16x16x32_bf16 v[112:115], v[32:35], v[80:83], v[112:115]
    ds_read_b128 a[4:7], v28 offset:2048
    v_mfma_f32_16x16x32_bf16 v[116:119], v[32:35], v[84:87], v[116:119]
    ds_read_b128 a[8:11], v28 offset:4096
    v_mfma_f32_16x16x32_bf16 v[120:123], v[32:35], v[88:91], v[120:123]
    ds_read_b128 a[12:15], v28 offset:6144
    v_mfma_f32_16x16x32_bf16 v[124:127], v[32:35], v[92:95], v[124:127]
    ds_read_b128 a[16:19], v28 offset:8192
    v_mfma_f32_16x16x32_bf16 v[128:131], v[36:39], v[64:67], v[128:131]
    ds_read_b128 a[20:23], v28 offset:10240
    v_mfma_f32_16x16x32_bf16 v[132:135], v[36:39], v[68:71], v[132:135]
    ds_read_b128 a[24:27], v28 offset:12288
    v_mfma_f32_16x16x32_bf16 v[136:139], v[36:39], v[72:75], v[136:139]
    ds_read_b128 a[28:31], v28 offset:14336
    v_mfma_f32_16x16x32_bf16 v[140:143], v[36:39], v[76:79], v[140:143]
    ds_read_b64_tr_b16 v[52:53], v30 offset:8192
    v_mfma_f32_16x16x32_bf16 v[144:147], v[36:39], v[80:83], v[144:147]
    ds_read_b64_tr_b16 v[54:55], v30 offset:9216
    v_mfma_f32_16x16x32_bf16 v[148:151], v[36:39], v[84:87], v[148:151]
    ds_read_b64_tr_b16 v[56:57], v29 offset:24576
    v_mfma_f32_16x16x32_bf16 v[152:155], v[36:39], v[88:91], v[152:155]
    ds_read_b64_tr_b16 v[58:59], v29 offset:25600
    v_mfma_f32_16x16x32_bf16 v[156:159], v[36:39], v[92:95], v[156:159]
    ds_read_b64_tr_b16 v[60:61], v30 offset:24576
    v_mfma_f32_16x16x32_bf16 v[160:163], v[40:43], v[64:67], v[160:163]
    ds_read_b64_tr_b16 v[62:63], v30 offset:25600
    v_mfma_f32_16x16x32_bf16 v[164:167], v[40:43], v[68:71], v[164:167]
    v_mfma_f32_16x16x32_bf16 v[168:171], v[40:43], v[72:75], v[168:171]
    v_mfma_f32_16x16x32_bf16 v[172:175], v[40:43], v[76:79], v[172:175]
    v_mfma_f32_16x16x32_bf16 v[176:179], v[40:43], v[80:83], v[176:179]
    v_mfma_f32_16x16x32_bf16 v[180:183], v[40:43], v[84:87], v[180:183]
    v_mfma_f32_16x16x32_bf16 v[184:187], v[40:43], v[88:91], v[184:187]
    v_mfma_f32_16x16x32_bf16 v[188:191], v[40:43], v[92:95], v[188:191]
    v_mfma_f32_16x16x32_bf16 v[192:195], v[44:47], v[64:67], v[192:195]
    v_mfma_f32_16x16x32_bf16 v[196:199], v[44:47], v[68:71], v[196:199]
    v_mfma_f32_16x16x32_bf16 v[200:203], v[44:47], v[72:75], v[200:203]
    v_mfma_f32_16x16x32_bf16 v[204:207], v[44:47], v[76:79], v[204:207]
    v_mfma_f32_16x16x32_bf16 v[208:211], v[44:47], v[80:83], v[208:211]
    v_mfma_f32_16x16x32_bf16 v[212:215], v[44:47], v[84:87], v[212:215]
    v_mfma_f32_16x16x32_bf16 v[216:219], v[44:47], v[88:91], v[216:219]
    v_mfma_f32_16x16x32_bf16 v[220:223], v[44:47], v[92:95], v[220:223]
    s_waitcnt vmcnt(4) lgkmcnt(0)
    s_barrier
    s_cmp_lg_u32 s27, 1
    s_cbranch_scc1 L_ones_recurr_6
    v_mfma_f32_16x16x32_bf16 v[0:3], v[48:51], v[16:19], v[0:3]
    v_mfma_f32_16x16x32_bf16 v[4:7], v[52:55], v[16:19], v[4:7]
    v_mfma_f32_16x16x32_bf16 v[8:11], v[56:59], v[16:19], v[8:11]
    v_mfma_f32_16x16x32_bf16 v[12:15], v[60:63], v[16:19], v[12:15]
L_ones_recurr_6:
    v_mfma_f32_16x16x32_bf16 v[96:99], v[48:51], a[0:3], v[96:99]
    v_xor_b32 v28, 0x8040, v28
    s_add_u32 s33, s33, 0x8000
    s_cmp_eq_u32 s33, 0x18000
    s_cselect_b32 s29, s68, s69
    s_cselect_b32 s33, 0, s33
    v_add_u32 v29, s29, v29
    v_add_u32 v30, s29, v30
    v_mfma_f32_16x16x32_bf16 v[100:103], v[48:51], a[4:7], v[100:103]
    s_add_u32 m0, s32, 0
    s_nop 0
    buffer_load_dwordx4 v20, s[8:11], s30 offen lds
    v_mfma_f32_16x16x32_bf16 v[104:107], v[48:51], a[8:11], v[104:107]
    ds_read_b64_tr_b16 v[32:33], v29 offset:0
    v_mfma_f32_16x16x32_bf16 v[108:111], v[48:51], a[12:15], v[108:111]
    ds_read_b64_tr_b16 v[34:35], v29 offset:1024
    v_mfma_f32_16x16x32_bf16 v[112:115], v[48:51], a[16:19], v[112:115]
    ds_read_b128 v[64:67], v28 offset:0
    v_mfma_f32_16x16x32_bf16 v[116:119], v[48:51], a[20:23], v[116:119]
    buffer_load_dwordx4 v21, s[8:11], s30 offen offset:1024 lds
    ds_read_b128 v[68:71], v28 offset:2048
    v_mfma_f32_16x16x32_bf16 v[120:123], v[48:51], a[24:27], v[120:123]
    ds_read_b128 v[72:75], v28 offset:4096
    v_mfma_f32_16x16x32_bf16 v[124:127], v[48:51], a[28:31], v[124:127]
    ds_read_b128 v[76:79], v28 offset:6144
    v_mfma_f32_16x16x32_bf16 v[128:131], v[52:55], a[0:3], v[128:131]
    ds_read_b128 v[80:83], v28 offset:8192
    v_mfma_f32_16x16x32_bf16 v[132:135], v[52:55], a[4:7], v[132:135]
    buffer_load_dwordx4 v22, s[8:11], s30 offen offset:2048 lds
    ds_read_b128 v[84:87], v28 offset:10240
    v_mfma_f32_16x16x32_bf16 v[136:139], v[52:55], a[8:11], v[136:139]
    ds_read_b128 v[88:91], v28 offset:12288
    v_mfma_f32_16x16x32_bf16 v[140:143], v[52:55], a[12:15], v[140:143]
    ds_read_b128 v[92:95], v28 offset:14336
    v_mfma_f32_16x16x32_bf16 v[144:147], v[52:55], a[16:19], v[144:147]
    ds_read_b64_tr_b16 v[36:37], v30 offset:0
    v_mfma_f32_16x16x32_bf16 v[148:151], v[52:55], a[20:23], v[148:151]
    buffer_load_dwordx4 v23, s[8:11], s30 offen offset:3072 lds
    s_add_u32 s30, s30, 128
    ds_read_b64_tr_b16 v[38:39], v30 offset:1024
    v_mfma_f32_16x16x32_bf16 v[152:155], v[52:55], a[24:27], v[152:155]
    ds_read_b64_tr_b16 v[40:41], v29 offset:16384
    v_mfma_f32_16x16x32_bf16 v[156:159], v[52:55], a[28:31], v[156:159]
    ds_read_b64_tr_b16 v[42:43], v29 offset:17408
    v_mfma_f32_16x16x32_bf16 v[160:163], v[56:59], a[0:3], v[160:163]
    ds_read_b64_tr_b16 v[44:45], v30 offset:16384
    v_mfma_f32_16x16x32_bf16 v[164:167], v[56:59], a[4:7], v[164:167]
    s_mov_b32 m0, s35
    s_add_u32 s35, s35, 0x8000
    buffer_load_dwordx4 v24, s[12:15], s31 offen lds
    ds_read_b64_tr_b16 v[46:47], v30 offset:17408
    v_mfma_f32_16x16x32_bf16 v[168:171], v[56:59], a[8:11], v[168:171]
    v_mfma_f32_16x16x32_bf16 v[172:175], v[56:59], a[12:15], v[172:175]
    v_mfma_f32_16x16x32_bf16 v[176:179], v[56:59], a[16:19], v[176:179]
    v_mfma_f32_16x16x32_bf16 v[180:183], v[56:59], a[20:23], v[180:183]
    buffer_load_dwordx4 v25, s[12:15], s31 offen offset:1024 lds
    v_mfma_f32_16x16x32_bf16 v[184:187], v[56:59], a[24:27], v[184:187]
    v_mfma_f32_16x16x32_bf16 v[188:191], v[56:59], a[28:31], v[188:191]
    v_mfma_f32_16x16x32_bf16 v[192:195], v[60:63], a[0:3], v[192:195]
    v_mfma_f32_16x16x32_bf16 v[196:199], v[60:63], a[4:7], v[196:199]
    buffer_load_dwordx4 v26, s[12:15], s31 offen offset:2048 lds
    v_mfma_f32_16x16x32_bf16 v[200:203], v[60:63], a[8:11], v[200:203]
    v_mfma_f32_16x16x32_bf16 v[204:207], v[60:63], a[12:15], v[204:207]
    v_mfma_f32_16x16x32_bf16 v[208:211], v[60:63], a[16:19], v[208:211]
    v_mfma_f32_16x16x32_bf16 v[212:215], v[60:63], a[20:23], v[212:215]
    buffer_load_dwordx4 v27, s[12:15], s31 offen offset:3072 lds
    s_add_u32 s31, s31, 458752
    s_cmp_ge_u32 s35, 0x28000
    s_cselect_b32 s29, 0x18000, 0
    s_sub_u32 s35, s35, s29
    v_mfma_f32_16x16x32_bf16 v[216:219], v[60:63], a[24:27], v[216:219]
    v_mfma_f32_16x16x32_bf16 v[220:223], v[60:63], a[28:31], v[220:223]
    s_waitcnt lgkmcnt(0)
    s_cmp_lg_u32 s27, 0
    s_cbranch_scc1 L_ones_recurr_7
    v_mfma_f32_16x16x32_bf16 v[0:3], v[32:35], v[16:19], v[0:3]
    v_mfma_f32_16x16x32_bf16 v[4:7], v[36:39], v[16:19], v[4:7]
    v_mfma_f32_16x16x32_bf16 v[8:11], v[40:43], v[16:19], v[8:11]
    v_mfma_f32_16x16x32_bf16 v[12:15], v[44:47], v[16:19], v[12:15]
L_ones_recurr_7:
    v_mfma_f32_16x16x32_bf16 v[96:99], v[32:35], v[64:67], v[96:99]
    v_xor_b32 v28, 64, v28
    v_mfma_f32_16x16x32_bf16 v[100:103], v[32:35], v[68:71], v[100:103]
    ds_read_b64_tr_b16 v[48:49], v29 offset:8192
    v_mfma_f32_16x16x32_bf16 v[104:107], v[32:35], v[72:75], v[104:107]
    ds_read_b64_tr_b16 v[50:51], v29 offset:9216
    v_mfma_f32_16x16x32_bf16 v[108:111], v[32:35], v[76:79], v[108:111]
    ds_read_b128 a[0:3], v28 offset:0
    v_mfma_f32_16x16x32_bf16 v[112:115], v[32:35], v[80:83], v[112:115]
    ds_read_b128 a[4:7], v28 offset:2048
    v_mfma_f32_16x16x32_bf16 v[116:119], v[32:35], v[84:87], v[116:119]
    ds_read_b128 a[8:11], v28 offset:4096
    v_mfma_f32_16x16x32_bf16 v[120:123], v[32:35], v[88:91], v[120:123]
    ds_read_b128 a[12:15], v28 offset:6144
    v_mfma_f32_16x16x32_bf16 v[124:127], v[32:35], v[92:95], v[124:127]
    ds_read_b128 a[16:19], v28 offset:8192
    v_mfma_f32_16x16x32_bf16 v[128:131], v[36:39], v[64:67], v[128:131]
    ds_read_b128 a[20:23], v28 offset:10240
    v_mfma_f32_16x16x32_bf16 v[132:135], v[36:39], v[68:71], v[132:135]
    ds_read_b128 a[24:27], v28 offset:12288
    v_mfma_f32_16x16x32_bf16 v[136:139], v[36:39], v[72:75], v[136:139]
    ds_read_b128 a[28:31], v28 offset:14336
    v_mfma_f32_16x16x32_bf16 v[140:143], v[36:39], v[76:79], v[140:143]
    ds_read_b64_tr_b16 v[52:53], v30 offset:8192
    v_mfma_f32_16x16x32_bf16 v[144:147], v[36:39], v[80:83], v[144:147]
    ds_read_b64_tr_b16 v[54:55], v30 offset:9216
    v_mfma_f32_16x16x32_bf16 v[148:151], v[36:39], v[84:87], v[148:151]
    ds_read_b64_tr_b16 v[56:57], v29 offset:24576
    v_mfma_f32_16x16x32_bf16 v[152:155], v[36:39], v[88:91], v[152:155]
    ds_read_b64_tr_b16 v[58:59], v29 offset:25600
    v_mfma_f32_16x16x32_bf16 v[156:159], v[36:39], v[92:95], v[156:159]
    ds_read_b64_tr_b16 v[60:61], v30 offset:24576
    v_mfma_f32_16x16x32_bf16 v[160:163], v[40:43], v[64:67], v[160:163]
    ds_read_b64_tr_b16 v[62:63], v30 offset:25600
    v_mfma_f32_16x16x32_bf16 v[164:167], v[40:43], v[68:71], v[164:167]
    v_mfma_f32_16x16x32_bf16 v[168:171], v[40:43], v[72:75], v[168:171]
    v_mfma_f32_16x16x32_bf16 v[172:175], v[40:43], v[76:79], v[172:175]
    v_mfma_f32_16x16x32_bf16 v[176:179], v[40:43], v[80:83], v[176:179]
    v_mfma_f32_16x16x32_bf16 v[180:183], v[40:43], v[84:87], v[180:183]
    v_mfma_f32_16x16x32_bf16 v[184:187], v[40:43], v[88:91], v[184:187]
    v_mfma_f32_16x16x32_bf16 v[188:191], v[40:43], v[92:95], v[188:191]
    v_mfma_f32_16x16x32_bf16 v[192:195], v[44:47], v[64:67], v[192:195]
    v_mfma_f32_16x16x32_bf16 v[196:199], v[44:47], v[68:71], v[196:199]
    v_mfma_f32_16x16x32_bf16 v[200:203], v[44:47], v[72:75], v[200:203]
    v_mfma_f32_16x16x32_bf16 v[204:207], v[44:47], v[76:79], v[204:207]
    v_mfma_f32_16x16x32_bf16 v[208:211], v[44:47], v[80:83], v[208:211]
    v_mfma_f32_16x16x32_bf16 v[212:215], v[44:47], v[84:87], v[212:215]
    v_mfma_f32_16x16x32_bf16 v[216:219], v[44:47], v[88:91], v[216:219]
    v_mfma_f32_16x16x32_bf16 v[220:223], v[44:47], v[92:95], v[220:223]
    s_waitcnt vmcnt(4) lgkmcnt(0)
    s_barrier
    s_cmp_lg_u32 s27, 1
    s_cbranch_scc1 L_ones_recurr_8
    v_mfma_f32_16x16x32_bf16 v[0:3], v[48:51], v[16:19], v[0:3]
    v_mfma_f32_16x16x32_bf16 v[4:7], v[52:55], v[16:19], v[4:7]
    v_mfma_f32_16x16x32_bf16 v[8:11], v[56:59], v[16:19], v[8:11]
    v_mfma_f32_16x16x32_bf16 v[12:15], v[60:63], v[16:19], v[12:15]
L_ones_recurr_8:
    v_mfma_f32_16x16x32_bf16 v[96:99], v[48:51], a[0:3], v[96:99]
    v_xor_b32 v28, 0x8040, v28
    s_add_u32 s33, s33, 0x8000
    s_cmp_eq_u32 s33, 0x18000
    s_cselect_b32 s29, s68, s69
    s_cselect_b32 s33, 0, s33
    v_add_u32 v29, s29, v29
    v_add_u32 v30, s29, v30
    v_mfma_f32_16x16x32_bf16 v[100:103], v[48:51], a[4:7], v[100:103]
    s_add_u32 m0, s32, 32768
    s_nop 0
    buffer_load_dwordx4 v20, s[8:11], s30 offen lds
    v_mfma_f32_16x16x32_bf16 v[104:107], v[48:51], a[8:11], v[104:107]
    ds_read_b64_tr_b16 v[32:33], v29 offset:0
    v_mfma_f32_16x16x32_bf16 v[108:111], v[48:51], a[12:15], v[108:111]
    ds_read_b64_tr_b16 v[34:35], v29 offset:1024
    v_mfma_f32_16x16x32_bf16 v[112:115], v[48:51], a[16:19], v[112:115]
    ds_read_b128 v[64:67], v28 offset:0
    v_mfma_f32_16x16x32_bf16 v[116:119], v[48:51], a[20:23], v[116:119]
    buffer_load_dwordx4 v21, s[8:11], s30 offen offset:1024 lds
    ds_read_b128 v[68:71], v28 offset:2048
    v_mfma_f32_16x16x32_bf16 v[120:123], v[48:51], a[24:27], v[120:123]
    ds_read_b128 v[72:75], v28 offset:4096
    v_mfma_f32_16x16x32_bf16 v[124:127], v[48:51], a[28:31], v[124:127]
    ds_read_b128 v[76:79], v28 offset:6144
    v_mfma_f32_16x16x32_bf16 v[128:131], v[52:55], a[0:3], v[128:131]
    ds_read_b128 v[80:83], v28 offset:8192
    v_mfma_f32_16x16x32_bf16 v[132:135], v[52:55], a[4:7], v[132:135]
    buffer_load_dwordx4 v22, s[8:11], s30 offen offset:2048 lds
    ds_read_b128 v[84:87], v28 offset:10240
    v_mfma_f32_16x16x32_bf16 v[136:139], v[52:55], a[8:11], v[136:139]
    ds_read_b128 v[88:91], v28 offset:12288
    v_mfma_f32_16x16x32_bf16 v[140:143], v[52:55], a[12:15], v[140:143]
    ds_read_b128 v[92:95], v28 offset:14336
    v_mfma_f32_16x16x32_bf16 v[144:147], v[52:55], a[16:19], v[144:147]
    ds_read_b64_tr_b16 v[36:37], v30 offset:0
    v_mfma_f32_16x16x32_bf16 v[148:151], v[52:55], a[20:23], v[148:151]
    buffer_load_dwordx4 v23, s[8:11], s30 offen offset:3072 lds
    s_add_u32 s30, s30, 128
    ds_read_b64_tr_b16 v[38:39], v30 offset:1024
    v_mfma_f32_16x16x32_bf16 v[152:155], v[52:55], a[24:27], v[152:155]
    ds_read_b64_tr_b16 v[40:41], v29 offset:16384
    v_mfma_f32_16x16x32_bf16 v[156:159], v[52:55], a[28:31], v[156:159]
    ds_read_b64_tr_b16 v[42:43], v29 offset:17408
    v_mfma_f32_16x16x32_bf16 v[160:163], v[56:59], a[0:3], v[160:163]
    ds_read_b64_tr_b16 v[44:45], v30 offset:16384
    v_mfma_f32_16x16x32_bf16 v[164:167], v[56:59], a[4:7], v[164:167]
    s_mov_b32 m0, s35
    s_add_u32 s35, s35, 0x8000
    buffer_load_dwordx4 v24, s[12:15], s31 offen lds
    ds_read_b64_tr_b16 v[46:47], v30 offset:17408
    v_mfma_f32_16x16x32_bf16 v[168:171], v[56:59], a[8:11], v[168:171]
    v_mfma_f32_16x16x32_bf16 v[172:175], v[56:59], a[12:15], v[172:175]
    v_mfma_f32_16x16x32_bf16 v[176:179], v[56:59], a[16:19], v[176:179]
    v_mfma_f32_16x16x32_bf16 v[180:183], v[56:59], a[20:23], v[180:183]
    buffer_load_dwordx4 v25, s[12:15], s31 offen offset:1024 lds
    v_mfma_f32_16x16x32_bf16 v[184:187], v[56:59], a[24:27], v[184:187]
    v_mfma_f32_16x16x32_bf16 v[188:191], v[56:59], a[28:31], v[188:191]
    v_mfma_f32_16x16x32_bf16 v[192:195], v[60:63], a[0:3], v[192:195]
    v_mfma_f32_16x16x32_bf16 v[196:199], v[60:63], a[4:7], v[196:199]
    buffer_load_dwordx4 v26, s[12:15], s31 offen offset:2048 lds
    v_mfma_f32_16x16x32_bf16 v[200:203], v[60:63], a[8:11], v[200:203]
    v_mfma_f32_16x16x32_bf16 v[204:207], v[60:63], a[12:15], v[204:207]
    v_mfma_f32_16x16x32_bf16 v[208:211], v[60:63], a[16:19], v[208:211]
    v_mfma_f32_16x16x32_bf16 v[212:215], v[60:63], a[20:23], v[212:215]
    buffer_load_dwordx4 v27, s[12:15], s31 offen offset:3072 lds
    s_add_u32 s31, s31, 458752
    s_cmp_ge_u32 s35, 0x28000
    s_cselect_b32 s29, 0x18000, 0
    s_sub_u32 s35, s35, s29
    v_mfma_f32_16x16x32_bf16 v[216:219], v[60:63], a[24:27], v[216:219]
    v_mfma_f32_16x16x32_bf16 v[220:223], v[60:63], a[28:31], v[220:223]
    s_sub_u32 s34, s34, 1
    s_cmp_lg_u32 s34, 0
    s_cbranch_scc1 L_g1_loop
    s_waitcnt lgkmcnt(0)
    s_cmp_lg_u32 s27, 0
    s_cbranch_scc1 L_ones_recurr_9
    v_mfma_f32_16x16x32_bf16 v[0:3], v[32:35], v[16:19], v[0:3]
    v_mfma_f32_16x16x32_bf16 v[4:7], v[36:39], v[16:19], v[4:7]
    v_mfma_f32_16x16x32_bf16 v[8:11], v[40:43], v[16:19], v[8:11]
    v_mfma_f32_16x16x32_bf16 v[12:15], v[44:47], v[16:19], v[12:15]
L_ones_recurr_9:
    v_mfma_f32_16x16x32_bf16 v[96:99], v[32:35], v[64:67], v[96:99]
    v_xor_b32 v28, 64, v28
    v_mfma_f32_16x16x32_bf16 v[100:103], v[32:35], v[68:71], v[100:103]
    ds_read_b64_tr_b16 v[48:49], v29 offset:8192
    v_mfma_f32_16x16x32_bf16 v[104:107], v[32:35], v[72:75], v[104:107]
    ds_read_b64_tr_b16 v[50:51], v29 offset:9216
    v_mfma_f32_16x16x32_bf16 v[108:111], v[32:35], v[76:79], v[108:111]
    ds_read_b128 a[0:3], v28 offset:0
    v_mfma_f32_16x16x32_bf16 v[112:115], v[32:35], v[80:83], v[112:115]
    ds_read_b128 a[4:7], v28 offset:2048
    v_mfma_f32_16x16x32_bf16 v[116:119], v[32:35], v[84:87], v[116:119]
    ds_read_b128 a[8:11], v28 offset:4096
    v_mfma_f32_16x16x32_bf16 v[120:123], v[32:35], v[88:91], v[120:123]
    ds_read_b128 a[12:15], v28 offset:6144
    v_mfma_f32_16x16x32_bf16 v[124:127], v[32:35], v[92:95], v[124:127]
    ds_read_b128 a[16:19], v28 offset:8192
    v_mfma_f32_16x16x32_bf16 v[128:131], v[36:39], v[64:67], v[128:131]
    ds_read_b128 a[20:23], v28 offset:10240
    v_mfma_f32_16x16x32_bf16 v[132:135], v[36:39], v[68:71], v[132:135]
    ds_read_b128 a[24:27], v28 offset:12288
    v_mfma_f32_16x16x32_bf16 v[136:139], v[36:39], v[72:75], v[136:139]
    ds_read_b128 a[28:31], v28 offset:14336
    v_mfma_f32_16x16x32_bf16 v[140:143], v[36:39], v[76:79], v[140:143]
    ds_read_b64_tr_b16 v[52:53], v30 offset:8192
    v_mfma_f32_16x16x32_bf16 v[144:147], v[36:39], v[80:83], v[144:147]
    ds_read_b64_tr_b16 v[54:55], v30 offset:9216
    v_mfma_f32_16x16x32_bf16 v[148:151], v[36:39], v[84:87], v[148:151]
    ds_read_b64_tr_b16 v[56:57], v29 offset:24576
    v_mfma_f32_16x16x32_bf16 v[152:155], v[36:39], v[88:91], v[152:155]
    ds_read_b64_tr_b16 v[58:59], v29 offset:25600
    v_mfma_f32_16x16x32_bf16 v[156:159], v[36:39], v[92:95], v[156:159]
    ds_read_b64_tr_b16 v[60:61], v30 offset:24576
    v_mfma_f32_16x16x32_bf16 v[160:163], v[40:43], v[64:67], v[160:163]
    ds_read_b64_tr_b16 v[62:63], v30 offset:25600
    v_mfma_f32_16x16x32_bf16 v[164:167], v[40:43], v[68:71], v[164:167]
    v_mfma_f32_16x16x32_bf16 v[168:171], v[40:43], v[72:75], v[168:171]
    v_mfma_f32_16x16x32_bf16 v[172:175], v[40:43], v[76:79], v[172:175]
    v_mfma_f32_16x16x32_bf16 v[176:179], v[40:43], v[80:83], v[176:179]
    v_mfma_f32_16x16x32_bf16 v[180:183], v[40:43], v[84:87], v[180:183]
    v_mfma_f32_16x16x32_bf16 v[184:187], v[40:43], v[88:91], v[184:187]
    v_mfma_f32_16x16x32_bf16 v[188:191], v[40:43], v[92:95], v[188:191]
    v_mfma_f32_16x16x32_bf16 v[192:195], v[44:47], v[64:67], v[192:195]
    v_mfma_f32_16x16x32_bf16 v[196:199], v[44:47], v[68:71], v[196:199]
    v_mfma_f32_16x16x32_bf16 v[200:203], v[44:47], v[72:75], v[200:203]
    v_mfma_f32_16x16x32_bf16 v[204:207], v[44:47], v[76:79], v[204:207]
    v_mfma_f32_16x16x32_bf16 v[208:211], v[44:47], v[80:83], v[208:211]
    v_mfma_f32_16x16x32_bf16 v[212:215], v[44:47], v[84:87], v[212:215]
    v_mfma_f32_16x16x32_bf16 v[216:219], v[44:47], v[88:91], v[216:219]
    v_mfma_f32_16x16x32_bf16 v[220:223], v[44:47], v[92:95], v[220:223]
    s_waitcnt vmcnt(4) lgkmcnt(0)
    s_barrier
    s_cmp_lg_u32 s27, 1
    s_cbranch_scc1 L_ones_recurr_10
    v_mfma_f32_16x16x32_bf16 v[0:3], v[48:51], v[16:19], v[0:3]
    v_mfma_f32_16x16x32_bf16 v[4:7], v[52:55], v[16:19], v[4:7]
    v_mfma_f32_16x16x32_bf16 v[8:11], v[56:59], v[16:19], v[8:11]
    v_mfma_f32_16x16x32_bf16 v[12:15], v[60:63], v[16:19], v[12:15]
L_ones_recurr_10:
    v_mfma_f32_16x16x32_bf16 v[96:99], v[48:51], a[0:3], v[96:99]
    v_xor_b32 v28, 0x8040, v28
    s_add_u32 s33, s33, 0x8000
    s_cmp_eq_u32 s33, 0x18000
    s_cselect_b32 s29, s68, s69
    s_cselect_b32 s33, 0, s33
    v_add_u32 v29, s29, v29
    v_add_u32 v30, s29, v30
    v_mfma_f32_16x16x32_bf16 v[100:103], v[48:51], a[4:7], v[100:103]
    s_add_u32 m0, s32, 0
    s_nop 0
    buffer_load_dwordx4 v20, s[8:11], s30 offen lds
    v_mfma_f32_16x16x32_bf16 v[104:107], v[48:51], a[8:11], v[104:107]
    ds_read_b64_tr_b16 v[32:33], v29 offset:0
    v_mfma_f32_16x16x32_bf16 v[108:111], v[48:51], a[12:15], v[108:111]
    ds_read_b64_tr_b16 v[34:35], v29 offset:1024
    v_mfma_f32_16x16x32_bf16 v[112:115], v[48:51], a[16:19], v[112:115]
    ds_read_b128 v[64:67], v28 offset:0
    v_mfma_f32_16x16x32_bf16 v[116:119], v[48:51], a[20:23], v[116:119]
    buffer_load_dwordx4 v21, s[8:11], s30 offen offset:1024 lds
    ds_read_b128 v[68:71], v28 offset:2048
    v_mfma_f32_16x16x32_bf16 v[120:123], v[48:51], a[24:27], v[120:123]
    ds_read_b128 v[72:75], v28 offset:4096
    v_mfma_f32_16x16x32_bf16 v[124:127], v[48:51], a[28:31], v[124:127]
    ds_read_b128 v[76:79], v28 offset:6144
    v_mfma_f32_16x16x32_bf16 v[128:131], v[52:55], a[0:3], v[128:131]
    ds_read_b128 v[80:83], v28 offset:8192
    v_mfma_f32_16x16x32_bf16 v[132:135], v[52:55], a[4:7], v[132:135]
    buffer_load_dwordx4 v22, s[8:11], s30 offen offset:2048 lds
    ds_read_b128 v[84:87], v28 offset:10240
    v_mfma_f32_16x16x32_bf16 v[136:139], v[52:55], a[8:11], v[136:139]
    ds_read_b128 v[88:91], v28 offset:12288
    v_mfma_f32_16x16x32_bf16 v[140:143], v[52:55], a[12:15], v[140:143]
    ds_read_b128 v[92:95], v28 offset:14336
    v_mfma_f32_16x16x32_bf16 v[144:147], v[52:55], a[16:19], v[144:147]
    ds_read_b64_tr_b16 v[36:37], v30 offset:0
    v_mfma_f32_16x16x32_bf16 v[148:151], v[52:55], a[20:23], v[148:151]
    buffer_load_dwordx4 v23, s[8:11], s30 offen offset:3072 lds
    s_add_u32 s30, s30, 128
    ds_read_b64_tr_b16 v[38:39], v30 offset:1024
    v_mfma_f32_16x16x32_bf16 v[152:155], v[52:55], a[24:27], v[152:155]
    ds_read_b64_tr_b16 v[40:41], v29 offset:16384
    v_mfma_f32_16x16x32_bf16 v[156:159], v[52:55], a[28:31], v[156:159]
    ds_read_b64_tr_b16 v[42:43], v29 offset:17408
    v_mfma_f32_16x16x32_bf16 v[160:163], v[56:59], a[0:3], v[160:163]
    ds_read_b64_tr_b16 v[44:45], v30 offset:16384
    v_mfma_f32_16x16x32_bf16 v[164:167], v[56:59], a[4:7], v[164:167]
    s_mov_b32 m0, s35
    s_add_u32 s35, s35, 0x8000
    buffer_load_dwordx4 v24, s[12:15], s31 offen lds
    ds_read_b64_tr_b16 v[46:47], v30 offset:17408
    v_mfma_f32_16x16x32_bf16 v[168:171], v[56:59], a[8:11], v[168:171]
    v_mfma_f32_16x16x32_bf16 v[172:175], v[56:59], a[12:15], v[172:175]
    v_mfma_f32_16x16x32_bf16 v[176:179], v[56:59], a[16:19], v[176:179]
    v_mfma_f32_16x16x32_bf16 v[180:183], v[56:59], a[20:23], v[180:183]
    buffer_load_dwordx4 v25, s[12:15], s31 offen offset:1024 lds
    v_mfma_f32_16x16x32_bf16 v[184:187], v[56:59], a[24:27], v[184:187]
    v_mfma_f32_16x16x32_bf16 v[188:191], v[56:59], a[28:31], v[188:191]
    v_mfma_f32_16x16x32_bf16 v[192:195], v[60:63], a[0:3], v[192:195]
    v_mfma_f32_16x16x32_bf16 v[196:199], v[60:63], a[4:7], v[196:199]
    buffer_load_dwordx4 v26, s[12:15], s31 offen offset:2048 lds
    v_mfma_f32_16x16x32_bf16 v[200:203], v[60:63], a[8:11], v[200:203]
    v_mfma_f32_16x16x32_bf16 v[204:207], v[60:63], a[12:15], v[204:207]
    v_mfma_f32_16x16x32_bf16 v[208:211], v[60:63], a[16:19], v[208:211]
    v_mfma_f32_16x16x32_bf16 v[212:215], v[60:63], a[20:23], v[212:215]
    buffer_load_dwordx4 v27, s[12:15], s31 offen offset:3072 lds
    s_add_u32 s31, s31, 458752
    s_cmp_ge_u32 s35, 0x28000
    s_cselect_b32 s29, 0x18000, 0
    s_sub_u32 s35, s35, s29
    v_mfma_f32_16x16x32_bf16 v[216:219], v[60:63], a[24:27], v[216:219]
    v_mfma_f32_16x16x32_bf16 v[220:223], v[60:63], a[28:31], v[220:223]
    s_waitcnt lgkmcnt(0)
    s_cmp_lg_u32 s27, 0
    s_cbranch_scc1 L_ones_recurr_11
    v_mfma_f32_16x16x32_bf16 v[0:3], v[32:35], v[16:19], v[0:3]
    v_mfma_f32_16x16x32_bf16 v[4:7], v[36:39], v[16:19], v[4:7]
    v_mfma_f32_16x16x32_bf16 v[8:11], v[40:43], v[16:19], v[8:11]
    v_mfma_f32_16x16x32_bf16 v[12:15], v[44:47], v[16:19], v[12:15]
L_ones_recurr_11:
    v_mfma_f32_16x16x32_bf16 v[96:99], v[32:35], v[64:67], v[96:99]
    v_xor_b32 v28, 64, v28
    v_mfma_f32_16x16x32_bf16 v[100:103], v[32:35], v[68:71], v[100:103]
    ds_read_b64_tr_b16 v[48:49], v29 offset:8192
    v_mfma_f32_16x16x32_bf16 v[104:107], v[32:35], v[72:75], v[104:107]
    ds_read_b64_tr_b16 v[50:51], v29 offset:9216
    v_mfma_f32_16x16x32_bf16 v[108:111], v[32:35], v[76:79], v[108:111]
    ds_read_b128 a[0:3], v28 offset:0
    v_mfma_f32_16x16x32_bf16 v[112:115], v[32:35], v[80:83], v[112:115]
    ds_read_b128 a[4:7], v28 offset:2048
    v_mfma_f32_16x16x32_bf16 v[116:119], v[32:35], v[84:87], v[116:119]
    ds_read_b128 a[8:11], v28 offset:4096
    v_mfma_f32_16x16x32_bf16 v[120:123], v[32:35], v[88:91], v[120:123]
    ds_read_b128 a[12:15], v28 offset:6144
    v_mfma_f32_16x16x32_bf16 v[124:127], v[32:35], v[92:95], v[124:127]
    ds_read_b128 a[16:19], v28 offset:8192
    v_mfma_f32_16x16x32_bf16 v[128:131], v[36:39], v[64:67], v[128:131]
    ds_read_b128 a[20:23], v28 offset:10240
    v_mfma_f32_16x16x32_bf16 v[132:135], v[36:39], v[68:71], v[132:135]
    ds_read_b128 a[24:27], v28 offset:12288
    v_mfma_f32_16x16x32_bf16 v[136:139], v[36:39], v[72:75], v[136:139]
    ds_read_b128 a[28:31], v28 offset:14336
    v_mfma_f32_16x16x32_bf16 v[140:143], v[36:39], v[76:79], v[140:143]
    ds_read_b64_tr_b16 v[52:53], v30 offset:8192
    v_mfma_f32_16x16x32_bf16 v[144:147], v[36:39], v[80:83], v[144:147]
    ds_read_b64_tr_b16 v[54:55], v30 offset:9216
    v_mfma_f32_16x16x32_bf16 v[148:151], v[36:39], v[84:87], v[148:151]
    ds_read_b64_tr_b16 v[56:57], v29 offset:24576
    v_mfma_f32_16x16x32_bf16 v[152:155], v[36:39], v[88:91], v[152:155]
    ds_read_b64_tr_b16 v[58:59], v29 offset:25600
    v_mfma_f32_16x16x32_bf16 v[156:159], v[36:39], v[92:95], v[156:159]
    ds_read_b64_tr_b16 v[60:61], v30 offset:24576
    v_mfma_f32_16x16x32_bf16 v[160:163], v[40:43], v[64:67], v[160:163]
    ds_read_b64_tr_b16 v[62:63], v30 offset:25600
    v_mfma_f32_16x16x32_bf16 v[164:167], v[40:43], v[68:71], v[164:167]
    v_mfma_f32_16x16x32_bf16 v[168:171], v[40:43], v[72:75], v[168:171]
    v_mfma_f32_16x16x32_bf16 v[172:175], v[40:43], v[76:79], v[172:175]
    v_mfma_f32_16x16x32_bf16 v[176:179], v[40:43], v[80:83], v[176:179]
    v_mfma_f32_16x16x32_bf16 v[180:183], v[40:43], v[84:87], v[180:183]
    v_mfma_f32_16x16x32_bf16 v[184:187], v[40:43], v[88:91], v[184:187]
    v_mfma_f32_16x16x32_bf16 v[188:191], v[40:43], v[92:95], v[188:191]
    v_mfma_f32_16x16x32_bf16 v[192:195], v[44:47], v[64:67], v[192:195]
    v_mfma_f32_16x16x32_bf16 v[196:199], v[44:47], v[68:71], v[196:199]
    v_mfma_f32_16x16x32_bf16 v[200:203], v[44:47], v[72:75], v[200:203]
    v_mfma_f32_16x16x32_bf16 v[204:207], v[44:47], v[76:79], v[204:207]
    v_mfma_f32_16x16x32_bf16 v[208:211], v[44:47], v[80:83], v[208:211]
    v_mfma_f32_16x16x32_bf16 v[212:215], v[44:47], v[84:87], v[212:215]
    v_mfma_f32_16x16x32_bf16 v[216:219], v[44:47], v[88:91], v[216:219]
    v_mfma_f32_16x16x32_bf16 v[220:223], v[44:47], v[92:95], v[220:223]
    s_waitcnt vmcnt(4) lgkmcnt(0)
    s_barrier
    s_cmp_lg_u32 s27, 1
    s_cbranch_scc1 L_ones_recurr_12
    v_mfma_f32_16x16x32_bf16 v[0:3], v[48:51], v[16:19], v[0:3]
    v_mfma_f32_16x16x32_bf16 v[4:7], v[52:55], v[16:19], v[4:7]
    v_mfma_f32_16x16x32_bf16 v[8:11], v[56:59], v[16:19], v[8:11]
    v_mfma_f32_16x16x32_bf16 v[12:15], v[60:63], v[16:19], v[12:15]
L_ones_recurr_12:
    v_mfma_f32_16x16x32_bf16 v[96:99], v[48:51], a[0:3], v[96:99]
    v_xor_b32 v28, 0x8040, v28
    s_add_u32 s33, s33, 0x8000
    s_cmp_eq_u32 s33, 0x18000
    s_cselect_b32 s29, s68, s69
    s_cselect_b32 s33, 0, s33
    v_add_u32 v29, s29, v29
    v_add_u32 v30, s29, v30
    v_mfma_f32_16x16x32_bf16 v[100:103], v[48:51], a[4:7], v[100:103]
    s_add_u32 m0, s32, 32768
    s_nop 0
    buffer_load_dwordx4 v20, s[8:11], s30 offen lds
    v_mfma_f32_16x16x32_bf16 v[104:107], v[48:51], a[8:11], v[104:107]
    ds_read_b64_tr_b16 v[32:33], v29 offset:0
    v_mfma_f32_16x16x32_bf16 v[108:111], v[48:51], a[12:15], v[108:111]
    ds_read_b64_tr_b16 v[34:35], v29 offset:1024
    v_mfma_f32_16x16x32_bf16 v[112:115], v[48:51], a[16:19], v[112:115]
    ds_read_b128 v[64:67], v28 offset:0
    v_mfma_f32_16x16x32_bf16 v[116:119], v[48:51], a[20:23], v[116:119]
    buffer_load_dwordx4 v21, s[8:11], s30 offen offset:1024 lds
    ds_read_b128 v[68:71], v28 offset:2048
    v_mfma_f32_16x16x32_bf16 v[120:123], v[48:51], a[24:27], v[120:123]
    ds_read_b128 v[72:75], v28 offset:4096
    v_mfma_f32_16x16x32_bf16 v[124:127], v[48:51], a[28:31], v[124:127]
    ds_read_b128 v[76:79], v28 offset:6144
    v_mfma_f32_16x16x32_bf16 v[128:131], v[52:55], a[0:3], v[128:131]
    ds_read_b128 v[80:83], v28 offset:8192
    v_mfma_f32_16x16x32_bf16 v[132:135], v[52:55], a[4:7], v[132:135]
    buffer_load_dwordx4 v22, s[8:11], s30 offen offset:2048 lds
    ds_read_b128 v[84:87], v28 offset:10240
    v_mfma_f32_16x16x32_bf16 v[136:139], v[52:55], a[8:11], v[136:139]
    ds_read_b128 v[88:91], v28 offset:12288
    v_mfma_f32_16x16x32_bf16 v[140:143], v[52:55], a[12:15], v[140:143]
    ds_read_b128 v[92:95], v28 offset:14336
    v_mfma_f32_16x16x32_bf16 v[144:147], v[52:55], a[16:19], v[144:147]
    ds_read_b64_tr_b16 v[36:37], v30 offset:0
    v_mfma_f32_16x16x32_bf16 v[148:151], v[52:55], a[20:23], v[148:151]
    buffer_load_dwordx4 v23, s[8:11], s30 offen offset:3072 lds
    s_add_u32 s30, s30, 128
    ds_read_b64_tr_b16 v[38:39], v30 offset:1024
    v_mfma_f32_16x16x32_bf16 v[152:155], v[52:55], a[24:27], v[152:155]
    ds_read_b64_tr_b16 v[40:41], v29 offset:16384
    v_mfma_f32_16x16x32_bf16 v[156:159], v[52:55], a[28:31], v[156:159]
    ds_read_b64_tr_b16 v[42:43], v29 offset:17408
    v_mfma_f32_16x16x32_bf16 v[160:163], v[56:59], a[0:3], v[160:163]
    ds_read_b64_tr_b16 v[44:45], v30 offset:16384
    v_mfma_f32_16x16x32_bf16 v[164:167], v[56:59], a[4:7], v[164:167]
    ds_read_b64_tr_b16 v[46:47], v30 offset:17408
    v_mfma_f32_16x16x32_bf16 v[168:171], v[56:59], a[8:11], v[168:171]
    v_mfma_f32_16x16x32_bf16 v[172:175], v[56:59], a[12:15], v[172:175]
    v_mfma_f32_16x16x32_bf16 v[176:179], v[56:59], a[16:19], v[176:179]
    v_mfma_f32_16x16x32_bf16 v[180:183], v[56:59], a[20:23], v[180:183]
    v_mfma_f32_16x16x32_bf16 v[184:187], v[56:59], a[24:27], v[184:187]
    v_mfma_f32_16x16x32_bf16 v[188:191], v[56:59], a[28:31], v[188:191]
    v_mfma_f32_16x16x32_bf16 v[192:195], v[60:63], a[0:3], v[192:195]
    v_mfma_f32_16x16x32_bf16 v[196:199], v[60:63], a[4:7], v[196:199]
    v_mfma_f32_16x16x32_bf16 v[200:203], v[60:63], a[8:11], v[200:203]
    v_mfma_f32_16x16x32_bf16 v[204:207], v[60:63], a[12:15], v[204:207]
    v_mfma_f32_16x16x32_bf16 v[208:211], v[60:63], a[16:19], v[208:211]
    v_mfma_f32_16x16x32_bf16 v[212:215], v[60:63], a[20:23], v[212:215]
    v_mfma_f32_16x16x32_bf16 v[216:219], v[60:63], a[24:27], v[216:219]
    v_mfma_f32_16x16x32_bf16 v[220:223], v[60:63], a[28:31], v[220:223]
    s_waitcnt lgkmcnt(0)
    s_cmp_lg_u32 s27, 0
    s_cbranch_scc1 L_ones_recurr_16
    v_mfma_f32_16x16x32_bf16 v[0:3], v[32:35], v[16:19], v[0:3]
    v_mfma_f32_16x16x32_bf16 v[4:7], v[36:39], v[16:19], v[4:7]
    v_mfma_f32_16x16x32_bf16 v[8:11], v[40:43], v[16:19], v[8:11]
    v_mfma_f32_16x16x32_bf16 v[12:15], v[44:47], v[16:19], v[12:15]
L_ones_recurr_16:
    v_mfma_f32_16x16x32_bf16 v[96:99], v[32:35], v[64:67], v[96:99]
    v_xor_b32 v28, 64, v28
    s_cmp_lg_u32 s28, 0
    s_cbranch_scc1 L_fl1_recurr_13
    v_mov_b32 v31, 4
    buffer_load_dword v20, v31, s[60:63], 0 offen sc1
    L_fl1_recurr_13:
    v_mfma_f32_16x16x32_bf16 v[100:103], v[32:35], v[68:71], v[100:103]
    ds_read_b64_tr_b16 v[48:49], v29 offset:8192
    v_mfma_f32_16x16x32_bf16 v[104:107], v[32:35], v[72:75], v[104:107]
    ds_read_b64_tr_b16 v[50:51], v29 offset:9216
    v_mfma_f32_16x16x32_bf16 v[108:111], v[32:35], v[76:79], v[108:111]
    ds_read_b128 a[0:3], v28 offset:0
    v_mfma_f32_16x16x32_bf16 v[112:115], v[32:35], v[80:83], v[112:115]
    ds_read_b128 a[4:7], v28 offset:2048
    v_mfma_f32_16x16x32_bf16 v[116:119], v[32:35], v[84:87], v[116:119]
    ds_read_b128 a[8:11], v28 offset:4096
    v_mfma_f32_16x16x32_bf16 v[120:123], v[32:35], v[88:91], v[120:123]
    ds_read_b128 a[12:15], v28 offset:6144
    v_mfma_f32_16x16x32_bf16 v[124:127], v[32:35], v[92:95], v[124:127]
    ds_read_b128 a[16:19], v28 offset:8192
    v_mfma_f32_16x16x32_bf16 v[128:131], v[36:39], v[64:67], v[128:131]
    ds_read_b128 a[20:23], v28 offset:10240
    v_mfma_f32_16x16x32_bf16 v[132:135], v[36:39], v[68:71], v[132:135]
    ds_read_b128 a[24:27], v28 offset:12288
    v_mfma_f32_16x16x32_bf16 v[136:139], v[36:39], v[72:75], v[136:139]
    ds_read_b128 a[28:31], v28 offset:14336
    v_mfma_f32_16x16x32_bf16 v[140:143], v[36:39], v[76:79], v[140:143]
    ds_read_b64_tr_b16 v[52:53], v30 offset:8192
    v_mfma_f32_16x16x32_bf16 v[144:147], v[36:39], v[80:83], v[144:147]
    ds_read_b64_tr_b16 v[54:55], v30 offset:9216
    v_mfma_f32_16x16x32_bf16 v[148:151], v[36:39], v[84:87], v[148:151]
    ds_read_b64_tr_b16 v[56:57], v29 offset:24576
    v_mfma_f32_16x16x32_bf16 v[152:155], v[36:39], v[88:91], v[152:155]
    ds_read_b64_tr_b16 v[58:59], v29 offset:25600
    v_mfma_f32_16x16x32_bf16 v[156:159], v[36:39], v[92:95], v[156:159]
    ds_read_b64_tr_b16 v[60:61], v30 offset:24576
    v_mfma_f32_16x16x32_bf16 v[160:163], v[40:43], v[64:67], v[160:163]
    ds_read_b64_tr_b16 v[62:63], v30 offset:25600
    v_mfma_f32_16x16x32_bf16 v[164:167], v[40:43], v[68:71], v[164:167]
    v_mfma_f32_16x16x32_bf16 v[168:171], v[40:43], v[72:75], v[168:171]
    v_mfma_f32_16x16x32_bf16 v[172:175], v[40:43], v[76:79], v[172:175]
    v_mfma_f32_16x16x32_bf16 v[176:179], v[40:43], v[80:83], v[176:179]
    v_mfma_f32_16x16x32_bf16 v[180:183], v[40:43], v[84:87], v[180:183]
    v_mfma_f32_16x16x32_bf16 v[184:187], v[40:43], v[88:91], v[184:187]
    v_mfma_f32_16x16x32_bf16 v[188:191], v[40:43], v[92:95], v[188:191]
    v_mfma_f32_16x16x32_bf16 v[192:195], v[44:47], v[64:67], v[192:195]
    v_mfma_f32_16x16x32_bf16 v[196:199], v[44:47], v[68:71], v[196:199]
    v_mfma_f32_16x16x32_bf16 v[200:203], v[44:47], v[72:75], v[200:203]
    v_mfma_f32_16x16x32_bf16 v[204:207], v[44:47], v[76:79], v[204:207]
    v_mfma_f32_16x16x32_bf16 v[208:211], v[44:47], v[80:83], v[208:211]
    v_mfma_f32_16x16x32_bf16 v[212:215], v[44:47], v[84:87], v[212:215]
    v_mfma_f32_16x16x32_bf16 v[216:219], v[44:47], v[88:91], v[216:219]
    v_mfma_f32_16x16x32_bf16 v[220:223], v[44:47], v[92:95], v[220:223]
    s_waitcnt vmcnt(0) lgkmcnt(0)
    s_cmp_lg_u32 s28, 0
    s_cbranch_scc1 L_ok_recurr_15
    v_readfirstlane_b32 s29, v20
    s_cmp_ge_u32 s29, 32
    s_cbranch_scc1 L_ok_recurr_15
    s_mov_b32 s100, 0x40000
    L_spin_recurr_14:
    s_sub_u32 s100, s100, 1
    s_cmp_eq_u32 s100, 0
    s_cbranch_scc1 L_ok_recurr_15
    s_sleep 2
    v_mov_b32 v31, 4
    buffer_load_dword v20, v31, s[60:63], 0 offen sc1
    s_waitcnt vmcnt(0)
    v_readfirstlane_b32 s29, v20
    s_cmp_lt_u32 s29, 32
    s_cbranch_scc1 L_spin_recurr_14
    L_ok_recurr_15:
    s_barrier
    v_mbcnt_lo_u32_b32 v31, -1, 0
    v_mbcnt_hi_u32_b32 v31, -1, v31
    v_and_b32 v31, 15, v31
    s_lshl_b32 s29, s25, 8
    s_lshl_b32 s35, s27, 7
    s_add_u32 s29, s29, s35
    v_add_u32 v31, s29, v31
    v_lshlrev_b32 v31, 3, v31
    buffer_load_dwordx2 v[20:21], v31, s[56:59], 0 offen offset:0 sc1
    buffer_load_dwordx2 v[22:23], v31, s[56:59], 0 offen offset:128 sc1
    buffer_load_dwordx2 v[24:25], v31, s[56:59], 0 offen offset:256 sc1
    buffer_load_dwordx2 v[26:27], v31, s[56:59], 0 offen offset:384 sc1
    s_cmp_lg_u32 s27, 1
    s_cbranch_scc1 L_ones_recurr_17
    v_mfma_f32_16x16x32_bf16 v[0:3], v[48:51], v[16:19], v[0:3]
    v_mfma_f32_16x16x32_bf16 v[4:7], v[52:55], v[16:19], v[4:7]
    v_mfma_f32_16x16x32_bf16 v[8:11], v[56:59], v[16:19], v[8:11]
    v_mfma_f32_16x16x32_bf16 v[12:15], v[60:63], v[16:19], v[12:15]
L_ones_recurr_17:
    v_mfma_f32_16x16x32_bf16 v[96:99], v[48:51], a[0:3], v[96:99]
    v_xor_b32 v28, 0x8040, v28
    s_add_u32 s33, s33, 0x8000
    s_cmp_eq_u32 s33, 0x18000
    s_cselect_b32 s29, s68, s69
    s_cselect_b32 s33, 0, s33
    v_add_u32 v29, s29, v29
    v_add_u32 v30, s29, v30
    v_mfma_f32_16x16x32_bf16 v[100:103], v[48:51], a[4:7], v[100:103]
    v_mfma_f32_16x16x32_bf16 v[104:107], v[48:51], a[8:11], v[104:107]
    ds_read_b64_tr_b16 v[32:33], v29 offset:0
    v_mfma_f32_16x16x32_bf16 v[108:111], v[48:51], a[12:15], v[108:111]
    ds_read_b64_tr_b16 v[34:35], v29 offset:1024
    v_mfma_f32_16x16x32_bf16 v[112:115], v[48:51], a[16:19], v[112:115]
    ds_read_b128 v[64:67], v28 offset:0
    v_mfma_f32_16x16x32_bf16 v[116:119], v[48:51], a[20:23], v[116:119]
    ds_read_b128 v[68:71], v28 offset:2048
    v_mfma_f32_16x16x32_bf16 v[120:123], v[48:51], a[24:27], v[120:123]
    ds_read_b128 v[72:75], v28 offset:4096
    v_mfma_f32_16x16x32_bf16 v[124:127], v[48:51], a[28:31], v[124:127]
    ds_read_b128 v[76:79], v28 offset:6144
    v_mfma_f32_16x16x32_bf16 v[128:131], v[52:55], a[0:3], v[128:131]
    ds_read_b128 v[80:83], v28 offset:8192
    v_mfma_f32_16x16x32_bf16 v[132:135], v[52:55], a[4:7], v[132:135]
    ds_read_b128 v[84:87], v28 offset:10240
    v_mfma_f32_16x16x32_bf16 v[136:139], v[52:55], a[8:11], v[136:139]
    ds_read_b128 v[88:91], v28 offset:12288
    v_mfma_f32_16x16x32_bf16 v[140:143], v[52:55], a[12:15], v[140:143]
    ds_read_b128 v[92:95], v28 offset:14336
    v_mfma_f32_16x16x32_bf16 v[144:147], v[52:55], a[16:19], v[144:147]
    ds_read_b64_tr_b16 v[36:37], v30 offset:0
    v_mfma_f32_16x16x32_bf16 v[148:151], v[52:55], a[20:23], v[148:151]
    ds_read_b64_tr_b16 v[38:39], v30 offset:1024
    v_mfma_f32_16x16x32_bf16 v[152:155], v[52:55], a[24:27], v[152:155]
    ds_read_b64_tr_b16 v[40:41], v29 offset:16384
    v_mfma_f32_16x16x32_bf16 v[156:159], v[52:55], a[28:31], v[156:159]
    ds_read_b64_tr_b16 v[42:43], v29 offset:17408
    v_mfma_f32_16x16x32_bf16 v[160:163], v[56:59], a[0:3], v[160:163]
    ds_read_b64_tr_b16 v[44:45], v30 offset:16384
    v_mfma_f32_16x16x32_bf16 v[164:167], v[56:59], a[4:7], v[164:167]
    ds_read_b64_tr_b16 v[46:47], v30 offset:17408
    v_mfma_f32_16x16x32_bf16 v[168:171], v[56:59], a[8:11], v[168:171]
    v_mfma_f32_16x16x32_bf16 v[172:175], v[56:59], a[12:15], v[172:175]
    v_mfma_f32_16x16x32_bf16 v[176:179], v[56:59], a[16:19], v[176:179]
    v_mfma_f32_16x16x32_bf16 v[180:183], v[56:59], a[20:23], v[180:183]
    v_mfma_f32_16x16x32_bf16 v[184:187], v[56:59], a[24:27], v[184:187]
    v_mfma_f32_16x16x32_bf16 v[188:191], v[56:59], a[28:31], v[188:191]
    v_mfma_f32_16x16x32_bf16 v[192:195], v[60:63], a[0:3], v[192:195]
    v_mfma_f32_16x16x32_bf16 v[196:199], v[60:63], a[4:7], v[196:199]
    v_mfma_f32_16x16x32_bf16 v[200:203], v[60:63], a[8:11], v[200:203]
    v_mfma_f32_16x16x32_bf16 v[204:207], v[60:63], a[12:15], v[204:207]
    v_mfma_f32_16x16x32_bf16 v[208:211], v[60:63], a[16:19], v[208:211]
    v_mfma_f32_16x16x32_bf16 v[212:215], v[60:63], a[20:23], v[212:215]
    v_mfma_f32_16x16x32_bf16 v[216:219], v[60:63], a[24:27], v[216:219]
    v_mfma_f32_16x16x32_bf16 v[220:223], v[60:63], a[28:31], v[220:223]
    s_waitcnt lgkmcnt(0)
    s_cmp_lg_u32 s27, 0
    s_cbranch_scc1 L_ones_recurr_18
    v_mfma_f32_16x16x32_bf16 v[0:3], v[32:35], v[16:19], v[0:3]
    v_mfma_f32_16x16x32_bf16 v[4:7], v[36:39], v[16:19], v[4:7]
    v_mfma_f32_16x16x32_bf16 v[8:11], v[40:43], v[16:19], v[8:11]
    v_mfma_f32_16x16x32_bf16 v[12:15], v[44:47], v[16:19], v[12:15]
L_ones_recurr_18:
    v_mfma_f32_16x16x32_bf16 v[96:99], v[32:35], v[64:67], v[96:99]
    v_xor_b32 v28, 64, v28
    v_mfma_f32_16x16x32_bf16 v[100:103], v[32:35], v[68:71], v[100:103]
    ds_read_b64_tr_b16 v[48:49], v29 offset:8192
    v_mfma_f32_16x16x32_bf16 v[104:107], v[32:35], v[72:75], v[104:107]
    ds_read_b64_tr_b16 v[50:51], v29 offset:9216
    v_mfma_f32_16x16x32_bf16 v[108:111], v[32:35], v[76:79], v[108:111]
    ds_read_b128 a[0:3], v28 offset:0
    v_mfma_f32_16x16x32_bf16 v[112:115], v[32:35], v[80:83], v[112:115]
    ds_read_b128 a[4:7], v28 offset:2048
    v_mfma_f32_16x16x32_bf16 v[116:119], v[32:35], v[84:87], v[116:119]
    ds_read_b128 a[8:11], v28 offset:4096
    v_mfma_f32_16x16x32_bf16 v[120:123], v[32:35], v[88:91], v[120:123]
    ds_read_b128 a[12:15], v28 offset:6144
    v_mfma_f32_16x16x32_bf16 v[124:127], v[32:35], v[92:95], v[124:127]
    ds_read_b128 a[16:19], v28 offset:8192
    v_mfma_f32_16x16x32_bf16 v[128:131], v[36:39], v[64:67], v[128:131]
    ds_read_b128 a[20:23], v28 offset:10240
    v_mfma_f32_16x16x32_bf16 v[132:135], v[36:39], v[68:71], v[132:135]
    ds_read_b128 a[24:27], v28 offset:12288
    v_mfma_f32_16x16x32_bf16 v[136:139], v[36:39], v[72:75], v[136:139]
    ds_read_b128 a[28:31], v28 offset:14336
    v_mfma_f32_16x16x32_bf16 v[140:143], v[36:39], v[76:79], v[140:143]
    ds_read_b64_tr_b16 v[52:53], v30 offset:8192
    v_mfma_f32_16x16x32_bf16 v[144:147], v[36:39], v[80:83], v[144:147]
    ds_read_b64_tr_b16 v[54:55], v30 offset:9216
    v_mfma_f32_16x16x32_bf16 v[148:151], v[36:39], v[84:87], v[148:151]
    ds_read_b64_tr_b16 v[56:57], v29 offset:24576
    v_mfma_f32_16x16x32_bf16 v[152:155], v[36:39], v[88:91], v[152:155]
    ds_read_b64_tr_b16 v[58:59], v29 offset:25600
    v_mfma_f32_16x16x32_bf16 v[156:159], v[36:39], v[92:95], v[156:159]
    ds_read_b64_tr_b16 v[60:61], v30 offset:24576
    v_mfma_f32_16x16x32_bf16 v[160:163], v[40:43], v[64:67], v[160:163]
    ds_read_b64_tr_b16 v[62:63], v30 offset:25600
    v_mfma_f32_16x16x32_bf16 v[164:167], v[40:43], v[68:71], v[164:167]
    v_mfma_f32_16x16x32_bf16 v[168:171], v[40:43], v[72:75], v[168:171]
    v_mfma_f32_16x16x32_bf16 v[172:175], v[40:43], v[76:79], v[172:175]
    v_mfma_f32_16x16x32_bf16 v[176:179], v[40:43], v[80:83], v[176:179]
    v_mfma_f32_16x16x32_bf16 v[180:183], v[40:43], v[84:87], v[180:183]
    v_mfma_f32_16x16x32_bf16 v[184:187], v[40:43], v[88:91], v[184:187]
    v_mfma_f32_16x16x32_bf16 v[188:191], v[40:43], v[92:95], v[188:191]
    v_mfma_f32_16x16x32_bf16 v[192:195], v[44:47], v[64:67], v[192:195]
    v_mfma_f32_16x16x32_bf16 v[196:199], v[44:47], v[68:71], v[196:199]
    v_mfma_f32_16x16x32_bf16 v[200:203], v[44:47], v[72:75], v[200:203]
    v_mfma_f32_16x16x32_bf16 v[204:207], v[44:47], v[76:79], v[204:207]
    v_mfma_f32_16x16x32_bf16 v[208:211], v[44:47], v[80:83], v[208:211]
    v_mfma_f32_16x16x32_bf16 v[212:215], v[44:47], v[84:87], v[212:215]
    v_mfma_f32_16x16x32_bf16 v[216:219], v[44:47], v[88:91], v[216:219]
    v_mfma_f32_16x16x32_bf16 v[220:223], v[44:47], v[92:95], v[220:223]
    s_waitcnt vmcnt(4) lgkmcnt(0)
    s_barrier
    buffer_load_dwordx2 v[64:65], v31, s[56:59], 0 offen offset:512 sc1
    buffer_load_dwordx2 v[66:67], v31, s[56:59], 0 offen offset:640 sc1
    buffer_load_dwordx2 v[68:69], v31, s[56:59], 0 offen offset:768 sc1
    buffer_load_dwordx2 v[70:71], v31, s[56:59], 0 offen offset:896 sc1
    v_mbcnt_lo_u32_b32 v72, -1, 0
    v_mbcnt_hi_u32_b32 v72, -1, v72
    v_lshlrev_b32 v72, 6, v72
    s_lshl_b32 s29, s3, 3
    s_add_u32 s29, s29, s24
    s_lshl_b32 s29, s29, 3
    s_add_u32 s29, s29, s28
    s_lshl_b32 s29, s29, 12
    buffer_load_dword v75, v72, s[84:87], s29 offen
    s_cmp_lg_u32 s27, 1
    s_cbranch_scc1 L_ones_recurr_19
    v_mfma_f32_16x16x32_bf16 v[0:3], v[48:51], v[16:19], v[0:3]
    v_mfma_f32_16x16x32_bf16 v[4:7], v[52:55], v[16:19], v[4:7]
    v_mfma_f32_16x16x32_bf16 v[8:11], v[56:59], v[16:19], v[8:11]
    v_mfma_f32_16x16x32_bf16 v[12:15], v[60:63], v[16:19], v[12:15]
L_ones_recurr_19:
    v_mfma_f32_16x16x32_bf16 v[96:99], v[48:51], a[0:3], v[96:99]
    v_mfma_f32_16x16x32_bf16 v[100:103], v[48:51], a[4:7], v[100:103]
    v_mfma_f32_16x16x32_bf16 v[104:107], v[48:51], a[8:11], v[104:107]
    v_mfma_f32_16x16x32_bf16 v[108:111], v[48:51], a[12:15], v[108:111]
    v_mfma_f32_16x16x32_bf16 v[112:115], v[48:51], a[16:19], v[112:115]
    v_mfma_f32_16x16x32_bf16 v[116:119], v[48:51], a[20:23], v[116:119]
    v_mfma_f32_16x16x32_bf16 v[120:123], v[48:51], a[24:27], v[120:123]
    v_mfma_f32_16x16x32_bf16 v[124:127], v[48:51], a[28:31], v[124:127]
    v_mfma_f32_16x16x32_bf16 v[128:131], v[52:55], a[0:3], v[128:131]
    v_mfma_f32_16x16x32_bf16 v[132:135], v[52:55], a[4:7], v[132:135]
    v_mfma_f32_16x16x32_bf16 v[136:139], v[52:55], a[8:11], v[136:139]
    v_mfma_f32_16x16x32_bf16 v[140:143], v[52:55], a[12:15], v[140:143]
    v_mfma_f32_16x16x32_bf16 v[144:147], v[52:55], a[16:19], v[144:147]
    v_mfma_f32_16x16x32_bf16 v[148:151], v[52:55], a[20:23], v[148:151]
    v_mfma_f32_16x16x32_bf16 v[152:155], v[52:55], a[24:27], v[152:155]
    v_mfma_f32_16x16x32_bf16 v[156:159], v[52:55], a[28:31], v[156:159]
    v_mfma_f32_16x16x32_bf16 v[160:163], v[56:59], a[0:3], v[160:163]
    v_mfma_f32_16x16x32_bf16 v[164:167], v[56:59], a[4:7], v[164:167]
    v_mfma_f32_16x16x32_bf16 v[168:171], v[56:59], a[8:11], v[168:171]
    v_mfma_f32_16x16x32_bf16 v[172:175], v[56:59], a[12:15], v[172:175]
    v_mfma_f32_16x16x32_bf16 v[176:179], v[56:59], a[16:19], v[176:179]
    v_mfma_f32_16x16x32_bf16 v[180:183], v[56:59], a[20:23], v[180:183]
    v_mfma_f32_16x16x32_bf16 v[184:187], v[56:59], a[24:27], v[184:187]
    v_mfma_f32_16x16x32_bf16 v[188:191], v[56:59], a[28:31], v[188:191]
    v_mfma_f32_16x16x32_bf16 v[192:195], v[60:63], a[0:3], v[192:195]
    v_mfma_f32_16x16x32_bf16 v[196:199], v[60:63], a[4:7], v[196:199]
    v_mfma_f32_16x16x32_bf16 v[200:203], v[60:63], a[8:11], v[200:203]
    v_mfma_f32_16x16x32_bf16 v[204:207], v[60:63], a[12:15], v[204:207]
    v_mfma_f32_16x16x32_bf16 v[208:211], v[60:63], a[16:19], v[208:211]
    v_mfma_f32_16x16x32_bf16 v[212:215], v[60:63], a[20:23], v[212:215]
    v_mfma_f32_16x16x32_bf16 v[216:219], v[60:63], a[24:27], v[216:219]
    v_mfma_f32_16x16x32_bf16 v[220:223], v[60:63], a[28:31], v[220:223]
    v_mbcnt_lo_u32_b32 v72, -1, 0
    v_mbcnt_hi_u32_b32 v72, -1, v72
    v_lshlrev_b32 v72, 4, v72
    s_lshl_b32 s29, s28, 12
    v_add_u32 v73, s29, v72
    s_xor_b32 s29, s29, 0x4000
    v_add_u32 v74, s29, v72
    s_nop 4
    ds_write_b128 v73, v[0:3] offset:0
    ds_write_b128 v73, v[4:7] offset:1024
    ds_write_b128 v73, v[8:11] offset:2048
    ds_write_b128 v73, v[12:15] offset:3072
    s_waitcnt lgkmcnt(0)
    s_barrier
    ds_read_b128 v[76:79], v74 offset:0
    ds_read_b128 v[80:83], v74 offset:1024
    ds_read_b128 v[84:87], v74 offset:2048
    ds_read_b128 v[88:91], v74 offset:3072
    s_lshl_b32 s29, s25, 1
    s_add_u32 s29, s29, s27
    s_mul_i32 s29, s29, 112
    s_and_b32 s35, s28, 3
    s_add_u32 s29, s29, s35
    s_lshl_b32 s35, s26, 2
    s_add_u32 s29, s29, s35
    s_lshl_b32 s33, s29, 13
    s_waitcnt vmcnt(1) lgkmcnt(0)
    v_pk_add_f32 v[76:77], v[76:77], v[0:1]
    v_pk_add_f32 v[78:79], v[78:79], v[2:3]
    v_pk_add_f32 v[80:81], v[80:81], v[4:5]
    v_pk_add_f32 v[82:83], v[82:83], v[6:7]
    v_pk_add_f32 v[84:85], v[84:85], v[8:9]
    v_pk_add_f32 v[86:87], v[86:87], v[10:11]
    v_pk_add_f32 v[88:89], v[88:89], v[12:13]
    v_pk_add_f32 v[90:91], v[90:91], v[14:15]
    s_mov_b32 s35, 0xbfb8aa3b
    v_mul_f32 v92, s35, v21
    v_mul_f32 v93, v21, v21
    v_pk_fma_f32 v[32:33], v[76:77], v[20:21], v[96:97] op_sel_hi:[1,0,1] neg_lo:[0,1,0] neg_hi:[0,1,0]
    v_pk_fma_f32 v[40:41], v[84:85], v[20:21], v[160:161] op_sel_hi:[1,0,1] neg_lo:[0,1,0] neg_hi:[0,1,0]
    v_pk_fma_f32 v[34:35], v[78:79], v[20:21], v[98:99] op_sel_hi:[1,0,1] neg_lo:[0,1,0] neg_hi:[0,1,0]
    v_pk_fma_f32 v[42:43], v[86:87], v[20:21], v[162:163] op_sel_hi:[1,0,1] neg_lo:[0,1,0] neg_hi:[0,1,0]
    v_pk_fma_f32 v[36:37], v[80:81], v[20:21], v[128:129] op_sel_hi:[1,0,1] neg_lo:[0,1,0] neg_hi:[0,1,0]
    v_pk_fma_f32 v[44:45], v[88:89], v[20:21], v[192:193] op_sel_hi:[1,0,1] neg_lo:[0,1,0] neg_hi:[0,1,0]
    v_pk_fma_f32 v[38:39], v[82:83], v[20:21], v[130:131] op_sel_hi:[1,0,1] neg_lo:[0,1,0] neg_hi:[0,1,0]
    v_pk_fma_f32 v[46:47], v[90:91], v[20:21], v[194:195] op_sel_hi:[1,0,1] neg_lo:[0,1,0] neg_hi:[0,1,0]
    v_pk_mul_f32 v[48:49], v[32:33], v[92:93] op_sel_hi:[1,0]
    v_pk_mul_f32 v[50:51], v[34:35], v[92:93] op_sel_hi:[1,0]
    v_pk_mul_f32 v[52:53], v[36:37], v[92:93] op_sel_hi:[1,0]
    v_pk_mul_f32 v[54:55], v[38:39], v[92:93] op_sel_hi:[1,0]
    v_exp_f32 v48, v48
    v_exp_f32 v49, v49
    v_exp_f32 v50, v50
    v_exp_f32 v51, v51
    v_exp_f32 v52, v52
    v_exp_f32 v53, v53
    v_exp_f32 v54, v54
    v_exp_f32 v55, v55
    v_pk_mul_f32 v[32:33], v[32:33], v[40:41]
    v_pk_mul_f32 v[34:35], v[34:35], v[42:43]
    v_pk_mul_f32 v[36:37], v[36:37], v[44:45]
    v_pk_mul_f32 v[38:39], v[38:39], v[46:47]
    v_pk_add_f32 v[48:49], v[48:49], 1.0 op_sel_hi:[1,0]
    v_pk_add_f32 v[50:51], v[50:51], 1.0 op_sel_hi:[1,0]
    v_pk_add_f32 v[52:53], v[52:53], 1.0 op_sel_hi:[1,0]
    v_pk_add_f32 v[54:55], v[54:55], 1.0 op_sel_hi:[1,0]
    v_rcp_f32 v48, v48
    v_rcp_f32 v49, v49
    v_rcp_f32 v50, v50
    v_rcp_f32 v51, v51
    v_rcp_f32 v52, v52
    v_rcp_f32 v53, v53
    v_rcp_f32 v54, v54
    v_rcp_f32 v55, v55
    v_pk_mul_f32 v[32:33], v[32:33], v[92:93] op_sel:[0,1] op_sel_hi:[1,1]
    v_pk_mul_f32 v[34:35], v[34:35], v[92:93] op_sel:[0,1] op_sel_hi:[1,1]
    v_pk_mul_f32 v[36:37], v[36:37], v[92:93] op_sel:[0,1] op_sel_hi:[1,1]
    v_pk_mul_f32 v[38:39], v[38:39], v[92:93] op_sel:[0,1] op_sel_hi:[1,1]
    v_pk_mul_f32 v[32:33], v[32:33], v[48:49]
    v_pk_mul_f32 v[34:35], v[34:35], v[50:51]
    v_pk_mul_f32 v[36:37], v[36:37], v[52:53]
    v_pk_mul_f32 v[38:39], v[38:39], v[54:55]
    v_cvt_pk_bf16_f32 v56, v32, v33
    v_cvt_pk_bf16_f32 v57, v34, v35
    v_cvt_pk_bf16_f32 v58, v36, v37
    v_cvt_pk_bf16_f32 v59, v38, v39
    buffer_store_dwordx4 v[56:59], v72, s[20:23], s33 offen offset:0 sc1
    v_mul_f32 v92, s35, v23
    v_mul_f32 v93, v23, v23
    v_pk_fma_f32 v[32:33], v[76:77], v[22:23], v[100:101] op_sel_hi:[1,0,1] neg_lo:[0,1,0] neg_hi:[0,1,0]
    v_pk_fma_f32 v[40:41], v[84:85], v[22:23], v[164:165] op_sel_hi:[1,0,1] neg_lo:[0,1,0] neg_hi:[0,1,0]
    v_pk_fma_f32 v[34:35], v[78:79], v[22:23], v[102:103] op_sel_hi:[1,0,1] neg_lo:[0,1,0] neg_hi:[0,1,0]
    v_pk_fma_f32 v[42:43], v[86:87], v[22:23], v[166:167] op_sel_hi:[1,0,1] neg_lo:[0,1,0] neg_hi:[0,1,0]
    v_pk_fma_f32 v[36:37], v[80:81], v[22:23], v[132:133] op_sel_hi:[1,0,1] neg_lo:[0,1,0] neg_hi:[0,1,0]
    v_pk_fma_f32 v[44:45], v[88:89], v[22:23], v[196:197] op_sel_hi:[1,0,1] neg_lo:[0,1,0] neg_hi:[0,1,0]
    v_pk_fma_f32 v[38:39], v[82:83], v[22:23], v[134:135] op_sel_hi:[1,0,1] neg_lo:[0,1,0] neg_hi:[0,1,0]
    v_pk_fma_f32 v[46:47], v[90:91], v[22:23], v[198:199] op_sel_hi:[1,0,1] neg_lo:[0,1,0] neg_hi:[0,1,0]
    v_pk_mul_f32 v[48:49], v[32:33], v[92:93] op_sel_hi:[1,0]
    v_pk_mul_f32 v[50:51], v[34:35], v[92:93] op_sel_hi:[1,0]
    v_pk_mul_f32 v[52:53], v[36:37], v[92:93] op_sel_hi:[1,0]
    v_pk_mul_f32 v[54:55], v[38:39], v[92:93] op_sel_hi:[1,0]
    v_exp_f32 v48, v48
    v_exp_f32 v49, v49
    v_exp_f32 v50, v50
    v_exp_f32 v51, v51
    v_exp_f32 v52, v52
    v_exp_f32 v53, v53
    v_exp_f32 v54, v54
    v_exp_f32 v55, v55
    v_pk_mul_f32 v[32:33], v[32:33], v[40:41]
    v_pk_mul_f32 v[34:35], v[34:35], v[42:43]
    v_pk_mul_f32 v[36:37], v[36:37], v[44:45]
    v_pk_mul_f32 v[38:39], v[38:39], v[46:47]
    v_pk_add_f32 v[48:49], v[48:49], 1.0 op_sel_hi:[1,0]
    v_pk_add_f32 v[50:51], v[50:51], 1.0 op_sel_hi:[1,0]
    v_pk_add_f32 v[52:53], v[52:53], 1.0 op_sel_hi:[1,0]
    v_pk_add_f32 v[54:55], v[54:55], 1.0 op_sel_hi:[1,0]
    v_rcp_f32 v48, v48
    v_rcp_f32 v49, v49
    v_rcp_f32 v50, v50
    v_rcp_f32 v51, v51
    v_rcp_f32 v52, v52
    v_rcp_f32 v53, v53
    v_rcp_f32 v54, v54
    v_rcp_f32 v55, v55
    v_pk_mul_f32 v[32:33], v[32:33], v[92:93] op_sel:[0,1] op_sel_hi:[1,1]
    v_pk_mul_f32 v[34:35], v[34:35], v[92:93] op_sel:[0,1] op_sel_hi:[1,1]
    v_pk_mul_f32 v[36:37], v[36:37], v[92:93] op_sel:[0,1] op_sel_hi:[1,1]
    v_pk_mul_f32 v[38:39], v[38:39], v[92:93] op_sel:[0,1] op_sel_hi:[1,1]
    v_pk_mul_f32 v[32:33], v[32:33], v[48:49]
    v_pk_mul_f32 v[34:35], v[34:35], v[50:51]
    v_pk_mul_f32 v[36:37], v[36:37], v[52:53]
    v_pk_mul_f32 v[38:39], v[38:39], v[54:55]
    v_cvt_pk_bf16_f32 v60, v32, v33
    v_cvt_pk_bf16_f32 v61, v34, v35
    v_cvt_pk_bf16_f32 v62, v36, v37
    v_cvt_pk_bf16_f32 v63, v38, v39
    buffer_store_dwordx4 v[60:63], v72, s[20:23], s33 offen offset:1024 sc1
    v_mul_f32 v92, s35, v25
    v_mul_f32 v93, v25, v25
    v_pk_fma_f32 v[32:33], v[76:77], v[24:25], v[104:105] op_sel_hi:[1,0,1] neg_lo:[0,1,0] neg_hi:[0,1,0]
    v_pk_fma_f32 v[40:41], v[84:85], v[24:25], v[168:169] op_sel_hi:[1,0,1] neg_lo:[0,1,0] neg_hi:[0,1,0]
    v_pk_fma_f32 v[34:35], v[78:79], v[24:25], v[106:107] op_sel_hi:[1,0,1] neg_lo:[0,1,0] neg_hi:[0,1,0]
    v_pk_fma_f32 v[42:43], v[86:87], v[24:25], v[170:171] op_sel_hi:[1,0,1] neg_lo:[0,1,0] neg_hi:[0,1,0]
    v_pk_fma_f32 v[36:37], v[80:81], v[24:25], v[136:137] op_sel_hi:[1,0,1] neg_lo:[0,1,0] neg_hi:[0,1,0]
    v_pk_fma_f32 v[44:45], v[88:89], v[24:25], v[200:201] op_sel_hi:[1,0,1] neg_lo:[0,1,0] neg_hi:[0,1,0]
    v_pk_fma_f32 v[38:39], v[82:83], v[24:25], v[138:139] op_sel_hi:[1,0,1] neg_lo:[0,1,0] neg_hi:[0,1,0]
    v_pk_fma_f32 v[46:47], v[90:91], v[24:25], v[202:203] op_sel_hi:[1,0,1] neg_lo:[0,1,0] neg_hi:[0,1,0]
    v_pk_mul_f32 v[48:49], v[32:33], v[92:93] op_sel_hi:[1,0]
    v_pk_mul_f32 v[50:51], v[34:35], v[92:93] op_sel_hi:[1,0]
    v_pk_mul_f32 v[52:53], v[36:37], v[92:93] op_sel_hi:[1,0]
    v_pk_mul_f32 v[54:55], v[38:39], v[92:93] op_sel_hi:[1,0]
    v_exp_f32 v48, v48
    v_exp_f32 v49, v49
    v_exp_f32 v50, v50
    v_exp_f32 v51, v51
    v_exp_f32 v52, v52
    v_exp_f32 v53, v53
    v_exp_f32 v54, v54
    v_exp_f32 v55, v55
    v_pk_mul_f32 v[32:33], v[32:33], v[40:41]
    v_pk_mul_f32 v[34:35], v[34:35], v[42:43]
    v_pk_mul_f32 v[36:37], v[36:37], v[44:45]
    v_pk_mul_f32 v[38:39], v[38:39], v[46:47]
    v_pk_add_f32 v[48:49], v[48:49], 1.0 op_sel_hi:[1,0]
    v_pk_add_f32 v[50:51], v[50:51], 1.0 op_sel_hi:[1,0]
    v_pk_add_f32 v[52:53], v[52:53], 1.0 op_sel_hi:[1,0]
    v_pk_add_f32 v[54:55], v[54:55], 1.0 op_sel_hi:[1,0]
    v_rcp_f32 v48, v48
    v_rcp_f32 v49, v49
    v_rcp_f32 v50, v50
    v_rcp_f32 v51, v51
    v_rcp_f32 v52, v52
    v_rcp_f32 v53, v53
    v_rcp_f32 v54, v54
    v_rcp_f32 v55, v55
    v_pk_mul_f32 v[32:33], v[32:33], v[92:93] op_sel:[0,1] op_sel_hi:[1,1]
    v_pk_mul_f32 v[34:35], v[34:35], v[92:93] op_sel:[0,1] op_sel_hi:[1,1]
    v_pk_mul_f32 v[36:37], v[36:37], v[92:93] op_sel:[0,1] op_sel_hi:[1,1]
    v_pk_mul_f32 v[38:39], v[38:39], v[92:93] op_sel:[0,1] op_sel_hi:[1,1]
    v_pk_mul_f32 v[32:33], v[32:33], v[48:49]
    v_pk_mul_f32 v[34:35], v[34:35], v[50:51]
    v_pk_mul_f32 v[36:37], v[36:37], v[52:53]
    v_pk_mul_f32 v[38:39], v[38:39], v[54:55]
    v_cvt_pk_bf16_f32 v56, v32, v33
    v_cvt_pk_bf16_f32 v57, v34, v35
    v_cvt_pk_bf16_f32 v58, v36, v37
    v_cvt_pk_bf16_f32 v59, v38, v39
    buffer_store_dwordx4 v[56:59], v72, s[20:23], s33 offen offset:2048 sc1
    v_mul_f32 v92, s35, v27
    v_mul_f32 v93, v27, v27
    v_pk_fma_f32 v[32:33], v[76:77], v[26:27], v[108:109] op_sel_hi:[1,0,1] neg_lo:[0,1,0] neg_hi:[0,1,0]
    v_pk_fma_f32 v[40:41], v[84:85], v[26:27], v[172:173] op_sel_hi:[1,0,1] neg_lo:[0,1,0] neg_hi:[0,1,0]
    v_pk_fma_f32 v[34:35], v[78:79], v[26:27], v[110:111] op_sel_hi:[1,0,1] neg_lo:[0,1,0] neg_hi:[0,1,0]
    v_pk_fma_f32 v[42:43], v[86:87], v[26:27], v[174:175] op_sel_hi:[1,0,1] neg_lo:[0,1,0] neg_hi:[0,1,0]
    v_pk_fma_f32 v[36:37], v[80:81], v[26:27], v[140:141] op_sel_hi:[1,0,1] neg_lo:[0,1,0] neg_hi:[0,1,0]
    v_pk_fma_f32 v[44:45], v[88:89], v[26:27], v[204:205] op_sel_hi:[1,0,1] neg_lo:[0,1,0] neg_hi:[0,1,0]
    v_pk_fma_f32 v[38:39], v[82:83], v[26:27], v[142:143] op_sel_hi:[1,0,1] neg_lo:[0,1,0] neg_hi:[0,1,0]
    v_pk_fma_f32 v[46:47], v[90:91], v[26:27], v[206:207] op_sel_hi:[1,0,1] neg_lo:[0,1,0] neg_hi:[0,1,0]
    v_pk_mul_f32 v[48:49], v[32:33], v[92:93] op_sel_hi:[1,0]
    v_pk_mul_f32 v[50:51], v[34:35], v[92:93] op_sel_hi:[1,0]
    v_pk_mul_f32 v[52:53], v[36:37], v[92:93] op_sel_hi:[1,0]
    v_pk_mul_f32 v[54:55], v[38:39], v[92:93] op_sel_hi:[1,0]
    v_exp_f32 v48, v48
    v_exp_f32 v49, v49
    v_exp_f32 v50, v50
    v_exp_f32 v51, v51
    v_exp_f32 v52, v52
    v_exp_f32 v53, v53
    v_exp_f32 v54, v54
    v_exp_f32 v55, v55
    v_pk_mul_f32 v[32:33], v[32:33], v[40:41]
    v_pk_mul_f32 v[34:35], v[34:35], v[42:43]
    v_pk_mul_f32 v[36:37], v[36:37], v[44:45]
    v_pk_mul_f32 v[38:39], v[38:39], v[46:47]
    v_pk_add_f32 v[48:49], v[48:49], 1.0 op_sel_hi:[1,0]
    v_pk_add_f32 v[50:51], v[50:51], 1.0 op_sel_hi:[1,0]
    v_pk_add_f32 v[52:53], v[52:53], 1.0 op_sel_hi:[1,0]
    v_pk_add_f32 v[54:55], v[54:55], 1.0 op_sel_hi:[1,0]
    v_rcp_f32 v48, v48
    v_rcp_f32 v49, v49
    v_rcp_f32 v50, v50
    v_rcp_f32 v51, v51
    v_rcp_f32 v52, v52
    v_rcp_f32 v53, v53
    v_rcp_f32 v54, v54
    v_rcp_f32 v55, v55
    v_pk_mul_f32 v[32:33], v[32:33], v[92:93] op_sel:[0,1] op_sel_hi:[1,1]
    v_pk_mul_f32 v[34:35], v[34:35], v[92:93] op_sel:[0,1] op_sel_hi:[1,1]
    v_pk_mul_f32 v[36:37], v[36:37], v[92:93] op_sel:[0,1] op_sel_hi:[1,1]
    v_pk_mul_f32 v[38:39], v[38:39], v[92:93] op_sel:[0,1] op_sel_hi:[1,1]
    v_pk_mul_f32 v[32:33], v[32:33], v[48:49]
    v_pk_mul_f32 v[34:35], v[34:35], v[50:51]
    v_pk_mul_f32 v[36:37], v[36:37], v[52:53]
    v_pk_mul_f32 v[38:39], v[38:39], v[54:55]
    v_cvt_pk_bf16_f32 v60, v32, v33
    v_cvt_pk_bf16_f32 v61, v34, v35
    v_cvt_pk_bf16_f32 v62, v36, v37
    v_cvt_pk_bf16_f32 v63, v38, v39
    buffer_store_dwordx4 v[60:63], v72, s[20:23], s33 offen offset:3072 sc1
    v_mul_f32 v92, s35, v65
    v_mul_f32 v93, v65, v65
    v_pk_fma_f32 v[32:33], v[76:77], v[64:65], v[112:113] op_sel_hi:[1,0,1] neg_lo:[0,1,0] neg_hi:[0,1,0]
    v_pk_fma_f32 v[40:41], v[84:85], v[64:65], v[176:177] op_sel_hi:[1,0,1] neg_lo:[0,1,0] neg_hi:[0,1,0]
    v_pk_fma_f32 v[34:35], v[78:79], v[64:65], v[114:115] op_sel_hi:[1,0,1] neg_lo:[0,1,0] neg_hi:[0,1,0]
    v_pk_fma_f32 v[42:43], v[86:87], v[64:65], v[178:179] op_sel_hi:[1,0,1] neg_lo:[0,1,0] neg_hi:[0,1,0]
    v_pk_fma_f32 v[36:37], v[80:81], v[64:65], v[144:145] op_sel_hi:[1,0,1] neg_lo:[0,1,0] neg_hi:[0,1,0]
    v_pk_fma_f32 v[44:45], v[88:89], v[64:65], v[208:209] op_sel_hi:[1,0,1] neg_lo:[0,1,0] neg_hi:[0,1,0]
    v_pk_fma_f32 v[38:39], v[82:83], v[64:65], v[146:147] op_sel_hi:[1,0,1] neg_lo:[0,1,0] neg_hi:[0,1,0]
    v_pk_fma_f32 v[46:47], v[90:91], v[64:65], v[210:211] op_sel_hi:[1,0,1] neg_lo:[0,1,0] neg_hi:[0,1,0]
    v_pk_mul_f32 v[48:49], v[32:33], v[92:93] op_sel_hi:[1,0]
    v_pk_mul_f32 v[50:51], v[34:35], v[92:93] op_sel_hi:[1,0]
    v_pk_mul_f32 v[52:53], v[36:37], v[92:93] op_sel_hi:[1,0]
    v_pk_mul_f32 v[54:55], v[38:39], v[92:93] op_sel_hi:[1,0]
    v_exp_f32 v48, v48
    v_exp_f32 v49, v49
    v_exp_f32 v50, v50
    v_exp_f32 v51, v51
    v_exp_f32 v52, v52
    v_exp_f32 v53, v53
    v_exp_f32 v54, v54
    v_exp_f32 v55, v55
    v_pk_mul_f32 v[32:33], v[32:33], v[40:41]
    v_pk_mul_f32 v[34:35], v[34:35], v[42:43]
    v_pk_mul_f32 v[36:37], v[36:37], v[44:45]
    v_pk_mul_f32 v[38:39], v[38:39], v[46:47]
    v_pk_add_f32 v[48:49], v[48:49], 1.0 op_sel_hi:[1,0]
    v_pk_add_f32 v[50:51], v[50:51], 1.0 op_sel_hi:[1,0]
    v_pk_add_f32 v[52:53], v[52:53], 1.0 op_sel_hi:[1,0]
    v_pk_add_f32 v[54:55], v[54:55], 1.0 op_sel_hi:[1,0]
    v_rcp_f32 v48, v48
    v_rcp_f32 v49, v49
    v_rcp_f32 v50, v50
    v_rcp_f32 v51, v51
    v_rcp_f32 v52, v52
    v_rcp_f32 v53, v53
    v_rcp_f32 v54, v54
    v_rcp_f32 v55, v55
    v_pk_mul_f32 v[32:33], v[32:33], v[92:93] op_sel:[0,1] op_sel_hi:[1,1]
    v_pk_mul_f32 v[34:35], v[34:35], v[92:93] op_sel:[0,1] op_sel_hi:[1,1]
    v_pk_mul_f32 v[36:37], v[36:37], v[92:93] op_sel:[0,1] op_sel_hi:[1,1]
    v_pk_mul_f32 v[38:39], v[38:39], v[92:93] op_sel:[0,1] op_sel_hi:[1,1]
    v_pk_mul_f32 v[32:33], v[32:33], v[48:49]
    v_pk_mul_f32 v[34:35], v[34:35], v[50:51]
    v_pk_mul_f32 v[36:37], v[36:37], v[52:53]
    v_pk_mul_f32 v[38:39], v[38:39], v[54:55]
    v_cvt_pk_bf16_f32 v56, v32, v33
    v_cvt_pk_bf16_f32 v57, v34, v35
    v_cvt_pk_bf16_f32 v58, v36, v37
    v_cvt_pk_bf16_f32 v59, v38, v39
    s_add_u32 s33, s33, 4096
    buffer_store_dwordx4 v[56:59], v72, s[20:23], s33 offen offset:0 sc1
    v_mul_f32 v92, s35, v67
    v_mul_f32 v93, v67, v67
    v_pk_fma_f32 v[32:33], v[76:77], v[66:67], v[116:117] op_sel_hi:[1,0,1] neg_lo:[0,1,0] neg_hi:[0,1,0]
    v_pk_fma_f32 v[40:41], v[84:85], v[66:67], v[180:181] op_sel_hi:[1,0,1] neg_lo:[0,1,0] neg_hi:[0,1,0]
    v_pk_fma_f32 v[34:35], v[78:79], v[66:67], v[118:119] op_sel_hi:[1,0,1] neg_lo:[0,1,0] neg_hi:[0,1,0]
    v_pk_fma_f32 v[42:43], v[86:87], v[66:67], v[182:183] op_sel_hi:[1,0,1] neg_lo:[0,1,0] neg_hi:[0,1,0]
    v_pk_fma_f32 v[36:37], v[80:81], v[66:67], v[148:149] op_sel_hi:[1,0,1] neg_lo:[0,1,0] neg_hi:[0,1,0]
    v_pk_fma_f32 v[44:45], v[88:89], v[66:67], v[212:213] op_sel_hi:[1,0,1] neg_lo:[0,1,0] neg_hi:[0,1,0]
    v_pk_fma_f32 v[38:39], v[82:83], v[66:67], v[150:151] op_sel_hi:[1,0,1] neg_lo:[0,1,0] neg_hi:[0,1,0]
    v_pk_fma_f32 v[46:47], v[90:91], v[66:67], v[214:215] op_sel_hi:[1,0,1] neg_lo:[0,1,0] neg_hi:[0,1,0]
    v_pk_mul_f32 v[48:49], v[32:33], v[92:93] op_sel_hi:[1,0]
    v_pk_mul_f32 v[50:51], v[34:35], v[92:93] op_sel_hi:[1,0]
    v_pk_mul_f32 v[52:53], v[36:37], v[92:93] op_sel_hi:[1,0]
    v_pk_mul_f32 v[54:55], v[38:39], v[92:93] op_sel_hi:[1,0]
    v_exp_f32 v48, v48
    v_exp_f32 v49, v49
    v_exp_f32 v50, v50
    v_exp_f32 v51, v51
    v_exp_f32 v52, v52
    v_exp_f32 v53, v53
    v_exp_f32 v54, v54
    v_exp_f32 v55, v55
    v_pk_mul_f32 v[32:33], v[32:33], v[40:41]
    v_pk_mul_f32 v[34:35], v[34:35], v[42:43]
    v_pk_mul_f32 v[36:37], v[36:37], v[44:45]
    v_pk_mul_f32 v[38:39], v[38:39], v[46:47]
    v_pk_add_f32 v[48:49], v[48:49], 1.0 op_sel_hi:[1,0]
    v_pk_add_f32 v[50:51], v[50:51], 1.0 op_sel_hi:[1,0]
    v_pk_add_f32 v[52:53], v[52:53], 1.0 op_sel_hi:[1,0]
    v_pk_add_f32 v[54:55], v[54:55], 1.0 op_sel_hi:[1,0]
    v_rcp_f32 v48, v48
    v_rcp_f32 v49, v49
    v_rcp_f32 v50, v50
    v_rcp_f32 v51, v51
    v_rcp_f32 v52, v52
    v_rcp_f32 v53, v53
    v_rcp_f32 v54, v54
    v_rcp_f32 v55, v55
    v_pk_mul_f32 v[32:33], v[32:33], v[92:93] op_sel:[0,1] op_sel_hi:[1,1]
    v_pk_mul_f32 v[34:35], v[34:35], v[92:93] op_sel:[0,1] op_sel_hi:[1,1]
    v_pk_mul_f32 v[36:37], v[36:37], v[92:93] op_sel:[0,1] op_sel_hi:[1,1]
    v_pk_mul_f32 v[38:39], v[38:39], v[92:93] op_sel:[0,1] op_sel_hi:[1,1]
    v_pk_mul_f32 v[32:33], v[32:33], v[48:49]
    v_pk_mul_f32 v[34:35], v[34:35], v[50:51]
    v_pk_mul_f32 v[36:37], v[36:37], v[52:53]
    v_pk_mul_f32 v[38:39], v[38:39], v[54:55]
    v_cvt_pk_bf16_f32 v60, v32, v33
    v_cvt_pk_bf16_f32 v61, v34, v35
    v_cvt_pk_bf16_f32 v62, v36, v37
    v_cvt_pk_bf16_f32 v63, v38, v39
    buffer_store_dwordx4 v[60:63], v72, s[20:23], s33 offen offset:1024 sc1
    v_mul_f32 v92, s35, v69
    v_mul_f32 v93, v69, v69
    v_pk_fma_f32 v[32:33], v[76:77], v[68:69], v[120:121] op_sel_hi:[1,0,1] neg_lo:[0,1,0] neg_hi:[0,1,0]
    v_pk_fma_f32 v[40:41], v[84:85], v[68:69], v[184:185] op_sel_hi:[1,0,1] neg_lo:[0,1,0] neg_hi:[0,1,0]
    v_pk_fma_f32 v[34:35], v[78:79], v[68:69], v[122:123] op_sel_hi:[1,0,1] neg_lo:[0,1,0] neg_hi:[0,1,0]
    v_pk_fma_f32 v[42:43], v[86:87], v[68:69], v[186:187] op_sel_hi:[1,0,1] neg_lo:[0,1,0] neg_hi:[0,1,0]
    v_pk_fma_f32 v[36:37], v[80:81], v[68:69], v[152:153] op_sel_hi:[1,0,1] neg_lo:[0,1,0] neg_hi:[0,1,0]
    v_pk_fma_f32 v[44:45], v[88:89], v[68:69], v[216:217] op_sel_hi:[1,0,1] neg_lo:[0,1,0] neg_hi:[0,1,0]
    v_pk_fma_f32 v[38:39], v[82:83], v[68:69], v[154:155] op_sel_hi:[1,0,1] neg_lo:[0,1,0] neg_hi:[0,1,0]
    v_pk_fma_f32 v[46:47], v[90:91], v[68:69], v[218:219] op_sel_hi:[1,0,1] neg_lo:[0,1,0] neg_hi:[0,1,0]
    v_pk_mul_f32 v[48:49], v[32:33], v[92:93] op_sel_hi:[1,0]
    v_pk_mul_f32 v[50:51], v[34:35], v[92:93] op_sel_hi:[1,0]
    v_pk_mul_f32 v[52:53], v[36:37], v[92:93] op_sel_hi:[1,0]
    v_pk_mul_f32 v[54:55], v[38:39], v[92:93] op_sel_hi:[1,0]
    v_exp_f32 v48, v48
    v_exp_f32 v49, v49
    v_exp_f32 v50, v50
    v_exp_f32 v51, v51
    v_exp_f32 v52, v52
    v_exp_f32 v53, v53
    v_exp_f32 v54, v54
    v_exp_f32 v55, v55
    v_pk_mul_f32 v[32:33], v[32:33], v[40:41]
    v_pk_mul_f32 v[34:35], v[34:35], v[42:43]
    v_pk_mul_f32 v[36:37], v[36:37], v[44:45]
    v_pk_mul_f32 v[38:39], v[38:39], v[46:47]
    v_pk_add_f32 v[48:49], v[48:49], 1.0 op_sel_hi:[1,0]
    v_pk_add_f32 v[50:51], v[50:51], 1.0 op_sel_hi:[1,0]
    v_pk_add_f32 v[52:53], v[52:53], 1.0 op_sel_hi:[1,0]
    v_pk_add_f32 v[54:55], v[54:55], 1.0 op_sel_hi:[1,0]
    v_rcp_f32 v48, v48
    v_rcp_f32 v49, v49
    v_rcp_f32 v50, v50
    v_rcp_f32 v51, v51
    v_rcp_f32 v52, v52
    v_rcp_f32 v53, v53
    v_rcp_f32 v54, v54
    v_rcp_f32 v55, v55
    v_pk_mul_f32 v[32:33], v[32:33], v[92:93] op_sel:[0,1] op_sel_hi:[1,1]
    v_pk_mul_f32 v[34:35], v[34:35], v[92:93] op_sel:[0,1] op_sel_hi:[1,1]
    v_pk_mul_f32 v[36:37], v[36:37], v[92:93] op_sel:[0,1] op_sel_hi:[1,1]
    v_pk_mul_f32 v[38:39], v[38:39], v[92:93] op_sel:[0,1] op_sel_hi:[1,1]
    v_pk_mul_f32 v[32:33], v[32:33], v[48:49]
    v_pk_mul_f32 v[34:35], v[34:35], v[50:51]
    v_pk_mul_f32 v[36:37], v[36:37], v[52:53]
    v_pk_mul_f32 v[38:39], v[38:39], v[54:55]
    v_cvt_pk_bf16_f32 v56, v32, v33
    v_cvt_pk_bf16_f32 v57, v34, v35
    v_cvt_pk_bf16_f32 v58, v36, v37
    v_cvt_pk_bf16_f32 v59, v38, v39
    buffer_store_dwordx4 v[56:59], v72, s[20:23], s33 offen offset:2048 sc1
    v_mul_f32 v92, s35, v71
    v_mul_f32 v93, v71, v71
    v_pk_fma_f32 v[32:33], v[76:77], v[70:71], v[124:125] op_sel_hi:[1,0,1] neg_lo:[0,1,0] neg_hi:[0,1,0]
    v_pk_fma_f32 v[40:41], v[84:85], v[70:71], v[188:189] op_sel_hi:[1,0,1] neg_lo:[0,1,0] neg_hi:[0,1,0]
    v_pk_fma_f32 v[34:35], v[78:79], v[70:71], v[126:127] op_sel_hi:[1,0,1] neg_lo:[0,1,0] neg_hi:[0,1,0]
    v_pk_fma_f32 v[42:43], v[86:87], v[70:71], v[190:191] op_sel_hi:[1,0,1] neg_lo:[0,1,0] neg_hi:[0,1,0]
    v_pk_fma_f32 v[36:37], v[80:81], v[70:71], v[156:157] op_sel_hi:[1,0,1] neg_lo:[0,1,0] neg_hi:[0,1,0]
    v_pk_fma_f32 v[44:45], v[88:89], v[70:71], v[220:221] op_sel_hi:[1,0,1] neg_lo:[0,1,0] neg_hi:[0,1,0]
    v_pk_fma_f32 v[38:39], v[82:83], v[70:71], v[158:159] op_sel_hi:[1,0,1] neg_lo:[0,1,0] neg_hi:[0,1,0]
    v_pk_fma_f32 v[46:47], v[90:91], v[70:71], v[222:223] op_sel_hi:[1,0,1] neg_lo:[0,1,0] neg_hi:[0,1,0]
    v_pk_mul_f32 v[48:49], v[32:33], v[92:93] op_sel_hi:[1,0]
    v_pk_mul_f32 v[50:51], v[34:35], v[92:93] op_sel_hi:[1,0]
    v_pk_mul_f32 v[52:53], v[36:37], v[92:93] op_sel_hi:[1,0]
    v_pk_mul_f32 v[54:55], v[38:39], v[92:93] op_sel_hi:[1,0]
    v_exp_f32 v48, v48
    v_exp_f32 v49, v49
    v_exp_f32 v50, v50
    v_exp_f32 v51, v51
    v_exp_f32 v52, v52
    v_exp_f32 v53, v53
    v_exp_f32 v54, v54
    v_exp_f32 v55, v55
    v_pk_mul_f32 v[32:33], v[32:33], v[40:41]
    v_pk_mul_f32 v[34:35], v[34:35], v[42:43]
    v_pk_mul_f32 v[36:37], v[36:37], v[44:45]
    v_pk_mul_f32 v[38:39], v[38:39], v[46:47]
    v_pk_add_f32 v[48:49], v[48:49], 1.0 op_sel_hi:[1,0]
    v_pk_add_f32 v[50:51], v[50:51], 1.0 op_sel_hi:[1,0]
    v_pk_add_f32 v[52:53], v[52:53], 1.0 op_sel_hi:[1,0]
    v_pk_add_f32 v[54:55], v[54:55], 1.0 op_sel_hi:[1,0]
    v_rcp_f32 v48, v48
    v_rcp_f32 v49, v49
    v_rcp_f32 v50, v50
    v_rcp_f32 v51, v51
    v_rcp_f32 v52, v52
    v_rcp_f32 v53, v53
    v_rcp_f32 v54, v54
    v_rcp_f32 v55, v55
    v_pk_mul_f32 v[32:33], v[32:33], v[92:93] op_sel:[0,1] op_sel_hi:[1,1]
    v_pk_mul_f32 v[34:35], v[34:35], v[92:93] op_sel:[0,1] op_sel_hi:[1,1]
    v_pk_mul_f32 v[36:37], v[36:37], v[92:93] op_sel:[0,1] op_sel_hi:[1,1]
    v_pk_mul_f32 v[38:39], v[38:39], v[92:93] op_sel:[0,1] op_sel_hi:[1,1]
    v_pk_mul_f32 v[32:33], v[32:33], v[48:49]
    v_pk_mul_f32 v[34:35], v[34:35], v[50:51]
    v_pk_mul_f32 v[36:37], v[36:37], v[52:53]
    v_pk_mul_f32 v[38:39], v[38:39], v[54:55]
    v_cvt_pk_bf16_f32 v60, v32, v33
    v_cvt_pk_bf16_f32 v61, v34, v35
    v_cvt_pk_bf16_f32 v62, v36, v37
    v_cvt_pk_bf16_f32 v63, v38, v39
    buffer_store_dwordx4 v[60:63], v72, s[20:23], s33 offen offset:3072 sc1
    s_waitcnt vmcnt(0)
    s_barrier
    s_cmp_lg_u32 s28, 0
    s_cbranch_scc1 L_g2_start
    s_add_u32 s20, s4, 0x2920000
    s_addc_u32 s21, s5, 0
    s_mov_b32 s22, 0x1000
    s_mov_b32 s23, 0x00020000
    s_cmp_ge_u32 s26, 14
    s_cselect_b32 s29, 1, 0
    s_lshl_b32 s35, s25, 1
    s_add_u32 s29, s29, s35
    s_lshl_b32 s29, s29, 7
    v_mov_b32 v2, 1
    v_mov_b32 v3, 0
    s_mov_b64 exec, 1
    buffer_atomic_add v2, v3, s[20:23], s29 offen sc1
    s_mov_b64 exec, -1
    s_branch L_g2_start
L_g1_fft:
    s_sub_u32 s3, s3, 28
    s_lshl_b32 s3, s3, 3
    s_add_u32 s3, s3, s24
    s_mov_b32 s60, s3
    s_mov_b32 s59, s24
    s_load_dwordx2 s[4:5], s[0:1], 0
    s_load_dwordx2 s[6:7], s[0:1], 88
    s_load_dwordx2 s[40:41], s[0:1], 80
    s_getpc_b64 s[42:43]
L_fft_pc:
    s_add_u32 s42, s42, fft_table-L_fft_pc
    s_addc_u32 s43, s43, 0
    v_lshrrev_b32 v1, 6, v0
    v_and_b32 v2, 63, v0
    v_lshlrev_b32 v3, 4, v2
    v_readfirstlane_b32 s28, v1
    v_lshl_add_u32 v22, v1, 19, v3
    s_waitcnt lgkmcnt(0)
    s_mov_b32 s8, s4
    s_mov_b32 s9, s5
    s_mov_b32 s10, 0x400000
    s_mov_b32 s11, 0x00020000
    s_mov_b32 s20, s40
    s_mov_b32 s21, s41
    s_mov_b32 s22, 0x100
    s_mov_b32 s23, 0x00020000
    s_add_u32 s12, s6, 0x2900000
    s_addc_u32 s13, s7, 0
    s_mov_b32 s14, 0x20000
    s_mov_b32 s15, 0x00020000
    v_lshlrev_b32 v120, 3, v0
    v_mov_b32 v124, 0
    v_mov_b32 v125, 0
    s_lshl_b32 s29, s60, 12
    buffer_store_dwordx2 v[124:125], v120, s[12:15], s29 offen sc1
    s_add_u32 s12, s6, 0x2920000
    s_addc_u32 s13, s7, 0
    s_mov_b32 s14, 0x2000
    s_mov_b32 s15, 0x00020000
    s_lshl_b32 s29, s60, 8
    s_mov_b32 exec_hi, 0
    buffer_store_dwordx2 v[124:125], v120, s[12:15], s29 offen sc1
    s_mov_b64 exec, -1
    s_mov_b32 s61, s60
    s_lshl_b32 s29, s61, 11
    s_add_u32 s29, s29, 0
    buffer_load_dwordx4 v[128:131], v22, s[8:11], s29 offen
    buffer_load_dwordx4 v[132:135], v22, s[8:11], s29 offen offset:1024
    s_lshl_b32 s29, s61, 11
    s_add_u32 s29, s29, 131072
    buffer_load_dwordx4 v[136:139], v22, s[8:11], s29 offen
    buffer_load_dwordx4 v[140:143], v22, s[8:11], s29 offen offset:1024
    s_lshl_b32 s29, s61, 11
    s_add_u32 s29, s29, 262144
    buffer_load_dwordx4 v[144:147], v22, s[8:11], s29 offen
    buffer_load_dwordx4 v[148:151], v22, s[8:11], s29 offen offset:1024
    s_lshl_b32 s29, s61, 11
    s_add_u32 s29, s29, 393216
    buffer_load_dwordx4 v[152:155], v22, s[8:11], s29 offen
    buffer_load_dwordx4 v[156:159], v22, s[8:11], s29 offen offset:1024
    s_lshl_b32 s50, s28, 10
L_tab_recurr_20:
    s_add_u32 m0, s50, 136192
    s_add_u32 s88, s42, s50
    s_addc_u32 s89, s43, 0
    s_add_u32 s88, s88, 0
    s_addc_u32 s89, s89, 0
    global_load_lds_dwordx4 v3, s[88:89]
    s_add_u32 s50, s50, 8192
    s_cmp_lt_u32 s50, 22528
    s_cbranch_scc1 L_tab_recurr_20
    s_add_u32 s62, s60, 32
    s_add_u32 s12, s6, 0x1a00000
    s_addc_u32 s13, s7, 0
    s_mov_b32 s14, 0x400000
    s_mov_b32 s15, 0x00020000
    s_add_u32 s44, s6, 0x1e00000
    s_addc_u32 s45, s7, 0
    s_mov_b32 s46, 0x20000
    s_mov_b32 s47, 0x00020000
    s_add_u32 s16, s6, 0x1400000
    s_addc_u32 s17, s7, 0
    s_mov_b32 s18, 0x440000
    s_mov_b32 s19, 0x00020000
    s_add_u32 s32, s6, 0x1f00000
    s_addc_u32 s33, s7, 0
    s_mov_b32 s34, 0x4000
    s_mov_b32 s35, 0x00020000
    s_mov_b32 s70, 0x3f803f80
    s_mov_b32 s71, 0xbf803f80
    v_lshrrev_b32 v120, 1, v0
    s_movk_i32 s29, 1056
    v_mul_lo_u32 v120, v120, s29
    v_and_b32 v121, 1, v0
    v_lshl_add_u32 v120, v121, 4, v120
    v_add_u32 v120, 1024, v120
    v_mov_b32 v124, 0
    v_mov_b32 v125, 0
    v_mov_b32 v126, 0
    v_mov_b32 v127, 0
    v_cmp_gt_u32 vcc, 128, v0
    s_and_saveexec_b64 s[66:67], vcc
    ds_write_b128 v120, v[124:127]
    s_mov_b64 exec, s[66:67]
    v_lshl_add_u32 v16, v1, 13, v3
    v_add_u32 v16, 67584, v16
    v_lshrrev_b32 v120, 5, v2
    v_bfe_u32 v121, v2, 2, 2
    v_lshl_add_u32 v120, v120, 3, v121
    v_lshlrev_b32 v120, 6, v120
    v_bfe_u32 v121, v2, 4, 1
    v_lshl_add_u32 v120, v121, 5, v120
    v_and_b32 v121, 3, v2
    v_lshl_add_u32 v120, v121, 3, v120
    v_lshl_add_u32 v17, v1, 13, v120
    v_add_u32 v17, 67584, v17
    v_and_b32 v120, 15, v2
    v_bfe_u32 v121, v2, 4, 1
    s_mov_b32 s29, 33792
    v_mul_lo_u32 v121, v121, s29
    s_movk_i32 s29, 4224
    v_mul_lo_u32 v122, v1, s29
    v_add_u32 v121, v121, v122
    v_lshl_add_u32 v121, v120, 6, v121
    v_and_b32 v120, 7, v120
    v_lshrrev_b32 v122, 5, v2
    v_add_u32 v124, 0, v122
    v_xor_b32 v124, v124, v120
    v_lshl_add_u32 v18, v124, 3, v121
    v_add_u32 v124, 2, v122
    v_xor_b32 v124, v124, v120
    v_lshl_add_u32 v19, v124, 3, v121
    v_add_u32 v124, 4, v122
    v_xor_b32 v124, v124, v120
    v_lshl_add_u32 v20, v124, 3, v121
    v_add_u32 v124, 6, v122
    v_xor_b32 v124, v124, v120
    v_lshl_add_u32 v21, v124, 3, v121
    v_bfe_u32 v120, v2, 2, 4
    s_movk_i32 s29, 1056
    v_mul_lo_u32 v23, v120, s29
    v_and_b32 v24, 3, v2
    v_and_b32 v120, 15, v2
    s_movk_i32 s29, 1072
    v_mul_lo_u32 v25, v120, s29
    v_lshrrev_b32 v120, 4, v2
    v_lshl_add_u32 v25, v120, 3, v25
    v_add_u32 v25, 67584, v25
    v_lshrrev_b32 v120, 4, v2
    v_lshrrev_b32 v121, 1, v120
    v_and_b32 v120, 1, v120
    v_lshl_add_u32 v120, v120, 1, v121
    v_lshl_add_u32 v120, v1, 2, v120
    s_movk_i32 s29, 1056
    v_mul_lo_u32 v30, v120, s29
    v_add_u32 v30, 1024, v30
    v_lshlrev_b32 v31, 9, v120
    s_waitcnt vmcnt(0) lgkmcnt(0)
    s_barrier
    s_lshl_b32 s29, s62, 11
    s_add_u32 s29, s29, 0
    buffer_load_dwordx4 v[64:67], v22, s[8:11], s29 offen
    buffer_load_dwordx4 v[68:71], v22, s[8:11], s29 offen offset:1024
    s_lshl_b32 s29, s62, 11
    s_add_u32 s29, s29, 131072
    buffer_load_dwordx4 v[72:75], v22, s[8:11], s29 offen
    buffer_load_dwordx4 v[76:79], v22, s[8:11], s29 offen offset:1024
    s_lshl_b32 s29, s62, 11
    s_add_u32 s29, s29, 262144
    buffer_load_dwordx4 v[80:83], v22, s[8:11], s29 offen
    buffer_load_dwordx4 v[84:87], v22, s[8:11], s29 offen offset:1024
    s_lshl_b32 s29, s62, 11
    s_add_u32 s29, s29, 393216
    buffer_load_dwordx4 v[88:91], v22, s[8:11], s29 offen
    buffer_load_dwordx4 v[92:95], v22, s[8:11], s29 offen offset:1024
    v_add_u32 v120, 136192, v3
    ds_read_b128 a[0:3], v120 offset:0
    ds_read_b128 a[4:7], v120 offset:1024
    ds_read_b128 a[8:11], v120 offset:2048
    ds_read_b128 a[12:15], v120 offset:3072
    ds_read_b128 a[16:19], v120 offset:4096
    ds_read_b128 a[20:23], v120 offset:5120
    ds_read_b128 a[24:27], v120 offset:6144
    ds_read_b128 a[28:31], v120 offset:7168
    ds_read_b128 v[160:163], v120 offset:8192
    ds_read_b128 v[164:167], v120 offset:9216
    ds_read_b128 v[168:171], v120 offset:10240
    ds_read_b128 v[172:175], v120 offset:11264
    ds_read_b128 v[176:179], v120 offset:12288
    ds_read_b128 v[180:183], v120 offset:13312
    ds_read_b128 v[184:187], v120 offset:14336
    ds_read_b128 v[188:191], v120 offset:15360
    ds_read_b128 v[192:195], v120 offset:16384
    ds_read_b128 v[196:199], v120 offset:17408
    ds_read_b128 v[200:203], v120 offset:18432
    ds_read_b128 v[204:207], v120 offset:19456
    ds_read_b128 v[208:211], v120 offset:20480
    ds_read_b128 v[212:215], v120 offset:21504
    v_dot2_f32_bf16 v4, v128, s70, 0
    v_dot2_f32_bf16 v8, v128, v128, 0
    v_dot2_f32_bf16 v12, v128, s71, 0
    v_dot2_f32_bf16 v5, v136, s70, 0
    v_dot2_f32_bf16 v9, v136, v136, 0
    v_dot2_f32_bf16 v13, v136, s71, 0
    v_dot2_f32_bf16 v6, v144, s70, 0
    v_dot2_f32_bf16 v10, v144, v144, 0
    v_dot2_f32_bf16 v14, v144, s71, 0
    v_dot2_f32_bf16 v7, v152, s70, 0
    v_dot2_f32_bf16 v11, v152, v152, 0
    v_dot2_f32_bf16 v15, v152, s71, 0
    v_dot2_f32_bf16 v4, v129, s70, v4
    v_dot2_f32_bf16 v8, v129, v129, v8
    v_dot2_f32_bf16 v12, v129, s71, v12
    v_dot2_f32_bf16 v5, v137, s70, v5
    v_dot2_f32_bf16 v9, v137, v137, v9
    v_dot2_f32_bf16 v13, v137, s71, v13
    v_dot2_f32_bf16 v6, v145, s70, v6
    v_dot2_f32_bf16 v10, v145, v145, v10
    v_dot2_f32_bf16 v14, v145, s71, v14
    v_dot2_f32_bf16 v7, v153, s70, v7
    v_dot2_f32_bf16 v11, v153, v153, v11
    v_dot2_f32_bf16 v15, v153, s71, v15
    v_dot2_f32_bf16 v4, v130, s70, v4
    v_dot2_f32_bf16 v8, v130, v130, v8
    v_dot2_f32_bf16 v12, v130, s71, v12
    v_dot2_f32_bf16 v5, v138, s70, v5
    v_dot2_f32_bf16 v9, v138, v138, v9
    v_dot2_f32_bf16 v13, v138, s71, v13
    v_dot2_f32_bf16 v6, v146, s70, v6
    v_dot2_f32_bf16 v10, v146, v146, v10
    v_dot2_f32_bf16 v14, v146, s71, v14
    v_dot2_f32_bf16 v7, v154, s70, v7
    v_dot2_f32_bf16 v11, v154, v154, v11
    v_dot2_f32_bf16 v15, v154, s71, v15
    v_dot2_f32_bf16 v4, v131, s70, v4
    v_dot2_f32_bf16 v8, v131, v131, v8
    v_dot2_f32_bf16 v12, v131, s71, v12
    v_dot2_f32_bf16 v5, v139, s70, v5
    v_dot2_f32_bf16 v9, v139, v139, v9
    v_dot2_f32_bf16 v13, v139, s71, v13
    v_dot2_f32_bf16 v6, v147, s70, v6
    v_dot2_f32_bf16 v10, v147, v147, v10
    v_dot2_f32_bf16 v14, v147, s71, v14
    v_dot2_f32_bf16 v7, v155, s70, v7
    v_dot2_f32_bf16 v11, v155, v155, v11
    v_dot2_f32_bf16 v15, v155, s71, v15
    v_dot2_f32_bf16 v4, v132, s70, v4
    v_dot2_f32_bf16 v8, v132, v132, v8
    v_dot2_f32_bf16 v12, v132, s71, v12
    v_dot2_f32_bf16 v5, v140, s70, v5
    v_dot2_f32_bf16 v9, v140, v140, v9
    v_dot2_f32_bf16 v13, v140, s71, v13
    v_dot2_f32_bf16 v6, v148, s70, v6
    v_dot2_f32_bf16 v10, v148, v148, v10
    v_dot2_f32_bf16 v14, v148, s71, v14
    v_dot2_f32_bf16 v7, v156, s70, v7
    v_dot2_f32_bf16 v11, v156, v156, v11
    v_dot2_f32_bf16 v15, v156, s71, v15
    v_dot2_f32_bf16 v4, v133, s70, v4
    v_dot2_f32_bf16 v8, v133, v133, v8
    v_dot2_f32_bf16 v12, v133, s71, v12
    v_dot2_f32_bf16 v5, v141, s70, v5
    v_dot2_f32_bf16 v9, v141, v141, v9
    v_dot2_f32_bf16 v13, v141, s71, v13
    v_dot2_f32_bf16 v6, v149, s70, v6
    v_dot2_f32_bf16 v10, v149, v149, v10
    v_dot2_f32_bf16 v14, v149, s71, v14
    v_dot2_f32_bf16 v7, v157, s70, v7
    v_dot2_f32_bf16 v11, v157, v157, v11
    v_dot2_f32_bf16 v15, v157, s71, v15
    v_dot2_f32_bf16 v4, v134, s70, v4
    v_dot2_f32_bf16 v8, v134, v134, v8
    v_dot2_f32_bf16 v12, v134, s71, v12
    v_dot2_f32_bf16 v5, v142, s70, v5
    v_dot2_f32_bf16 v9, v142, v142, v9
    v_dot2_f32_bf16 v13, v142, s71, v13
    v_dot2_f32_bf16 v6, v150, s70, v6
    v_dot2_f32_bf16 v10, v150, v150, v10
    v_dot2_f32_bf16 v14, v150, s71, v14
    v_dot2_f32_bf16 v7, v158, s70, v7
    v_dot2_f32_bf16 v11, v158, v158, v11
    v_dot2_f32_bf16 v15, v158, s71, v15
    v_dot2_f32_bf16 v4, v135, s70, v4
    v_dot2_f32_bf16 v8, v135, v135, v8
    v_dot2_f32_bf16 v12, v135, s71, v12
    v_dot2_f32_bf16 v5, v143, s70, v5
    v_dot2_f32_bf16 v9, v143, v143, v9
    v_dot2_f32_bf16 v13, v143, s71, v13
    v_dot2_f32_bf16 v6, v151, s70, v6
    v_dot2_f32_bf16 v10, v151, v151, v10
    v_dot2_f32_bf16 v14, v151, s71, v14
    v_dot2_f32_bf16 v7, v159, s70, v7
    v_dot2_f32_bf16 v11, v159, v159, v11
    v_dot2_f32_bf16 v15, v159, s71, v15
    s_nop 2
    v_permlane32_swap_b32 v4, v5
    v_permlane32_swap_b32 v8, v9
    v_permlane32_swap_b32 v12, v13
    v_permlane32_swap_b32 v6, v7
    v_permlane32_swap_b32 v10, v11
    v_permlane32_swap_b32 v14, v15
    s_nop 1
    v_add_f32 v4, v4, v5
    v_add_f32 v8, v8, v9
    v_add_f32 v12, v12, v13
    v_add_f32 v6, v6, v7
    v_add_f32 v10, v10, v11
    v_add_f32 v14, v14, v15
    s_nop 1
    v_permlane16_swap_b32 v4, v6
    v_permlane16_swap_b32 v8, v10
    v_permlane16_swap_b32 v12, v14
    s_nop 1
    v_add_f32 v4, v4, v6
    v_add_f32 v8, v8, v10
    v_add_f32 v12, v12, v14
    s_nop 0
    v_add_f32_dpp v4, v4, v4 row_ror:8 row_mask:0xf bank_mask:0xf
    v_add_f32_dpp v8, v8, v8 row_ror:8 row_mask:0xf bank_mask:0xf
    v_add_f32_dpp v12, v12, v12 row_ror:8 row_mask:0xf bank_mask:0xf
    s_nop 0
    v_add_f32_dpp v4, v4, v4 row_ror:4 row_mask:0xf bank_mask:0xf
    v_add_f32_dpp v8, v8, v8 row_ror:4 row_mask:0xf bank_mask:0xf
    v_add_f32_dpp v12, v12, v12 row_ror:4 row_mask:0xf bank_mask:0xf
    s_nop 0
    v_add_f32_dpp v4, v4, v4 row_ror:2 row_mask:0xf bank_mask:0xf
    v_add_f32_dpp v8, v8, v8 row_ror:2 row_mask:0xf bank_mask:0xf
    v_add_f32_dpp v12, v12, v12 row_ror:2 row_mask:0xf bank_mask:0xf
    s_nop 0
    v_add_f32_dpp v4, v4, v4 row_ror:1 row_mask:0xf bank_mask:0xf
    v_add_f32_dpp v8, v8, v8 row_ror:1 row_mask:0xf bank_mask:0xf
    v_add_f32_dpp v12, v12, v12 row_ror:1 row_mask:0xf bank_mask:0xf
    v_mul_f32 v4, 0x3a800000, v4
    v_mul_f32 v8, 0x3a800000, v8
    v_fma_f32 v8, -v4, v4, v8
    v_max_f32 v8, 0, v8
    v_cvt_pk_bf16_f32 v4, v4, v8
    v_and_b32 v8, 0xffff0000, v4
    v_lshlrev_b32 v4, 16, v4
    v_add_f32 v8, 0x3727c5ac, v8
    v_cvt_pk_bf16_f32 v8, v8, v8
    v_lshlrev_b32 v8, 16, v8
    v_sqrt_f32 v8, v8
    s_nop 0
    v_cvt_pk_bf16_f32 v8, v8, v8
    v_lshlrev_b32 v8, 16, v8
    v_rcp_f32 v5, v8
    s_nop 0
    v_mul_f32 v6, v4, v5
    v_sub_f32 v6, 0, v6
    v_mul_f32 v12, v12, v5
    v_cvt_pk_f16_f32 v12, v12, 0
    s_lshl_b32 s29, s61, 3
    s_mov_b32 exec_lo, 0x00010001
    s_mov_b32 exec_hi, 0x00010001
    buffer_store_dwordx2 v[4:5], v31, s[32:35], s29 offen sc1
    ds_write_b32 v30, v12
    s_mov_b64 exec, -1
    v_mov_b32 v219, v5
    v_mov_b32 v220, v6
    s_waitcnt vmcnt(1)
    s_mov_b32 s63, s61
    s_mov_b32 s61, s62
    v_dot2_f32_bf16 v4, v64, s70, 0
    v_dot2_f32_bf16 v8, v64, v64, 0
    v_dot2_f32_bf16 v12, v64, s71, 0
    v_dot2_f32_bf16 v5, v72, s70, 0
    v_dot2_f32_bf16 v9, v72, v72, 0
    v_dot2_f32_bf16 v13, v72, s71, 0
    v_dot2_f32_bf16 v6, v80, s70, 0
    v_dot2_f32_bf16 v10, v80, v80, 0
    v_dot2_f32_bf16 v14, v80, s71, 0
    v_dot2_f32_bf16 v7, v88, s70, 0
    v_dot2_f32_bf16 v11, v88, v88, 0
    v_dot2_f32_bf16 v15, v88, s71, 0
    v_dot2_f32_bf16 v4, v65, s70, v4
    v_dot2_f32_bf16 v8, v65, v65, v8
    v_dot2_f32_bf16 v12, v65, s71, v12
    v_dot2_f32_bf16 v5, v73, s70, v5
    v_dot2_f32_bf16 v9, v73, v73, v9
    v_dot2_f32_bf16 v13, v73, s71, v13
    v_dot2_f32_bf16 v6, v81, s70, v6
    v_dot2_f32_bf16 v10, v81, v81, v10
    v_dot2_f32_bf16 v14, v81, s71, v14
    v_dot2_f32_bf16 v7, v89, s70, v7
    v_dot2_f32_bf16 v11, v89, v89, v11
    v_dot2_f32_bf16 v15, v89, s71, v15
    v_dot2_f32_bf16 v4, v66, s70, v4
    v_dot2_f32_bf16 v8, v66, v66, v8
    v_dot2_f32_bf16 v12, v66, s71, v12
    v_dot2_f32_bf16 v5, v74, s70, v5
    v_dot2_f32_bf16 v9, v74, v74, v9
    v_dot2_f32_bf16 v13, v74, s71, v13
    v_dot2_f32_bf16 v6, v82, s70, v6
    v_dot2_f32_bf16 v10, v82, v82, v10
    v_dot2_f32_bf16 v14, v82, s71, v14
    v_dot2_f32_bf16 v7, v90, s70, v7
    v_dot2_f32_bf16 v11, v90, v90, v11
    v_dot2_f32_bf16 v15, v90, s71, v15
    v_dot2_f32_bf16 v4, v67, s70, v4
    v_dot2_f32_bf16 v8, v67, v67, v8
    v_dot2_f32_bf16 v12, v67, s71, v12
    v_dot2_f32_bf16 v5, v75, s70, v5
    v_dot2_f32_bf16 v9, v75, v75, v9
    v_dot2_f32_bf16 v13, v75, s71, v13
    v_dot2_f32_bf16 v6, v83, s70, v6
    v_dot2_f32_bf16 v10, v83, v83, v10
    v_dot2_f32_bf16 v14, v83, s71, v14
    v_dot2_f32_bf16 v7, v91, s70, v7
    v_dot2_f32_bf16 v11, v91, v91, v11
    v_dot2_f32_bf16 v15, v91, s71, v15
    v_dot2_f32_bf16 v4, v68, s70, v4
    v_dot2_f32_bf16 v8, v68, v68, v8
    v_dot2_f32_bf16 v12, v68, s71, v12
    v_dot2_f32_bf16 v5, v76, s70, v5
    v_dot2_f32_bf16 v9, v76, v76, v9
    v_dot2_f32_bf16 v13, v76, s71, v13
    v_dot2_f32_bf16 v6, v84, s70, v6
    v_dot2_f32_bf16 v10, v84, v84, v10
    v_dot2_f32_bf16 v14, v84, s71, v14
    v_dot2_f32_bf16 v7, v92, s70, v7
    v_dot2_f32_bf16 v11, v92, v92, v11
    v_dot2_f32_bf16 v15, v92, s71, v15
    v_dot2_f32_bf16 v4, v69, s70, v4
    v_dot2_f32_bf16 v8, v69, v69, v8
    v_dot2_f32_bf16 v12, v69, s71, v12
    v_dot2_f32_bf16 v5, v77, s70, v5
    v_dot2_f32_bf16 v9, v77, v77, v9
    v_dot2_f32_bf16 v13, v77, s71, v13
    v_dot2_f32_bf16 v6, v85, s70, v6
    v_dot2_f32_bf16 v10, v85, v85, v10
    v_dot2_f32_bf16 v14, v85, s71, v14
    v_dot2_f32_bf16 v7, v93, s70, v7
    v_dot2_f32_bf16 v11, v93, v93, v11
    v_dot2_f32_bf16 v15, v93, s71, v15
    v_dot2_f32_bf16 v4, v70, s70, v4
    v_dot2_f32_bf16 v8, v70, v70, v8
    v_dot2_f32_bf16 v12, v70, s71, v12
    v_dot2_f32_bf16 v5, v78, s70, v5
    v_dot2_f32_bf16 v9, v78, v78, v9
    v_dot2_f32_bf16 v13, v78, s71, v13
    v_dot2_f32_bf16 v6, v86, s70, v6
    v_dot2_f32_bf16 v10, v86, v86, v10
    v_dot2_f32_bf16 v14, v86, s71, v14
    v_dot2_f32_bf16 v7, v94, s70, v7
    v_dot2_f32_bf16 v11, v94, v94, v11
    v_dot2_f32_bf16 v15, v94, s71, v15
    v_dot2_f32_bf16 v4, v71, s70, v4
    v_dot2_f32_bf16 v8, v71, v71, v8
    v_dot2_f32_bf16 v12, v71, s71, v12
    v_dot2_f32_bf16 v5, v79, s70, v5
    v_dot2_f32_bf16 v9, v79, v79, v9
    v_dot2_f32_bf16 v13, v79, s71, v13
    v_dot2_f32_bf16 v6, v87, s70, v6
    v_dot2_f32_bf16 v10, v87, v87, v10
    v_dot2_f32_bf16 v14, v87, s71, v14
    v_dot2_f32_bf16 v7, v95, s70, v7
    v_dot2_f32_bf16 v11, v95, v95, v11
    v_dot2_f32_bf16 v15, v95, s71, v15
    s_nop 2
    v_permlane32_swap_b32 v4, v5
    v_permlane32_swap_b32 v8, v9
    v_permlane32_swap_b32 v12, v13
    v_permlane32_swap_b32 v6, v7
    v_permlane32_swap_b32 v10, v11
    v_permlane32_swap_b32 v14, v15
    s_nop 1
    v_add_f32 v4, v4, v5
    v_add_f32 v8, v8, v9
    v_add_f32 v12, v12, v13
    v_add_f32 v6, v6, v7
    v_add_f32 v10, v10, v11
    v_add_f32 v14, v14, v15
    s_nop 1
    v_permlane16_swap_b32 v4, v6
    v_permlane16_swap_b32 v8, v10
    v_permlane16_swap_b32 v12, v14
    s_nop 1
    v_add_f32 v4, v4, v6
    v_add_f32 v8, v8, v10
    v_add_f32 v12, v12, v14
    s_nop 0
    v_add_f32_dpp v4, v4, v4 row_ror:8 row_mask:0xf bank_mask:0xf
    v_add_f32_dpp v8, v8, v8 row_ror:8 row_mask:0xf bank_mask:0xf
    v_add_f32_dpp v12, v12, v12 row_ror:8 row_mask:0xf bank_mask:0xf
    s_nop 0
    v_add_f32_dpp v4, v4, v4 row_ror:4 row_mask:0xf bank_mask:0xf
    v_add_f32_dpp v8, v8, v8 row_ror:4 row_mask:0xf bank_mask:0xf
    v_add_f32_dpp v12, v12, v12 row_ror:4 row_mask:0xf bank_mask:0xf
    s_nop 0
    v_add_f32_dpp v4, v4, v4 row_ror:2 row_mask:0xf bank_mask:0xf
    v_add_f32_dpp v8, v8, v8 row_ror:2 row_mask:0xf bank_mask:0xf
    v_add_f32_dpp v12, v12, v12 row_ror:2 row_mask:0xf bank_mask:0xf
    s_nop 0
    v_add_f32_dpp v4, v4, v4 row_ror:1 row_mask:0xf bank_mask:0xf
    v_add_f32_dpp v8, v8, v8 row_ror:1 row_mask:0xf bank_mask:0xf
    v_add_f32_dpp v12, v12, v12 row_ror:1 row_mask:0xf bank_mask:0xf
    v_mul_f32 v4, 0x3a800000, v4
    v_mul_f32 v8, 0x3a800000, v8
    v_fma_f32 v8, -v4, v4, v8
    v_max_f32 v8, 0, v8
    v_cvt_pk_bf16_f32 v4, v4, v8
    v_and_b32 v8, 0xffff0000, v4
    v_lshlrev_b32 v4, 16, v4
    v_add_f32 v8, 0x3727c5ac, v8
    v_cvt_pk_bf16_f32 v8, v8, v8
    v_lshlrev_b32 v8, 16, v8
    v_sqrt_f32 v8, v8
    s_nop 0
    v_cvt_pk_bf16_f32 v8, v8, v8
    v_lshlrev_b32 v8, 16, v8
    v_rcp_f32 v5, v8
    s_nop 0
    v_mul_f32 v6, v4, v5
    v_sub_f32 v6, 0, v6
    v_mul_f32 v12, v12, v5
    v_cvt_pk_f16_f32 v12, v12, 0
    s_lshl_b32 s29, s61, 3
    s_mov_b32 exec_lo, 0x00010001
    s_mov_b32 exec_hi, 0x00010001
    buffer_store_dwordx2 v[4:5], v31, s[32:35], s29 offen sc1
    s_mov_b64 exec, -1
    v_mov_b32 v216, v5
    v_mov_b32 v217, v6
    v_mov_b32 v218, v12
    s_mov_b32 s61, s63
    s_nop 0
    v_readlane_b32 s72, v219, 0
    v_readlane_b32 s80, v220, 0
    v_readlane_b32 s74, v219, 32
    v_readlane_b32 s81, v220, 32
    v_readlane_b32 s76, v219, 16
    v_readlane_b32 s82, v220, 16
    v_readlane_b32 s78, v219, 48
    v_readlane_b32 s83, v220, 48
    s_nop 1
    v_mov_b32 v8, s80
    v_mov_b32 v10, s81
    v_mov_b32 v12, s82
    v_mov_b32 v14, s83
    s_waitcnt lgkmcnt(0)
L_fft_task:
    v_and_b32 v120, 15, v2
    v_add_u32 v121, 0, v120
    v_mul_lo_u32 v121, v121, s61
    v_cvt_f32_u32 v121, v121
    v_mul_f32 v121, 0x3a000000, v121
    v_cos_f32 v26, v121
    v_sin_f32 v27, v121
    v_add_u32 v121, 16, v120
    v_mul_lo_u32 v121, v121, s61
    v_cvt_f32_u32 v121, v121
    v_mul_f32 v121, 0x3a000000, v121
    v_cos_f32 v28, v121
    v_sin_f32 v29, v121
    s_cmp_lt_u32 s61, 32
    s_cbranch_scc1 L_w2d_recurr_21
    s_waitcnt vmcnt(9)
    s_mov_b32 exec_lo, 0x00010001
    s_mov_b32 exec_hi, 0x00010001
    ds_write_b32 v30, v218
    s_mov_b64 exec, -1
    v_readlane_b32 s72, v216, 0
    v_readlane_b32 s80, v217, 0
    v_readlane_b32 s74, v216, 32
    v_readlane_b32 s81, v217, 32
    v_readlane_b32 s76, v216, 16
    v_readlane_b32 s82, v217, 16
    v_readlane_b32 s78, v216, 48
    v_readlane_b32 s83, v217, 48
    s_nop 1
    v_mov_b32 v8, s80
    v_mov_b32 v10, s81
    v_mov_b32 v12, s82
    v_mov_b32 v14, s83
L_w2d_recurr_21:
    v_lshlrev_b32 v32, 16, v128
    v_and_b32 v33, 0xffff0000, v128
    v_lshlrev_b32 v34, 16, v129
    v_and_b32 v35, 0xffff0000, v129
    v_lshlrev_b32 v36, 16, v130
    v_and_b32 v37, 0xffff0000, v130
    v_lshlrev_b32 v38, 16, v131
    v_and_b32 v39, 0xffff0000, v131
    v_lshlrev_b32 v40, 16, v132
    v_and_b32 v41, 0xffff0000, v132
    v_lshlrev_b32 v42, 16, v133
    v_and_b32 v43, 0xffff0000, v133
    v_lshlrev_b32 v44, 16, v134
    v_and_b32 v45, 0xffff0000, v134
    v_lshlrev_b32 v46, 16, v135
    v_and_b32 v47, 0xffff0000, v135
    v_pk_fma_f32 v[32:33], v[32:33], s[72:73], v[8:9] op_sel_hi:[1,0,0]
    v_pk_fma_f32 v[34:35], v[34:35], s[72:73], v[8:9] op_sel_hi:[1,0,0]
    v_pk_fma_f32 v[36:37], v[36:37], s[72:73], v[8:9] op_sel_hi:[1,0,0]
    v_pk_fma_f32 v[38:39], v[38:39], s[72:73], v[8:9] op_sel_hi:[1,0,0]
    v_pk_fma_f32 v[40:41], v[40:41], s[72:73], v[8:9] op_sel_hi:[1,0,0]
    v_pk_fma_f32 v[42:43], v[42:43], s[72:73], v[8:9] op_sel_hi:[1,0,0]
    v_pk_fma_f32 v[44:45], v[44:45], s[72:73], v[8:9] op_sel_hi:[1,0,0]
    v_pk_fma_f32 v[46:47], v[46:47], s[72:73], v[8:9] op_sel_hi:[1,0,0]
    v_cvt_pk_f16_f32 v32, v32, v33
    v_cvt_pk_f16_f32 v33, v34, v35
    v_cvt_pk_f16_f32 v34, v36, v37
    v_cvt_pk_f16_f32 v35, v38, v39
    v_cvt_pk_f16_f32 v36, v40, v41
    v_cvt_pk_f16_f32 v37, v42, v43
    v_cvt_pk_f16_f32 v38, v44, v45
    v_cvt_pk_f16_f32 v39, v46, v47
    ds_write_b128 v16, v[32:35] offset:0
    ds_write_b128 v16, v[36:39] offset:1024
    s_waitcnt lgkmcnt(0)
    ds_read_b64_tr_b16 v[112:113], v17 offset:0
    ds_read_b64_tr_b16 v[114:115], v17 offset:256
    ds_read_b64_tr_b16 v[116:117], v17 offset:1024
    ds_read_b64_tr_b16 v[118:119], v17 offset:1280
    s_waitcnt lgkmcnt(0)
    v_mfma_f32_32x32x16_f16 v[48:63], v[112:115], a[0:3], 0
    v_mfma_f32_32x32x16_f16 v[64:79], v[112:115], a[4:7], 0
    v_mfma_f32_32x32x16_f16 v[48:63], v[116:119], a[8:11], v[48:63]
    v_mfma_f32_32x32x16_f16 v[64:79], v[116:119], a[12:15], v[64:79]
    s_nop 7
    s_nop 7
    s_nop 1
    v_pk_mul_f32 v[32:33], v[48:49], v[184:185]
    v_pk_mul_f32 v[34:35], v[64:65], v[184:185]
    v_pk_fma_f32 v[32:33], v[64:65], v[200:201], v[32:33]
    v_pk_fma_f32 v[34:35], v[48:49], v[200:201], v[34:35] neg_lo:[1,0,0] neg_hi:[1,0,0]
    v_cvt_pk_f16_f32 v80, v32, v33
    v_cvt_pk_f16_f32 v88, v34, v35
    v_pk_mul_f32 v[32:33], v[50:51], v[186:187]
    v_pk_mul_f32 v[34:35], v[66:67], v[186:187]
    v_pk_fma_f32 v[32:33], v[66:67], v[202:203], v[32:33]
    v_pk_fma_f32 v[34:35], v[50:51], v[202:203], v[34:35] neg_lo:[1,0,0] neg_hi:[1,0,0]
    v_cvt_pk_f16_f32 v81, v32, v33
    v_cvt_pk_f16_f32 v89, v34, v35
    v_pk_mul_f32 v[32:33], v[52:53], v[188:189]
    v_pk_mul_f32 v[34:35], v[68:69], v[188:189]
    v_pk_fma_f32 v[32:33], v[68:69], v[204:205], v[32:33]
    v_pk_fma_f32 v[34:35], v[52:53], v[204:205], v[34:35] neg_lo:[1,0,0] neg_hi:[1,0,0]
    v_cvt_pk_f16_f32 v82, v32, v33
    v_cvt_pk_f16_f32 v90, v34, v35
    v_pk_mul_f32 v[32:33], v[54:55], v[190:191]
    v_pk_mul_f32 v[34:35], v[70:71], v[190:191]
    v_pk_fma_f32 v[32:33], v[70:71], v[206:207], v[32:33]
    v_pk_fma_f32 v[34:35], v[54:55], v[206:207], v[34:35] neg_lo:[1,0,0] neg_hi:[1,0,0]
    v_cvt_pk_f16_f32 v83, v32, v33
    v_cvt_pk_f16_f32 v91, v34, v35
    v_pk_mul_f32 v[32:33], v[56:57], v[192:193]
    v_pk_mul_f32 v[34:35], v[72:73], v[192:193]
    v_pk_fma_f32 v[32:33], v[72:73], v[208:209], v[32:33]
    v_pk_fma_f32 v[34:35], v[56:57], v[208:209], v[34:35] neg_lo:[1,0,0] neg_hi:[1,0,0]
    v_cvt_pk_f16_f32 v84, v32, v33
    v_cvt_pk_f16_f32 v92, v34, v35
    v_pk_mul_f32 v[32:33], v[58:59], v[194:195]
    v_pk_mul_f32 v[34:35], v[74:75], v[194:195]
    v_pk_fma_f32 v[32:33], v[74:75], v[210:211], v[32:33]
    v_pk_fma_f32 v[34:35], v[58:59], v[210:211], v[34:35] neg_lo:[1,0,0] neg_hi:[1,0,0]
    v_cvt_pk_f16_f32 v85, v32, v33
    v_cvt_pk_f16_f32 v93, v34, v35
    v_pk_mul_f32 v[32:33], v[60:61], v[196:197]
    v_pk_mul_f32 v[34:35], v[76:77], v[196:197]
    v_pk_fma_f32 v[32:33], v[76:77], v[212:213], v[32:33]
    v_pk_fma_f32 v[34:35], v[60:61], v[212:213], v[34:35] neg_lo:[1,0,0] neg_hi:[1,0,0]
    v_cvt_pk_f16_f32 v86, v32, v33
    v_cvt_pk_f16_f32 v94, v34, v35
    v_pk_mul_f32 v[32:33], v[62:63], v[198:199]
    v_pk_mul_f32 v[34:35], v[78:79], v[198:199]
    v_pk_fma_f32 v[32:33], v[78:79], v[214:215], v[32:33]
    v_pk_fma_f32 v[34:35], v[62:63], v[214:215], v[34:35] neg_lo:[1,0,0] neg_hi:[1,0,0]
    v_cvt_pk_f16_f32 v87, v32, v33
    v_cvt_pk_f16_f32 v95, v34, v35
    s_nop 1
    v_mfma_f32_32x32x16_f16 v[96:111], v[80:83], a[16:19], 0
    v_mfma_f32_32x32x16_f16 v[96:111], v[88:91], a[20:23], v[96:111]
    v_mfma_f32_32x32x16_f16 v[96:111], v[84:87], a[24:27], v[96:111]
    v_mfma_f32_32x32x16_f16 v[96:111], v[92:95], a[28:31], v[96:111]
    s_nop 7
    s_nop 7
    s_nop 1
    v_cvt_pk_f16_f32 v80, v96, v97
    v_cvt_pk_f16_f32 v81, v98, v99
    v_cvt_pk_f16_f32 v82, v100, v101
    v_cvt_pk_f16_f32 v83, v102, v103
    v_cvt_pk_f16_f32 v84, v104, v105
    v_cvt_pk_f16_f32 v85, v106, v107
    v_cvt_pk_f16_f32 v86, v108, v109
    v_cvt_pk_f16_f32 v87, v110, v111
    ds_write_b64 v18, v[80:81] offset:0
    ds_write_b64 v19, v[82:83] offset:0
    ds_write_b64 v20, v[84:85] offset:0
    ds_write_b64 v21, v[86:87] offset:0
    v_lshlrev_b32 v32, 16, v136
    v_and_b32 v33, 0xffff0000, v136
    v_lshlrev_b32 v34, 16, v137
    v_and_b32 v35, 0xffff0000, v137
    v_lshlrev_b32 v36, 16, v138
    v_and_b32 v37, 0xffff0000, v138
    v_lshlrev_b32 v38, 16, v139
    v_and_b32 v39, 0xffff0000, v139
    v_lshlrev_b32 v40, 16, v140
    v_and_b32 v41, 0xffff0000, v140
    v_lshlrev_b32 v42, 16, v141
    v_and_b32 v43, 0xffff0000, v141
    v_lshlrev_b32 v44, 16, v142
    v_and_b32 v45, 0xffff0000, v142
    v_lshlrev_b32 v46, 16, v143
    v_and_b32 v47, 0xffff0000, v143
    v_pk_fma_f32 v[32:33], v[32:33], s[74:75], v[10:11] op_sel_hi:[1,0,0]
    v_pk_fma_f32 v[34:35], v[34:35], s[74:75], v[10:11] op_sel_hi:[1,0,0]
    v_pk_fma_f32 v[36:37], v[36:37], s[74:75], v[10:11] op_sel_hi:[1,0,0]
    v_pk_fma_f32 v[38:39], v[38:39], s[74:75], v[10:11] op_sel_hi:[1,0,0]
    v_pk_fma_f32 v[40:41], v[40:41], s[74:75], v[10:11] op_sel_hi:[1,0,0]
    v_pk_fma_f32 v[42:43], v[42:43], s[74:75], v[10:11] op_sel_hi:[1,0,0]
    v_pk_fma_f32 v[44:45], v[44:45], s[74:75], v[10:11] op_sel_hi:[1,0,0]
    v_pk_fma_f32 v[46:47], v[46:47], s[74:75], v[10:11] op_sel_hi:[1,0,0]
    v_cvt_pk_f16_f32 v32, v32, v33
    v_cvt_pk_f16_f32 v33, v34, v35
    v_cvt_pk_f16_f32 v34, v36, v37
    v_cvt_pk_f16_f32 v35, v38, v39
    v_cvt_pk_f16_f32 v36, v40, v41
    v_cvt_pk_f16_f32 v37, v42, v43
    v_cvt_pk_f16_f32 v38, v44, v45
    v_cvt_pk_f16_f32 v39, v46, v47
    ds_write_b128 v16, v[32:35] offset:2048
    ds_write_b128 v16, v[36:39] offset:3072
    s_waitcnt lgkmcnt(0)
    ds_read_b64_tr_b16 v[112:113], v17 offset:2048
    ds_read_b64_tr_b16 v[114:115], v17 offset:2304
    ds_read_b64_tr_b16 v[116:117], v17 offset:3072
    ds_read_b64_tr_b16 v[118:119], v17 offset:3328
    s_waitcnt lgkmcnt(0)
    v_mfma_f32_32x32x16_f16 v[48:63], v[112:115], a[0:3], 0
    v_mfma_f32_32x32x16_f16 v[64:79], v[112:115], a[4:7], 0
    v_mfma_f32_32x32x16_f16 v[48:63], v[116:119], a[8:11], v[48:63]
    v_mfma_f32_32x32x16_f16 v[64:79], v[116:119], a[12:15], v[64:79]
    s_nop 7
    s_nop 7
    s_nop 1
    v_pk_mul_f32 v[32:33], v[48:49], v[184:185]
    v_pk_mul_f32 v[34:35], v[64:65], v[184:185]
    v_pk_fma_f32 v[32:33], v[64:65], v[200:201], v[32:33]
    v_pk_fma_f32 v[34:35], v[48:49], v[200:201], v[34:35] neg_lo:[1,0,0] neg_hi:[1,0,0]
    v_cvt_pk_f16_f32 v80, v32, v33
    v_cvt_pk_f16_f32 v88, v34, v35
    v_pk_mul_f32 v[32:33], v[50:51], v[186:187]
    v_pk_mul_f32 v[34:35], v[66:67], v[186:187]
    v_pk_fma_f32 v[32:33], v[66:67], v[202:203], v[32:33]
    v_pk_fma_f32 v[34:35], v[50:51], v[202:203], v[34:35] neg_lo:[1,0,0] neg_hi:[1,0,0]
    v_cvt_pk_f16_f32 v81, v32, v33
    v_cvt_pk_f16_f32 v89, v34, v35
    v_pk_mul_f32 v[32:33], v[52:53], v[188:189]
    v_pk_mul_f32 v[34:35], v[68:69], v[188:189]
    v_pk_fma_f32 v[32:33], v[68:69], v[204:205], v[32:33]
    v_pk_fma_f32 v[34:35], v[52:53], v[204:205], v[34:35] neg_lo:[1,0,0] neg_hi:[1,0,0]
    v_cvt_pk_f16_f32 v82, v32, v33
    v_cvt_pk_f16_f32 v90, v34, v35
    v_pk_mul_f32 v[32:33], v[54:55], v[190:191]
    v_pk_mul_f32 v[34:35], v[70:71], v[190:191]
    v_pk_fma_f32 v[32:33], v[70:71], v[206:207], v[32:33]
    v_pk_fma_f32 v[34:35], v[54:55], v[206:207], v[34:35] neg_lo:[1,0,0] neg_hi:[1,0,0]
    v_cvt_pk_f16_f32 v83, v32, v33
    v_cvt_pk_f16_f32 v91, v34, v35
    v_pk_mul_f32 v[32:33], v[56:57], v[192:193]
    v_pk_mul_f32 v[34:35], v[72:73], v[192:193]
    v_pk_fma_f32 v[32:33], v[72:73], v[208:209], v[32:33]
    v_pk_fma_f32 v[34:35], v[56:57], v[208:209], v[34:35] neg_lo:[1,0,0] neg_hi:[1,0,0]
    v_cvt_pk_f16_f32 v84, v32, v33
    v_cvt_pk_f16_f32 v92, v34, v35
    v_pk_mul_f32 v[32:33], v[58:59], v[194:195]
    v_pk_mul_f32 v[34:35], v[74:75], v[194:195]
    v_pk_fma_f32 v[32:33], v[74:75], v[210:211], v[32:33]
    v_pk_fma_f32 v[34:35], v[58:59], v[210:211], v[34:35] neg_lo:[1,0,0] neg_hi:[1,0,0]
    v_cvt_pk_f16_f32 v85, v32, v33
    v_cvt_pk_f16_f32 v93, v34, v35
    v_pk_mul_f32 v[32:33], v[60:61], v[196:197]
    v_pk_mul_f32 v[34:35], v[76:77], v[196:197]
    v_pk_fma_f32 v[32:33], v[76:77], v[212:213], v[32:33]
    v_pk_fma_f32 v[34:35], v[60:61], v[212:213], v[34:35] neg_lo:[1,0,0] neg_hi:[1,0,0]
    v_cvt_pk_f16_f32 v86, v32, v33
    v_cvt_pk_f16_f32 v94, v34, v35
    v_pk_mul_f32 v[32:33], v[62:63], v[198:199]
    v_pk_mul_f32 v[34:35], v[78:79], v[198:199]
    v_pk_fma_f32 v[32:33], v[78:79], v[214:215], v[32:33]
    v_pk_fma_f32 v[34:35], v[62:63], v[214:215], v[34:35] neg_lo:[1,0,0] neg_hi:[1,0,0]
    v_cvt_pk_f16_f32 v87, v32, v33
    v_cvt_pk_f16_f32 v95, v34, v35
    s_nop 1
    v_mfma_f32_32x32x16_f16 v[96:111], v[80:83], a[16:19], 0
    v_mfma_f32_32x32x16_f16 v[96:111], v[88:91], a[20:23], v[96:111]
    v_mfma_f32_32x32x16_f16 v[96:111], v[84:87], a[24:27], v[96:111]
    v_mfma_f32_32x32x16_f16 v[96:111], v[92:95], a[28:31], v[96:111]
    s_nop 7
    s_nop 7
    s_nop 1
    v_cvt_pk_f16_f32 v80, v96, v97
    v_cvt_pk_f16_f32 v81, v98, v99
    v_cvt_pk_f16_f32 v82, v100, v101
    v_cvt_pk_f16_f32 v83, v102, v103
    v_cvt_pk_f16_f32 v84, v104, v105
    v_cvt_pk_f16_f32 v85, v106, v107
    v_cvt_pk_f16_f32 v86, v108, v109
    v_cvt_pk_f16_f32 v87, v110, v111
    ds_write_b64 v18, v[80:81] offset:1056
    ds_write_b64 v19, v[82:83] offset:1056
    ds_write_b64 v20, v[84:85] offset:1056
    ds_write_b64 v21, v[86:87] offset:1056
    v_lshlrev_b32 v32, 16, v144
    v_and_b32 v33, 0xffff0000, v144
    v_lshlrev_b32 v34, 16, v145
    v_and_b32 v35, 0xffff0000, v145
    v_lshlrev_b32 v36, 16, v146
    v_and_b32 v37, 0xffff0000, v146
    v_lshlrev_b32 v38, 16, v147
    v_and_b32 v39, 0xffff0000, v147
    v_lshlrev_b32 v40, 16, v148
    v_and_b32 v41, 0xffff0000, v148
    v_lshlrev_b32 v42, 16, v149
    v_and_b32 v43, 0xffff0000, v149
    v_lshlrev_b32 v44, 16, v150
    v_and_b32 v45, 0xffff0000, v150
    v_lshlrev_b32 v46, 16, v151
    v_and_b32 v47, 0xffff0000, v151
    v_pk_fma_f32 v[32:33], v[32:33], s[76:77], v[12:13] op_sel_hi:[1,0,0]
    v_pk_fma_f32 v[34:35], v[34:35], s[76:77], v[12:13] op_sel_hi:[1,0,0]
    v_pk_fma_f32 v[36:37], v[36:37], s[76:77], v[12:13] op_sel_hi:[1,0,0]
    v_pk_fma_f32 v[38:39], v[38:39], s[76:77], v[12:13] op_sel_hi:[1,0,0]
    v_pk_fma_f32 v[40:41], v[40:41], s[76:77], v[12:13] op_sel_hi:[1,0,0]
    v_pk_fma_f32 v[42:43], v[42:43], s[76:77], v[12:13] op_sel_hi:[1,0,0]
    v_pk_fma_f32 v[44:45], v[44:45], s[76:77], v[12:13] op_sel_hi:[1,0,0]
    v_pk_fma_f32 v[46:47], v[46:47], s[76:77], v[12:13] op_sel_hi:[1,0,0]
    v_cvt_pk_f16_f32 v32, v32, v33
    v_cvt_pk_f16_f32 v33, v34, v35
    v_cvt_pk_f16_f32 v34, v36, v37
    v_cvt_pk_f16_f32 v35, v38, v39
    v_cvt_pk_f16_f32 v36, v40, v41
    v_cvt_pk_f16_f32 v37, v42, v43
    v_cvt_pk_f16_f32 v38, v44, v45
    v_cvt_pk_f16_f32 v39, v46, v47
    ds_write_b128 v16, v[32:35] offset:4096
    ds_write_b128 v16, v[36:39] offset:5120
    s_waitcnt lgkmcnt(0)
    ds_read_b64_tr_b16 v[112:113], v17 offset:4096
    ds_read_b64_tr_b16 v[114:115], v17 offset:4352
    ds_read_b64_tr_b16 v[116:117], v17 offset:5120
    ds_read_b64_tr_b16 v[118:119], v17 offset:5376
    s_waitcnt lgkmcnt(0)
    v_mfma_f32_32x32x16_f16 v[48:63], v[112:115], a[0:3], 0
    v_mfma_f32_32x32x16_f16 v[64:79], v[112:115], a[4:7], 0
    v_mfma_f32_32x32x16_f16 v[48:63], v[116:119], a[8:11], v[48:63]
    v_mfma_f32_32x32x16_f16 v[64:79], v[116:119], a[12:15], v[64:79]
    s_nop 7
    s_nop 7
    s_nop 1
    v_pk_mul_f32 v[32:33], v[48:49], v[184:185]
    v_pk_mul_f32 v[34:35], v[64:65], v[184:185]
    v_pk_fma_f32 v[32:33], v[64:65], v[200:201], v[32:33]
    v_pk_fma_f32 v[34:35], v[48:49], v[200:201], v[34:35] neg_lo:[1,0,0] neg_hi:[1,0,0]
    v_cvt_pk_f16_f32 v80, v32, v33
    v_cvt_pk_f16_f32 v88, v34, v35
    v_pk_mul_f32 v[32:33], v[50:51], v[186:187]
    v_pk_mul_f32 v[34:35], v[66:67], v[186:187]
    v_pk_fma_f32 v[32:33], v[66:67], v[202:203], v[32:33]
    v_pk_fma_f32 v[34:35], v[50:51], v[202:203], v[34:35] neg_lo:[1,0,0] neg_hi:[1,0,0]
    v_cvt_pk_f16_f32 v81, v32, v33
    v_cvt_pk_f16_f32 v89, v34, v35
    v_pk_mul_f32 v[32:33], v[52:53], v[188:189]
    v_pk_mul_f32 v[34:35], v[68:69], v[188:189]
    v_pk_fma_f32 v[32:33], v[68:69], v[204:205], v[32:33]
    v_pk_fma_f32 v[34:35], v[52:53], v[204:205], v[34:35] neg_lo:[1,0,0] neg_hi:[1,0,0]
    v_cvt_pk_f16_f32 v82, v32, v33
    v_cvt_pk_f16_f32 v90, v34, v35
    v_pk_mul_f32 v[32:33], v[54:55], v[190:191]
    v_pk_mul_f32 v[34:35], v[70:71], v[190:191]
    v_pk_fma_f32 v[32:33], v[70:71], v[206:207], v[32:33]
    v_pk_fma_f32 v[34:35], v[54:55], v[206:207], v[34:35] neg_lo:[1,0,0] neg_hi:[1,0,0]
    v_cvt_pk_f16_f32 v83, v32, v33
    v_cvt_pk_f16_f32 v91, v34, v35
    v_pk_mul_f32 v[32:33], v[56:57], v[192:193]
    v_pk_mul_f32 v[34:35], v[72:73], v[192:193]
    v_pk_fma_f32 v[32:33], v[72:73], v[208:209], v[32:33]
    v_pk_fma_f32 v[34:35], v[56:57], v[208:209], v[34:35] neg_lo:[1,0,0] neg_hi:[1,0,0]
    v_cvt_pk_f16_f32 v84, v32, v33
    v_cvt_pk_f16_f32 v92, v34, v35
    v_pk_mul_f32 v[32:33], v[58:59], v[194:195]
    v_pk_mul_f32 v[34:35], v[74:75], v[194:195]
    v_pk_fma_f32 v[32:33], v[74:75], v[210:211], v[32:33]
    v_pk_fma_f32 v[34:35], v[58:59], v[210:211], v[34:35] neg_lo:[1,0,0] neg_hi:[1,0,0]
    v_cvt_pk_f16_f32 v85, v32, v33
    v_cvt_pk_f16_f32 v93, v34, v35
    v_pk_mul_f32 v[32:33], v[60:61], v[196:197]
    v_pk_mul_f32 v[34:35], v[76:77], v[196:197]
    v_pk_fma_f32 v[32:33], v[76:77], v[212:213], v[32:33]
    v_pk_fma_f32 v[34:35], v[60:61], v[212:213], v[34:35] neg_lo:[1,0,0] neg_hi:[1,0,0]
    v_cvt_pk_f16_f32 v86, v32, v33
    v_cvt_pk_f16_f32 v94, v34, v35
    v_pk_mul_f32 v[32:33], v[62:63], v[198:199]
    v_pk_mul_f32 v[34:35], v[78:79], v[198:199]
    v_pk_fma_f32 v[32:33], v[78:79], v[214:215], v[32:33]
    v_pk_fma_f32 v[34:35], v[62:63], v[214:215], v[34:35] neg_lo:[1,0,0] neg_hi:[1,0,0]
    v_cvt_pk_f16_f32 v87, v32, v33
    v_cvt_pk_f16_f32 v95, v34, v35
    s_nop 1
    v_mfma_f32_32x32x16_f16 v[96:111], v[80:83], a[16:19], 0
    v_mfma_f32_32x32x16_f16 v[96:111], v[88:91], a[20:23], v[96:111]
    v_mfma_f32_32x32x16_f16 v[96:111], v[84:87], a[24:27], v[96:111]
    v_mfma_f32_32x32x16_f16 v[96:111], v[92:95], a[28:31], v[96:111]
    s_nop 7
    s_nop 7
    s_nop 1
    v_cvt_pk_f16_f32 v80, v96, v97
    v_cvt_pk_f16_f32 v81, v98, v99
    v_cvt_pk_f16_f32 v82, v100, v101
    v_cvt_pk_f16_f32 v83, v102, v103
    v_cvt_pk_f16_f32 v84, v104, v105
    v_cvt_pk_f16_f32 v85, v106, v107
    v_cvt_pk_f16_f32 v86, v108, v109
    v_cvt_pk_f16_f32 v87, v110, v111
    ds_write_b64 v18, v[80:81] offset:2112
    ds_write_b64 v19, v[82:83] offset:2112
    ds_write_b64 v20, v[84:85] offset:2112
    ds_write_b64 v21, v[86:87] offset:2112
    v_lshlrev_b32 v32, 16, v152
    v_and_b32 v33, 0xffff0000, v152
    v_lshlrev_b32 v34, 16, v153
    v_and_b32 v35, 0xffff0000, v153
    v_lshlrev_b32 v36, 16, v154
    v_and_b32 v37, 0xffff0000, v154
    v_lshlrev_b32 v38, 16, v155
    v_and_b32 v39, 0xffff0000, v155
    v_lshlrev_b32 v40, 16, v156
    v_and_b32 v41, 0xffff0000, v156
    v_lshlrev_b32 v42, 16, v157
    v_and_b32 v43, 0xffff0000, v157
    v_lshlrev_b32 v44, 16, v158
    v_and_b32 v45, 0xffff0000, v158
    v_lshlrev_b32 v46, 16, v159
    v_and_b32 v47, 0xffff0000, v159
    v_pk_fma_f32 v[32:33], v[32:33], s[78:79], v[14:15] op_sel_hi:[1,0,0]
    v_pk_fma_f32 v[34:35], v[34:35], s[78:79], v[14:15] op_sel_hi:[1,0,0]
    v_pk_fma_f32 v[36:37], v[36:37], s[78:79], v[14:15] op_sel_hi:[1,0,0]
    v_pk_fma_f32 v[38:39], v[38:39], s[78:79], v[14:15] op_sel_hi:[1,0,0]
    v_pk_fma_f32 v[40:41], v[40:41], s[78:79], v[14:15] op_sel_hi:[1,0,0]
    v_pk_fma_f32 v[42:43], v[42:43], s[78:79], v[14:15] op_sel_hi:[1,0,0]
    v_pk_fma_f32 v[44:45], v[44:45], s[78:79], v[14:15] op_sel_hi:[1,0,0]
    v_pk_fma_f32 v[46:47], v[46:47], s[78:79], v[14:15] op_sel_hi:[1,0,0]
    v_cvt_pk_f16_f32 v32, v32, v33
    v_cvt_pk_f16_f32 v33, v34, v35
    v_cvt_pk_f16_f32 v34, v36, v37
    v_cvt_pk_f16_f32 v35, v38, v39
    v_cvt_pk_f16_f32 v36, v40, v41
    v_cvt_pk_f16_f32 v37, v42, v43
    v_cvt_pk_f16_f32 v38, v44, v45
    v_cvt_pk_f16_f32 v39, v46, v47
    ds_write_b128 v16, v[32:35] offset:6144
    ds_write_b128 v16, v[36:39] offset:7168
    s_waitcnt lgkmcnt(0)
    ds_read_b64_tr_b16 v[112:113], v17 offset:6144
    ds_read_b64_tr_b16 v[114:115], v17 offset:6400
    ds_read_b64_tr_b16 v[116:117], v17 offset:7168
    ds_read_b64_tr_b16 v[118:119], v17 offset:7424
    s_waitcnt lgkmcnt(0)
    v_mfma_f32_32x32x16_f16 v[48:63], v[112:115], a[0:3], 0
    v_mfma_f32_32x32x16_f16 v[64:79], v[112:115], a[4:7], 0
    v_mfma_f32_32x32x16_f16 v[48:63], v[116:119], a[8:11], v[48:63]
    v_mfma_f32_32x32x16_f16 v[64:79], v[116:119], a[12:15], v[64:79]
    s_nop 7
    s_nop 7
    s_nop 1
    v_pk_mul_f32 v[32:33], v[48:49], v[184:185]
    v_pk_mul_f32 v[34:35], v[64:65], v[184:185]
    v_pk_fma_f32 v[32:33], v[64:65], v[200:201], v[32:33]
    v_pk_fma_f32 v[34:35], v[48:49], v[200:201], v[34:35] neg_lo:[1,0,0] neg_hi:[1,0,0]
    v_cvt_pk_f16_f32 v80, v32, v33
    v_cvt_pk_f16_f32 v88, v34, v35
    v_pk_mul_f32 v[32:33], v[50:51], v[186:187]
    v_pk_mul_f32 v[34:35], v[66:67], v[186:187]
    v_pk_fma_f32 v[32:33], v[66:67], v[202:203], v[32:33]
    v_pk_fma_f32 v[34:35], v[50:51], v[202:203], v[34:35] neg_lo:[1,0,0] neg_hi:[1,0,0]
    v_cvt_pk_f16_f32 v81, v32, v33
    v_cvt_pk_f16_f32 v89, v34, v35
    v_pk_mul_f32 v[32:33], v[52:53], v[188:189]
    v_pk_mul_f32 v[34:35], v[68:69], v[188:189]
    v_pk_fma_f32 v[32:33], v[68:69], v[204:205], v[32:33]
    v_pk_fma_f32 v[34:35], v[52:53], v[204:205], v[34:35] neg_lo:[1,0,0] neg_hi:[1,0,0]
    v_cvt_pk_f16_f32 v82, v32, v33
    v_cvt_pk_f16_f32 v90, v34, v35
    v_pk_mul_f32 v[32:33], v[54:55], v[190:191]
    v_pk_mul_f32 v[34:35], v[70:71], v[190:191]
    v_pk_fma_f32 v[32:33], v[70:71], v[206:207], v[32:33]
    v_pk_fma_f32 v[34:35], v[54:55], v[206:207], v[34:35] neg_lo:[1,0,0] neg_hi:[1,0,0]
    v_cvt_pk_f16_f32 v83, v32, v33
    v_cvt_pk_f16_f32 v91, v34, v35
    v_pk_mul_f32 v[32:33], v[56:57], v[192:193]
    v_pk_mul_f32 v[34:35], v[72:73], v[192:193]
    v_pk_fma_f32 v[32:33], v[72:73], v[208:209], v[32:33]
    v_pk_fma_f32 v[34:35], v[56:57], v[208:209], v[34:35] neg_lo:[1,0,0] neg_hi:[1,0,0]
    v_cvt_pk_f16_f32 v84, v32, v33
    v_cvt_pk_f16_f32 v92, v34, v35
    v_pk_mul_f32 v[32:33], v[58:59], v[194:195]
    v_pk_mul_f32 v[34:35], v[74:75], v[194:195]
    v_pk_fma_f32 v[32:33], v[74:75], v[210:211], v[32:33]
    v_pk_fma_f32 v[34:35], v[58:59], v[210:211], v[34:35] neg_lo:[1,0,0] neg_hi:[1,0,0]
    v_cvt_pk_f16_f32 v85, v32, v33
    v_cvt_pk_f16_f32 v93, v34, v35
    v_pk_mul_f32 v[32:33], v[60:61], v[196:197]
    v_pk_mul_f32 v[34:35], v[76:77], v[196:197]
    v_pk_fma_f32 v[32:33], v[76:77], v[212:213], v[32:33]
    v_pk_fma_f32 v[34:35], v[60:61], v[212:213], v[34:35] neg_lo:[1,0,0] neg_hi:[1,0,0]
    v_cvt_pk_f16_f32 v86, v32, v33
    v_cvt_pk_f16_f32 v94, v34, v35
    v_pk_mul_f32 v[32:33], v[62:63], v[198:199]
    v_pk_mul_f32 v[34:35], v[78:79], v[198:199]
    v_pk_fma_f32 v[32:33], v[78:79], v[214:215], v[32:33]
    v_pk_fma_f32 v[34:35], v[62:63], v[214:215], v[34:35] neg_lo:[1,0,0] neg_hi:[1,0,0]
    v_cvt_pk_f16_f32 v87, v32, v33
    v_cvt_pk_f16_f32 v95, v34, v35
    s_nop 1
    v_mfma_f32_32x32x16_f16 v[96:111], v[80:83], a[16:19], 0
    v_mfma_f32_32x32x16_f16 v[96:111], v[88:91], a[20:23], v[96:111]
    v_mfma_f32_32x32x16_f16 v[96:111], v[84:87], a[24:27], v[96:111]
    v_mfma_f32_32x32x16_f16 v[96:111], v[92:95], a[28:31], v[96:111]
    s_nop 7
    s_nop 7
    s_nop 1
    v_cvt_pk_f16_f32 v80, v96, v97
    v_cvt_pk_f16_f32 v81, v98, v99
    v_cvt_pk_f16_f32 v82, v100, v101
    v_cvt_pk_f16_f32 v83, v102, v103
    v_cvt_pk_f16_f32 v84, v104, v105
    v_cvt_pk_f16_f32 v85, v106, v107
    v_cvt_pk_f16_f32 v86, v108, v109
    v_cvt_pk_f16_f32 v87, v110, v111
    ds_write_b64 v18, v[80:81] offset:3168
    ds_write_b64 v19, v[82:83] offset:3168
    ds_write_b64 v20, v[84:85] offset:3168
    ds_write_b64 v21, v[86:87] offset:3168
    s_add_u32 s62, s61, 32
    s_cmp_ge_u32 s62, 64
    s_cbranch_scc1 L_noload_recurr_22
    s_waitcnt vmcnt(0) lgkmcnt(0)
    s_barrier
    s_lshl_b32 s29, s62, 11
    s_add_u32 s29, s29, 0
    buffer_load_dwordx4 v[128:131], v22, s[8:11], s29 offen
    buffer_load_dwordx4 v[132:135], v22, s[8:11], s29 offen offset:1024
    s_lshl_b32 s29, s62, 11
    s_add_u32 s29, s29, 131072
    buffer_load_dwordx4 v[136:139], v22, s[8:11], s29 offen
    buffer_load_dwordx4 v[140:143], v22, s[8:11], s29 offen offset:1024
    s_lshl_b32 s29, s62, 11
    s_add_u32 s29, s29, 262144
    buffer_load_dwordx4 v[144:147], v22, s[8:11], s29 offen
    buffer_load_dwordx4 v[148:151], v22, s[8:11], s29 offen offset:1024
    s_lshl_b32 s29, s62, 11
    s_add_u32 s29, s29, 393216
    buffer_load_dwordx4 v[152:155], v22, s[8:11], s29 offen
    buffer_load_dwordx4 v[156:159], v22, s[8:11], s29 offen offset:1024
    s_cmp_lg_u32 s28, 0
    s_cbranch_scc1 L_loaded_recurr_23
    v_mov_b32 v120, 1
    v_mov_b32 v121, 4
    s_mov_b64 exec, 1
    buffer_atomic_add v120, v121, s[20:23], 0 offen sc1
    s_mov_b64 exec, -1
    s_branch L_loaded_recurr_23
L_noload_recurr_22:
    s_waitcnt lgkmcnt(0)
    s_barrier
L_loaded_recurr_23:
    s_mov_b32 s48, s28
L_fft_s1:
    s_lshr_b32 s50, s48, 1
    s_and_b32 s51, s48, 1
    s_lshl_b32 s51, s51, 2
    s_and_b32 s52, s50, 7
    s_xor_b32 s51, s51, s52
    v_xor_b32 v120, s51, v24
    v_lshl_add_u32 v120, v120, 3, v23
    s_lshl_b32 s50, s50, 6
    v_add_u32 v120, s50, v120
    ds_read_b64_tr_b16 v[32:33], v120 offset:0
    ds_read_b64_tr_b16 v[34:35], v120 offset:16896
    ds_read_b64_tr_b16 v[36:37], v120 offset:33792
    ds_read_b64_tr_b16 v[38:39], v120 offset:50688
    s_lshl_b32 s50, s48, 5
    v_add_u32 v121, s50, v25
    s_waitcnt lgkmcnt(0)
    v_mfma_f32_16x16x32_f16 v[48:51], v[32:35], v[160:163], 0
    v_mfma_f32_16x16x32_f16 v[52:55], v[36:39], v[160:163], 0
    v_mfma_f32_16x16x32_f16 v[56:59], v[32:35], v[164:167], 0
    v_mfma_f32_16x16x32_f16 v[60:63], v[36:39], v[164:167], 0
    v_mfma_f32_16x16x32_f16 v[48:51], v[36:39], v[168:171], v[48:51]
    v_mfma_f32_16x16x32_f16 v[52:55], v[32:35], v[176:179], v[52:55]
    v_mfma_f32_16x16x32_f16 v[56:59], v[36:39], v[172:175], v[56:59]
    v_mfma_f32_16x16x32_f16 v[60:63], v[32:35], v[180:183], v[60:63]
    s_nop 7
    v_pk_mul_f32 v[64:65], v[48:49], v[26:27] op_sel_hi:[1,0]
    v_pk_mul_f32 v[68:69], v[52:53], v[26:27] op_sel_hi:[1,0]
    v_pk_fma_f32 v[64:65], v[52:53], v[26:27], v[64:65] op_sel:[0,1,0] op_sel_hi:[1,1,1]
    v_pk_fma_f32 v[68:69], v[48:49], v[26:27], v[68:69] op_sel:[0,1,0] op_sel_hi:[1,1,1] neg_lo:[1,0,0] neg_hi:[1,0,0]
    v_pk_mul_f32 v[66:67], v[50:51], v[26:27] op_sel_hi:[1,0]
    v_pk_mul_f32 v[70:71], v[54:55], v[26:27] op_sel_hi:[1,0]
    v_pk_fma_f32 v[66:67], v[54:55], v[26:27], v[66:67] op_sel:[0,1,0] op_sel_hi:[1,1,1]
    v_pk_fma_f32 v[70:71], v[50:51], v[26:27], v[70:71] op_sel:[0,1,0] op_sel_hi:[1,1,1] neg_lo:[1,0,0] neg_hi:[1,0,0]
    v_cvt_pk_f16_f32 v80, v64, v65
    v_cvt_pk_f16_f32 v81, v66, v67
    v_cvt_pk_f16_f32 v82, v68, v69
    v_cvt_pk_f16_f32 v83, v70, v71
    ds_write_b64 v121, v[80:81] offset:0
    ds_write_b64 v121, v[82:83] offset:34304
    v_pk_mul_f32 v[72:73], v[56:57], v[28:29] op_sel_hi:[1,0]
    v_pk_mul_f32 v[76:77], v[60:61], v[28:29] op_sel_hi:[1,0]
    v_pk_fma_f32 v[72:73], v[60:61], v[28:29], v[72:73] op_sel:[0,1,0] op_sel_hi:[1,1,1]
    v_pk_fma_f32 v[76:77], v[56:57], v[28:29], v[76:77] op_sel:[0,1,0] op_sel_hi:[1,1,1] neg_lo:[1,0,0] neg_hi:[1,0,0]
    v_pk_mul_f32 v[74:75], v[58:59], v[28:29] op_sel_hi:[1,0]
    v_pk_mul_f32 v[78:79], v[62:63], v[28:29] op_sel_hi:[1,0]
    v_pk_fma_f32 v[74:75], v[62:63], v[28:29], v[74:75] op_sel:[0,1,0] op_sel_hi:[1,1,1]
    v_pk_fma_f32 v[78:79], v[58:59], v[28:29], v[78:79] op_sel:[0,1,0] op_sel_hi:[1,1,1] neg_lo:[1,0,0] neg_hi:[1,0,0]
    v_cvt_pk_f16_f32 v84, v72, v73
    v_cvt_pk_f16_f32 v85, v74, v75
    v_cvt_pk_f16_f32 v86, v76, v77
    v_cvt_pk_f16_f32 v87, v78, v79
    ds_write_b64 v121, v[84:85] offset:17152
    ds_write_b64 v121, v[86:87] offset:51456
    s_add_u32 s48, s48, 8
    s_cmp_lt_u32 s48, 33
    s_cbranch_scc1 L_fft_s1
    s_waitcnt lgkmcnt(0)
    s_barrier
    s_mul_i32 s50, s28, 8576
    v_add_u32 v120, s50, v3
    v_add_u32 v120, 67584, v120
    ds_read_b128 v[32:35], v120 offset:0
    ds_read_b128 v[36:39], v120 offset:1072
    ds_read_b128 v[40:43], v120 offset:2144
    ds_read_b128 v[44:47], v120 offset:3216
    ds_read_b128 v[48:51], v120 offset:4288
    ds_read_b128 v[52:55], v120 offset:5360
    ds_read_b128 v[56:59], v120 offset:6432
    ds_read_b128 v[60:63], v120 offset:7504
    v_lshrrev_b32 v121, 1, v2
    v_and_b32 v121, 7, v121
    s_movk_i32 s29, 1072
    v_mul_lo_u32 v122, v121, s29
    v_and_b32 v123, 1, v2
    v_lshl_add_u32 v122, v123, 4, v122
    v_add_u32 v122, s50, v122
    v_add_u32 v122, 68608, v122
    ds_read_b128 v[64:67], v122
    s_lshr_b32 s50, s28, 2
    s_and_b32 s51, s28, 3
    s_lshl_b32 s51, s51, 3
    s_lshl_b32 s51, s51, 1
    s_add_u32 s51, s51, s50
    s_lshl_b32 s51, s51, 6
    s_add_u32 s51, s51, s61
    v_lshlrev_b32 v121, 12, v121
    v_lshl_add_u32 v121, v123, 4, v121
    s_lshl_b32 s52, s51, 5
    s_lshl_b32 s51, s51, 10
    s_waitcnt lgkmcnt(0)
    buffer_store_dwordx4 v[32:35], v3, s[12:15], s51 offen sc1
    s_add_u32 s51, s51, 131072
    buffer_store_dwordx4 v[36:39], v3, s[12:15], s51 offen sc1
    s_add_u32 s51, s51, 131072
    buffer_store_dwordx4 v[40:43], v3, s[12:15], s51 offen sc1
    s_add_u32 s51, s51, 131072
    buffer_store_dwordx4 v[44:47], v3, s[12:15], s51 offen sc1
    s_add_u32 s51, s51, 131072
    buffer_store_dwordx4 v[48:51], v3, s[12:15], s51 offen sc1
    s_add_u32 s51, s51, 131072
    buffer_store_dwordx4 v[52:55], v3, s[12:15], s51 offen sc1
    s_add_u32 s51, s51, 131072
    buffer_store_dwordx4 v[56:59], v3, s[12:15], s51 offen sc1
    s_add_u32 s51, s51, 131072
    buffer_store_dwordx4 v[60:63], v3, s[12:15], s51 offen sc1
    s_add_u32 s51, s51, 131072
    s_mov_b64 exec, 0xffff
    buffer_store_dwordx4 v[64:67], v121, s[44:47], s52 offen sc1
    s_mov_b64 exec, -1
    s_barrier
    s_add_u32 s61, s61, 32
    s_cmp_lt_u32 s61, 64
    s_cbranch_scc1 L_fft_task
    s_lshl_b32 s50, s28, 10
L_tab_recurr_24:
    s_add_u32 m0, s50, 136192
    s_add_u32 s88, s42, s50
    s_addc_u32 s89, s43, 0
    s_add_u32 s88, s88, 22528
    s_addc_u32 s89, s89, 0
    global_load_lds_dwordx4 v3, s[88:89]
    s_add_u32 s50, s50, 8192
    s_cmp_lt_u32 s50, 16384
    s_cbranch_scc1 L_tab_recurr_24
    s_waitcnt vmcnt(0)
    s_barrier
    v_add_u32 v122, 136192, v3
    ds_read_b128 v[160:163], v122 offset:0
    ds_read_b128 v[164:167], v122 offset:1024
    ds_read_b128 v[168:171], v122 offset:2048
    ds_read_b128 v[172:175], v122 offset:3072
    ds_read_b128 v[176:179], v122 offset:4096
    ds_read_b128 v[180:183], v122 offset:5120
    ds_read_b128 v[184:187], v122 offset:6144
    ds_read_b128 v[188:191], v122 offset:7168
    ds_read_b128 v[192:195], v122 offset:8192
    ds_read_b128 v[196:199], v122 offset:9216
    ds_read_b128 v[200:203], v122 offset:10240
    ds_read_b128 v[204:207], v122 offset:11264
    ds_read_b128 v[208:211], v122 offset:12288
    ds_read_b128 v[212:215], v122 offset:13312
    ds_read_b128 v[216:219], v122 offset:14336
    ds_read_b128 v[220:223], v122 offset:15360
    s_cmp_lg_u32 s28, 0
    s_cbranch_scc1 L_fft_wait_done
    v_mov_b32 v120, 1
    v_mov_b32 v121, 0
    s_mov_b64 exec, 1
    buffer_atomic_add v120, v121, s[20:23], 0 offen sc1
    s_mov_b32 s100, 0x40000
L_fft_poll:
    s_sub_u32 s100, s100, 1
    s_cmp_eq_u32 s100, 0
    s_cbranch_scc1 L_fft_poll_done
    buffer_load_dword v120, v121, s[20:23], 0 offen sc1
    s_waitcnt vmcnt(0)
    v_readfirstlane_b32 s29, v120
    s_cmp_ge_u32 s29, 32
    s_cbranch_scc1 L_fft_poll_done
    s_sleep 1
    s_branch L_fft_poll
L_fft_poll_done:
    s_mov_b64 exec, -1
L_fft_wait_done:
    s_barrier
    s_lshl_b32 s49, s60, 17
    s_lshl_b32 s50, s28, 14
    s_add_u32 s49, s49, s50
    buffer_load_dwordx4 v[32:35], v3, s[12:15], s49 offen sc1
    s_add_u32 s49, s49, 1024
    buffer_load_dwordx4 v[36:39], v3, s[12:15], s49 offen sc1
    s_add_u32 s49, s49, 1024
    buffer_load_dwordx4 v[40:43], v3, s[12:15], s49 offen sc1
    s_add_u32 s49, s49, 1024
    buffer_load_dwordx4 v[44:47], v3, s[12:15], s49 offen sc1
    s_add_u32 s49, s49, 1024
    buffer_load_dwordx4 v[48:51], v3, s[12:15], s49 offen sc1
    s_add_u32 s49, s49, 1024
    buffer_load_dwordx4 v[52:55], v3, s[12:15], s49 offen sc1
    s_add_u32 s49, s49, 1024
    buffer_load_dwordx4 v[56:59], v3, s[12:15], s49 offen sc1
    s_add_u32 s49, s49, 1024
    buffer_load_dwordx4 v[60:63], v3, s[12:15], s49 offen sc1
    s_add_u32 s49, s49, 1024
    buffer_load_dwordx4 v[64:67], v3, s[12:15], s49 offen sc1
    s_add_u32 s49, s49, 1024
    buffer_load_dwordx4 v[68:71], v3, s[12:15], s49 offen sc1
    s_add_u32 s49, s49, 1024
    buffer_load_dwordx4 v[72:75], v3, s[12:15], s49 offen sc1
    s_add_u32 s49, s49, 1024
    buffer_load_dwordx4 v[76:79], v3, s[12:15], s49 offen sc1
    s_add_u32 s49, s49, 1024
    buffer_load_dwordx4 v[80:83], v3, s[12:15], s49 offen sc1
    s_add_u32 s49, s49, 1024
    buffer_load_dwordx4 v[84:87], v3, s[12:15], s49 offen sc1
    s_add_u32 s49, s49, 1024
    buffer_load_dwordx4 v[88:91], v3, s[12:15], s49 offen sc1
    s_add_u32 s49, s49, 1024
    buffer_load_dwordx4 v[92:95], v3, s[12:15], s49 offen sc1
    s_add_u32 s49, s49, 1024
    s_lshl_b32 s49, s60, 12
    s_lshl_b32 s50, s28, 9
    s_add_u32 s49, s49, s50
    buffer_load_dwordx4 v[96:99], v3, s[44:47], s49 offen sc1
    s_mul_i32 s50, s28, 16896
    v_add_u32 v120, s50, v3
    v_lshrrev_b32 v121, 1, v2
    s_movk_i32 s29, 1056
    v_mul_lo_u32 v121, v121, s29
    v_and_b32 v122, 1, v2
    v_lshl_add_u32 v121, v122, 4, v121
    v_add_u32 v121, s50, v121
    v_add_u32 v121, 1024, v121
    s_waitcnt vmcnt(16)
    ds_write_b128 v120, v[32:35] offset:0
    s_waitcnt vmcnt(15)
    ds_write_b128 v120, v[36:39] offset:1056
    s_waitcnt vmcnt(14)
    ds_write_b128 v120, v[40:43] offset:2112
    s_waitcnt vmcnt(13)
    ds_write_b128 v120, v[44:47] offset:3168
    s_waitcnt vmcnt(12)
    ds_write_b128 v120, v[48:51] offset:4224
    s_waitcnt vmcnt(11)
    ds_write_b128 v120, v[52:55] offset:5280
    s_waitcnt vmcnt(10)
    ds_write_b128 v120, v[56:59] offset:6336
    s_waitcnt vmcnt(9)
    ds_write_b128 v120, v[60:63] offset:7392
    s_waitcnt vmcnt(8)
    ds_write_b128 v120, v[64:67] offset:8448
    s_waitcnt vmcnt(7)
    ds_write_b128 v120, v[68:71] offset:9504
    s_waitcnt vmcnt(6)
    ds_write_b128 v120, v[72:75] offset:10560
    s_waitcnt vmcnt(5)
    ds_write_b128 v120, v[76:79] offset:11616
    s_waitcnt vmcnt(4)
    ds_write_b128 v120, v[80:83] offset:12672
    s_waitcnt vmcnt(3)
    ds_write_b128 v120, v[84:87] offset:13728
    s_waitcnt vmcnt(2)
    ds_write_b128 v120, v[88:91] offset:14784
    s_waitcnt vmcnt(1)
    ds_write_b128 v120, v[92:95] offset:15840
    s_waitcnt vmcnt(0)
    s_mov_b32 exec_hi, 0
    ds_write_b128 v121, v[96:99]
    s_mov_b64 exec, -1
    v_and_b32 v120, 15, v2
    v_lshrrev_b32 v121, 5, v2
    v_lshl_add_u32 v120, v121, 6, v120
    s_movk_i32 s29, 1056
    v_mul_lo_u32 v25, v120, s29
    v_bfe_u32 v120, v2, 4, 1
    v_lshl_add_u32 v25, v120, 4, v25
    v_lshl_add_u32 v23, v24, 3, v23
    s_waitcnt lgkmcnt(0)
    s_barrier
    s_mov_b32 s48, s28
L_fft_s2:
    s_lshl_b32 s50, s48, 5
    v_add_u32 v120, s50, v23
    v_add_u32 v121, 67584, v120
    ds_read_b64_tr_b16 v[32:33], v120 offset:0
    ds_read_b64_tr_b16 v[34:35], v120 offset:16896
    ds_read_b64_tr_b16 v[36:37], v120 offset:33792
    ds_read_b64_tr_b16 v[38:39], v120 offset:50688
    ds_read_b64_tr_b16 v[40:41], v121 offset:0
    ds_read_b64_tr_b16 v[42:43], v121 offset:16896
    ds_read_b64_tr_b16 v[44:45], v121 offset:33792
    ds_read_b64_tr_b16 v[46:47], v121 offset:50688
    v_add_u32 v122, s50, v25
    s_waitcnt lgkmcnt(0)
    v_mfma_f32_16x16x32_f16 v[48:51], v[32:35], v[160:163], 0
    v_mfma_f32_16x16x32_f16 v[52:55], v[32:35], v[168:171], 0
    v_mfma_f32_16x16x32_f16 v[56:59], v[32:35], v[176:179], 0
    v_mfma_f32_16x16x32_f16 v[60:63], v[32:35], v[184:187], 0
    v_mfma_f32_16x16x32_f16 v[48:51], v[40:43], v[164:167], v[48:51]
    v_mfma_f32_16x16x32_f16 v[52:55], v[40:43], v[172:175], v[52:55]
    v_mfma_f32_16x16x32_f16 v[56:59], v[40:43], v[180:183], v[56:59]
    v_mfma_f32_16x16x32_f16 v[60:63], v[40:43], v[188:191], v[60:63]
    v_mfma_f32_16x16x32_f16 v[48:51], v[36:39], v[192:195], v[48:51]
    v_mfma_f32_16x16x32_f16 v[52:55], v[36:39], v[200:203], v[52:55]
    v_mfma_f32_16x16x32_f16 v[56:59], v[36:39], v[208:211], v[56:59]
    v_mfma_f32_16x16x32_f16 v[60:63], v[36:39], v[216:219], v[60:63]
    v_mfma_f32_16x16x32_f16 v[48:51], v[44:47], v[196:199], v[48:51]
    v_mfma_f32_16x16x32_f16 v[52:55], v[44:47], v[204:207], v[52:55]
    v_mfma_f32_16x16x32_f16 v[56:59], v[44:47], v[212:215], v[56:59]
    v_mfma_f32_16x16x32_f16 v[60:63], v[44:47], v[220:223], v[60:63]
    s_nop 7
    ds_write_b128 v122, v[48:51] offset:0
    ds_write_b128 v122, v[52:55] offset:16896
    ds_write_b128 v122, v[56:59] offset:33792
    ds_write_b128 v122, v[60:63] offset:50688
    s_add_u32 s48, s48, 8
    s_cmp_lt_u32 s48, 33
    s_cbranch_scc1 L_fft_s2
    s_waitcnt lgkmcnt(0)
    s_barrier
    v_bfe_u32 v120, v2, 1, 1
    s_mov_b32 s29, 67584
    v_mul_lo_u32 v120, v120, s29
    v_lshrrev_b32 v121, 2, v2
    v_lshl_add_u32 v120, v121, 5, v120
    v_and_b32 v121, 1, v2
    v_lshl_add_u32 v120, v121, 4, v120
    s_mul_i32 s50, s28, 8448
    v_add_u32 v120, s50, v120
    ds_read_b128 v[32:35], v120 offset:0
    ds_read_b128 v[36:39], v120 offset:512
    ds_read_b128 v[40:43], v120 offset:1056
    ds_read_b128 v[44:47], v120 offset:1568
    ds_read_b128 v[48:51], v120 offset:2112
    ds_read_b128 v[52:55], v120 offset:2624
    ds_read_b128 v[56:59], v120 offset:3168
    ds_read_b128 v[60:63], v120 offset:3680
    ds_read_b128 v[64:67], v120 offset:4224
    ds_read_b128 v[68:71], v120 offset:4736
    ds_read_b128 v[72:75], v120 offset:5280
    ds_read_b128 v[76:79], v120 offset:5792
    ds_read_b128 v[80:83], v120 offset:6336
    ds_read_b128 v[84:87], v120 offset:6848
    ds_read_b128 v[88:91], v120 offset:7392
    ds_read_b128 v[92:95], v120 offset:7904
    s_movk_i32 s29, 1056
    v_and_b32 v122, 7, v2
    v_mul_lo_u32 v121, v122, s29
    v_add_u32 v121, s50, v121
    ds_read_b128 v[96:99], v121 offset:1024
    s_mul_i32 s51, s28, 557056
    s_mul_i32 s52, s60, 2176
    s_add_u32 s51, s51, s52
    s_mov_b32 s29, 69632
    v_mul_lo_u32 v122, v122, s29
    v_add_u32 v122, 2048, v122
    s_mov_b32 s52, s51
    s_waitcnt lgkmcnt(0)
    buffer_store_dwordx4 v[32:35], v3, s[16:19], s51 offen offset:0 sc1
    buffer_store_dwordx4 v[36:39], v3, s[16:19], s51 offen offset:1024 sc1
    s_add_u32 s51, s51, 69632
    buffer_store_dwordx4 v[40:43], v3, s[16:19], s51 offen offset:0 sc1
    buffer_store_dwordx4 v[44:47], v3, s[16:19], s51 offen offset:1024 sc1
    s_add_u32 s51, s51, 69632
    buffer_store_dwordx4 v[48:51], v3, s[16:19], s51 offen offset:0 sc1
    buffer_store_dwordx4 v[52:55], v3, s[16:19], s51 offen offset:1024 sc1
    s_add_u32 s51, s51, 69632
    buffer_store_dwordx4 v[56:59], v3, s[16:19], s51 offen offset:0 sc1
    buffer_store_dwordx4 v[60:63], v3, s[16:19], s51 offen offset:1024 sc1
    s_add_u32 s51, s51, 69632
    buffer_store_dwordx4 v[64:67], v3, s[16:19], s51 offen offset:0 sc1
    buffer_store_dwordx4 v[68:71], v3, s[16:19], s51 offen offset:1024 sc1
    s_add_u32 s51, s51, 69632
    buffer_store_dwordx4 v[72:75], v3, s[16:19], s51 offen offset:0 sc1
    buffer_store_dwordx4 v[76:79], v3, s[16:19], s51 offen offset:1024 sc1
    s_add_u32 s51, s51, 69632
    buffer_store_dwordx4 v[80:83], v3, s[16:19], s51 offen offset:0 sc1
    buffer_store_dwordx4 v[84:87], v3, s[16:19], s51 offen offset:1024 sc1
    s_add_u32 s51, s51, 69632
    buffer_store_dwordx4 v[88:91], v3, s[16:19], s51 offen offset:0 sc1
    buffer_store_dwordx4 v[92:95], v3, s[16:19], s51 offen offset:1024 sc1
    s_add_u32 s51, s51, 69632
    s_mov_b64 exec, 0xff
    buffer_store_dwordx4 v[96:99], v122, s[16:19], s52 offen sc1
    s_mov_b64 exec, -1
    s_branch L_hlp_end
L_hlp_end:
    s_waitcnt vmcnt(0)
    s_barrier
    s_cmp_lg_u32 s28, 0
    s_cbranch_scc1 L_g2_start
    s_add_u32 s20, s6, 0x2920000
    s_addc_u32 s21, s7, 0
    s_mov_b32 s22, 0x1000
    s_mov_b32 s23, 0x00020000
    v_mov_b32 v2, 1
    v_mov_b32 v3, 0
    s_movk_i32 s29, 2048
    s_mov_b64 exec, 1
    buffer_atomic_add v2, v3, s[20:23], s29 offen sc1
    s_mov_b64 exec, -1
L_g2_start:
    s_lshr_b32 s3, s2, 3
    s_and_b32 s24, s2, 7
    s_load_dwordx2 s[4:5], s[0:1], 88
    s_load_dwordx4 s[36:39], s[0:1], 64
    s_load_dwordx2 s[40:41], s[0:1], 0
    s_load_dwordx2 s[42:43], s[0:1], 80
    s_and_b32 s23, s24, 1
    s_bfe_u32 s25, s24, 0x10001
    s_lshl_b32 s25, s25, 3
    s_and_b32 s26, s3, 7
    s_add_u32 s25, s25, s26
    s_lshr_b32 s26, s24, 2
    s_lshl_b32 s26, s26, 2
    s_lshr_b32 s27, s3, 3
    s_add_u32 s26, s26, s27
    v_mbcnt_lo_u32_b32 v2, -1, 0
    v_mbcnt_hi_u32_b32 v2, -1, v2
    v_mov_b32 v1, s28
    v_lshlrev_b32 v3, 4, v2
    s_cmp_ge_u32 s28, 4
    s_cbranch_scc1 L_g2_loader
    s_waitcnt lgkmcnt(0)
    s_mov_b32 s16, s38
    s_mov_b32 s17, s39
    s_mov_b32 s18, 0x400000
    s_mov_b32 s19, 0x00020000
    s_mov_b32 s80, s40
    s_mov_b32 s81, s41
    s_mov_b32 s82, 0x400000
    s_mov_b32 s83, 0x00020000
    s_add_u32 s52, s4, 0x1400000
    s_addc_u32 s53, s5, 0
    s_mov_b32 s54, 0x440000
    s_mov_b32 s55, 0x00020000
    s_add_u32 s56, s4, 0x2000000
    s_addc_u32 s57, s5, 0
    s_mov_b32 s58, 0x800000
    s_mov_b32 s59, 0x00020000
    s_mov_b32 s60, s42
    s_mov_b32 s61, s43
    s_mov_b32 s62, 0x100
    s_mov_b32 s63, 0x00020000
    s_add_u32 s76, s4, 0x2900000
    s_addc_u32 s77, s5, 0
    s_mov_b32 s78, 0x20000
    s_mov_b32 s79, 0x00020000
    v_lshrrev_b32 v16, 1, v1
    v_lshl_add_u32 v8, v16, 12, v3
    v_lshrrev_b32 v16, 2, v2
    v_and_b32 v17, 7, v16
    v_and_b32 v18, 3, v2
    v_lshlrev_b32 v19, 8, v16
    v_lshl_add_u32 v19, v18, 3, v19
    v_add_u32 v19, 16384, v19
    v_and_b32 v18, 1, v1
    v_lshlrev_b32 v18, 2, v18
    v_add_u32 v20, 0, v18
    v_xor_b32 v20, v20, v17
    v_lshl_add_u32 v10, v20, 5, v19
    v_add_u32 v20, 1, v18
    v_xor_b32 v20, v20, v17
    v_lshl_add_u32 v11, v20, 5, v19
    v_add_u32 v20, 2, v18
    v_xor_b32 v20, v20, v17
    v_lshl_add_u32 v12, v20, 5, v19
    v_add_u32 v20, 3, v18
    v_xor_b32 v20, v20, v17
    v_lshl_add_u32 v13, v20, 5, v19
    v_mov_b32 v160, 0
    v_mov_b32 v161, 0
    v_mov_b32 v162, 0
    v_mov_b32 v163, 0
    v_mov_b32 v164, 0
    v_mov_b32 v165, 0
    v_mov_b32 v166, 0
    v_mov_b32 v167, 0
    v_mov_b32 v168, 0
    v_mov_b32 v169, 0
    v_mov_b32 v170, 0
    v_mov_b32 v171, 0
    v_mov_b32 v172, 0
    v_mov_b32 v173, 0
    v_mov_b32 v174, 0
    v_mov_b32 v175, 0
    v_mov_b32 v176, 0
    v_mov_b32 v177, 0
    v_mov_b32 v178, 0
    v_mov_b32 v179, 0
    v_mov_b32 v180, 0
    v_mov_b32 v181, 0
    v_mov_b32 v182, 0
    v_mov_b32 v183, 0
    v_mov_b32 v184, 0
    v_mov_b32 v185, 0
    v_mov_b32 v186, 0
    v_mov_b32 v187, 0
    v_mov_b32 v188, 0
    v_mov_b32 v189, 0
    v_mov_b32 v190, 0
    v_mov_b32 v191, 0
    v_mov_b32 v192, 0
    v_mov_b32 v193, 0
    v_mov_b32 v194, 0
    v_mov_b32 v195, 0
    v_mov_b32 v196, 0
    v_mov_b32 v197, 0
    v_mov_b32 v198, 0
    v_mov_b32 v199, 0
    v_mov_b32 v200, 0
    v_mov_b32 v201, 0
    v_mov_b32 v202, 0
    v_mov_b32 v203, 0
    v_mov_b32 v204, 0
    v_mov_b32 v205, 0
    v_mov_b32 v206, 0
    v_mov_b32 v207, 0
    v_mov_b32 v208, 0
    v_mov_b32 v209, 0
    v_mov_b32 v210, 0
    v_mov_b32 v211, 0
    v_mov_b32 v212, 0
    v_mov_b32 v213, 0
    v_mov_b32 v214, 0
    v_mov_b32 v215, 0
    v_mov_b32 v216, 0
    v_mov_b32 v217, 0
    v_mov_b32 v218, 0
    v_mov_b32 v219, 0
    v_mov_b32 v220, 0
    v_mov_b32 v221, 0
    v_mov_b32 v222, 0
    v_mov_b32 v223, 0
    s_barrier
    s_barrier
    ds_read_b64_tr_b16 v[32:33], v10 offset:0
    ds_read_b64_tr_b16 v[34:35], v10 offset:4096
    ds_read_b128 v[64:67], v8 offset:0
    ds_read_b128 v[68:71], v8 offset:1024
    ds_read_b128 v[72:75], v8 offset:2048
    ds_read_b128 v[76:79], v8 offset:3072
    ds_read_b64_tr_b16 v[36:37], v11 offset:0
    ds_read_b64_tr_b16 v[38:39], v11 offset:4096
    ds_read_b64_tr_b16 v[40:41], v12 offset:0
    ds_read_b64_tr_b16 v[42:43], v12 offset:4096
    ds_read_b64_tr_b16 v[44:45], v13 offset:0
    ds_read_b64_tr_b16 v[46:47], v13 offset:4096
    ds_read_b64_tr_b16 v[48:49], v10 offset:8192
    ds_read_b64_tr_b16 v[50:51], v10 offset:12288
    ds_read_b128 v[80:83], v8 offset:8192
    ds_read_b128 v[84:87], v8 offset:9216
    ds_read_b128 v[88:91], v8 offset:10240
    ds_read_b128 v[92:95], v8 offset:11264
    ds_read_b64_tr_b16 v[52:53], v11 offset:8192
    ds_read_b64_tr_b16 v[54:55], v11 offset:12288
    ds_read_b64_tr_b16 v[56:57], v12 offset:8192
    ds_read_b64_tr_b16 v[58:59], v12 offset:12288
    ds_read_b64_tr_b16 v[60:61], v13 offset:8192
    ds_read_b64_tr_b16 v[62:63], v13 offset:12288
    s_mov_b32 s35, 0
    s_mov_b32 s68, 4294836224
    s_mov_b32 s69, 32768
    s_mov_b32 s70, 13
L_g2_cloop:
    s_waitcnt lgkmcnt(0)
    s_barrier
    v_mfma_f32_16x16x32_bf16 v[160:163], v[32:35], v[64:67], v[160:163]
    s_add_u32 s35, s35, 32768
    s_cmp_eq_u32 s35, 163840
    s_cselect_b32 s29, s68, s69
    s_cselect_b32 s35, 0, s35
    v_add_u32 v10, s29, v10
    v_add_u32 v8, s29, v8
    v_mfma_f32_16x16x32_bf16 v[176:179], v[32:35], v[68:71], v[176:179]
    v_add_u32 v11, s29, v11
    v_add_u32 v12, s29, v12
    v_add_u32 v13, s29, v13
    v_mfma_f32_16x16x32_bf16 v[192:195], v[32:35], v[72:75], v[192:195]
    ds_read_b64_tr_b16 v[96:97], v10 offset:0
    ds_read_b64_tr_b16 v[98:99], v10 offset:4096
    v_mfma_f32_16x16x32_bf16 v[208:211], v[32:35], v[76:79], v[208:211]
    ds_read_b128 v[128:131], v8 offset:0
    v_mfma_f32_16x16x32_bf16 v[164:167], v[36:39], v[64:67], v[164:167]
    ds_read_b128 v[132:135], v8 offset:1024
    v_mfma_f32_16x16x32_bf16 v[180:183], v[36:39], v[68:71], v[180:183]
    ds_read_b128 v[136:139], v8 offset:2048
    v_mfma_f32_16x16x32_bf16 v[196:199], v[36:39], v[72:75], v[196:199]
    ds_read_b128 v[140:143], v8 offset:3072
    v_mfma_f32_16x16x32_bf16 v[212:215], v[36:39], v[76:79], v[212:215]
    ds_read_b64_tr_b16 v[100:101], v11 offset:0
    v_mfma_f32_16x16x32_bf16 v[168:171], v[40:43], v[64:67], v[168:171]
    ds_read_b64_tr_b16 v[102:103], v11 offset:4096
    v_mfma_f32_16x16x32_bf16 v[184:187], v[40:43], v[68:71], v[184:187]
    ds_read_b64_tr_b16 v[104:105], v12 offset:0
    v_mfma_f32_16x16x32_bf16 v[200:203], v[40:43], v[72:75], v[200:203]
    ds_read_b64_tr_b16 v[106:107], v12 offset:4096
    v_mfma_f32_16x16x32_bf16 v[216:219], v[40:43], v[76:79], v[216:219]
    ds_read_b64_tr_b16 v[108:109], v13 offset:0
    ds_read_b64_tr_b16 v[110:111], v13 offset:4096
    v_mfma_f32_16x16x32_bf16 v[172:175], v[44:47], v[64:67], v[172:175]
    ds_read_b64_tr_b16 v[112:113], v10 offset:8192
    v_mfma_f32_16x16x32_bf16 v[188:191], v[44:47], v[68:71], v[188:191]
    ds_read_b64_tr_b16 v[114:115], v10 offset:12288
    v_mfma_f32_16x16x32_bf16 v[204:207], v[44:47], v[72:75], v[204:207]
    ds_read_b128 v[144:147], v8 offset:8192
    v_mfma_f32_16x16x32_bf16 v[220:223], v[44:47], v[76:79], v[220:223]
    ds_read_b128 v[148:151], v8 offset:9216
    v_mfma_f32_16x16x32_bf16 v[160:163], v[48:51], v[80:83], v[160:163]
    ds_read_b128 v[152:155], v8 offset:10240
    v_mfma_f32_16x16x32_bf16 v[176:179], v[48:51], v[84:87], v[176:179]
    ds_read_b128 v[156:159], v8 offset:11264
    v_mfma_f32_16x16x32_bf16 v[192:195], v[48:51], v[88:91], v[192:195]
    ds_read_b64_tr_b16 v[116:117], v11 offset:8192
    v_mfma_f32_16x16x32_bf16 v[208:211], v[48:51], v[92:95], v[208:211]
    ds_read_b64_tr_b16 v[118:119], v11 offset:12288
    v_mfma_f32_16x16x32_bf16 v[164:167], v[52:55], v[80:83], v[164:167]
    ds_read_b64_tr_b16 v[120:121], v12 offset:8192
    ds_read_b64_tr_b16 v[122:123], v12 offset:12288
    v_mfma_f32_16x16x32_bf16 v[180:183], v[52:55], v[84:87], v[180:183]
    ds_read_b64_tr_b16 v[124:125], v13 offset:8192
    v_mfma_f32_16x16x32_bf16 v[196:199], v[52:55], v[88:91], v[196:199]
    ds_read_b64_tr_b16 v[126:127], v13 offset:12288
    v_mfma_f32_16x16x32_bf16 v[212:215], v[52:55], v[92:95], v[212:215]
    v_mfma_f32_16x16x32_bf16 v[168:171], v[56:59], v[80:83], v[168:171]
    v_mfma_f32_16x16x32_bf16 v[184:187], v[56:59], v[84:87], v[184:187]
    v_mfma_f32_16x16x32_bf16 v[200:203], v[56:59], v[88:91], v[200:203]
    v_mfma_f32_16x16x32_bf16 v[216:219], v[56:59], v[92:95], v[216:219]
    v_mfma_f32_16x16x32_bf16 v[172:175], v[60:63], v[80:83], v[172:175]
    v_mfma_f32_16x16x32_bf16 v[188:191], v[60:63], v[84:87], v[188:191]
    v_mfma_f32_16x16x32_bf16 v[204:207], v[60:63], v[88:91], v[204:207]
    v_mfma_f32_16x16x32_bf16 v[220:223], v[60:63], v[92:95], v[220:223]
    s_waitcnt lgkmcnt(0)
    s_barrier
    v_mfma_f32_16x16x32_bf16 v[160:163], v[96:99], v[128:131], v[160:163]
    s_add_u32 s35, s35, 32768
    s_cmp_eq_u32 s35, 163840
    s_cselect_b32 s29, s68, s69
    s_cselect_b32 s35, 0, s35
    v_add_u32 v10, s29, v10
    v_add_u32 v8, s29, v8
    v_mfma_f32_16x16x32_bf16 v[176:179], v[96:99], v[132:135], v[176:179]
    v_add_u32 v11, s29, v11
    v_add_u32 v12, s29, v12
    v_add_u32 v13, s29, v13
    v_mfma_f32_16x16x32_bf16 v[192:195], v[96:99], v[136:139], v[192:195]
    ds_read_b64_tr_b16 v[32:33], v10 offset:0
    ds_read_b64_tr_b16 v[34:35], v10 offset:4096
    v_mfma_f32_16x16x32_bf16 v[208:211], v[96:99], v[140:143], v[208:211]
    ds_read_b128 v[64:67], v8 offset:0
    v_mfma_f32_16x16x32_bf16 v[164:167], v[100:103], v[128:131], v[164:167]
    ds_read_b128 v[68:71], v8 offset:1024
    v_mfma_f32_16x16x32_bf16 v[180:183], v[100:103], v[132:135], v[180:183]
    ds_read_b128 v[72:75], v8 offset:2048
    v_mfma_f32_16x16x32_bf16 v[196:199], v[100:103], v[136:139], v[196:199]
    ds_read_b128 v[76:79], v8 offset:3072
    v_mfma_f32_16x16x32_bf16 v[212:215], v[100:103], v[140:143], v[212:215]
    ds_read_b64_tr_b16 v[36:37], v11 offset:0
    v_mfma_f32_16x16x32_bf16 v[168:171], v[104:107], v[128:131], v[168:171]
    ds_read_b64_tr_b16 v[38:39], v11 offset:4096
    v_mfma_f32_16x16x32_bf16 v[184:187], v[104:107], v[132:135], v[184:187]
    ds_read_b64_tr_b16 v[40:41], v12 offset:0
    v_mfma_f32_16x16x32_bf16 v[200:203], v[104:107], v[136:139], v[200:203]
    ds_read_b64_tr_b16 v[42:43], v12 offset:4096
    v_mfma_f32_16x16x32_bf16 v[216:219], v[104:107], v[140:143], v[216:219]
    ds_read_b64_tr_b16 v[44:45], v13 offset:0
    ds_read_b64_tr_b16 v[46:47], v13 offset:4096
    v_mfma_f32_16x16x32_bf16 v[172:175], v[108:111], v[128:131], v[172:175]
    ds_read_b64_tr_b16 v[48:49], v10 offset:8192
    v_mfma_f32_16x16x32_bf16 v[188:191], v[108:111], v[132:135], v[188:191]
    ds_read_b64_tr_b16 v[50:51], v10 offset:12288
    v_mfma_f32_16x16x32_bf16 v[204:207], v[108:111], v[136:139], v[204:207]
    ds_read_b128 v[80:83], v8 offset:8192
    v_mfma_f32_16x16x32_bf16 v[220:223], v[108:111], v[140:143], v[220:223]
    ds_read_b128 v[84:87], v8 offset:9216
    v_mfma_f32_16x16x32_bf16 v[160:163], v[112:115], v[144:147], v[160:163]
    ds_read_b128 v[88:91], v8 offset:10240
    v_mfma_f32_16x16x32_bf16 v[176:179], v[112:115], v[148:151], v[176:179]
    ds_read_b128 v[92:95], v8 offset:11264
    v_mfma_f32_16x16x32_bf16 v[192:195], v[112:115], v[152:155], v[192:195]
    ds_read_b64_tr_b16 v[52:53], v11 offset:8192
    v_mfma_f32_16x16x32_bf16 v[208:211], v[112:115], v[156:159], v[208:211]
    ds_read_b64_tr_b16 v[54:55], v11 offset:12288
    v_mfma_f32_16x16x32_bf16 v[164:167], v[116:119], v[144:147], v[164:167]
    ds_read_b64_tr_b16 v[56:57], v12 offset:8192
    ds_read_b64_tr_b16 v[58:59], v12 offset:12288
    v_mfma_f32_16x16x32_bf16 v[180:183], v[116:119], v[148:151], v[180:183]
    ds_read_b64_tr_b16 v[60:61], v13 offset:8192
    v_mfma_f32_16x16x32_bf16 v[196:199], v[116:119], v[152:155], v[196:199]
    ds_read_b64_tr_b16 v[62:63], v13 offset:12288
    v_mfma_f32_16x16x32_bf16 v[212:215], v[116:119], v[156:159], v[212:215]
    v_mfma_f32_16x16x32_bf16 v[168:171], v[120:123], v[144:147], v[168:171]
    v_mfma_f32_16x16x32_bf16 v[184:187], v[120:123], v[148:151], v[184:187]
    v_mfma_f32_16x16x32_bf16 v[200:203], v[120:123], v[152:155], v[200:203]
    v_mfma_f32_16x16x32_bf16 v[216:219], v[120:123], v[156:159], v[216:219]
    v_mfma_f32_16x16x32_bf16 v[172:175], v[124:127], v[144:147], v[172:175]
    v_mfma_f32_16x16x32_bf16 v[188:191], v[124:127], v[148:151], v[188:191]
    v_mfma_f32_16x16x32_bf16 v[204:207], v[124:127], v[152:155], v[204:207]
    v_mfma_f32_16x16x32_bf16 v[220:223], v[124:127], v[156:159], v[220:223]
    s_sub_u32 s70, s70, 1
    s_cmp_lg_u32 s70, 0
    s_cbranch_scc1 L_g2_cloop
    s_waitcnt lgkmcnt(0)
    s_barrier
    v_mfma_f32_16x16x32_bf16 v[160:163], v[32:35], v[64:67], v[160:163]
    s_add_u32 s35, s35, 32768
    s_cmp_eq_u32 s35, 163840
    s_cselect_b32 s29, s68, s69
    s_cselect_b32 s35, 0, s35
    v_add_u32 v10, s29, v10
    v_add_u32 v8, s29, v8
    v_mfma_f32_16x16x32_bf16 v[176:179], v[32:35], v[68:71], v[176:179]
    v_add_u32 v11, s29, v11
    v_add_u32 v12, s29, v12
    v_add_u32 v13, s29, v13
    v_mfma_f32_16x16x32_bf16 v[192:195], v[32:35], v[72:75], v[192:195]
    ds_read_b64_tr_b16 v[96:97], v10 offset:0
    ds_read_b64_tr_b16 v[98:99], v10 offset:4096
    v_mfma_f32_16x16x32_bf16 v[208:211], v[32:35], v[76:79], v[208:211]
    ds_read_b128 v[128:131], v8 offset:0
    v_mfma_f32_16x16x32_bf16 v[164:167], v[36:39], v[64:67], v[164:167]
    ds_read_b128 v[132:135], v8 offset:1024
    v_mfma_f32_16x16x32_bf16 v[180:183], v[36:39], v[68:71], v[180:183]
    ds_read_b128 v[136:139], v8 offset:2048
    v_mfma_f32_16x16x32_bf16 v[196:199], v[36:39], v[72:75], v[196:199]
    ds_read_b128 v[140:143], v8 offset:3072
    v_mfma_f32_16x16x32_bf16 v[212:215], v[36:39], v[76:79], v[212:215]
    ds_read_b64_tr_b16 v[100:101], v11 offset:0
    v_mfma_f32_16x16x32_bf16 v[168:171], v[40:43], v[64:67], v[168:171]
    ds_read_b64_tr_b16 v[102:103], v11 offset:4096
    v_mfma_f32_16x16x32_bf16 v[184:187], v[40:43], v[68:71], v[184:187]
    ds_read_b64_tr_b16 v[104:105], v12 offset:0
    v_mfma_f32_16x16x32_bf16 v[200:203], v[40:43], v[72:75], v[200:203]
    ds_read_b64_tr_b16 v[106:107], v12 offset:4096
    v_mfma_f32_16x16x32_bf16 v[216:219], v[40:43], v[76:79], v[216:219]
    ds_read_b64_tr_b16 v[108:109], v13 offset:0
    ds_read_b64_tr_b16 v[110:111], v13 offset:4096
    v_mfma_f32_16x16x32_bf16 v[172:175], v[44:47], v[64:67], v[172:175]
    ds_read_b64_tr_b16 v[112:113], v10 offset:8192
    v_mfma_f32_16x16x32_bf16 v[188:191], v[44:47], v[68:71], v[188:191]
    ds_read_b64_tr_b16 v[114:115], v10 offset:12288
    v_mfma_f32_16x16x32_bf16 v[204:207], v[44:47], v[72:75], v[204:207]
    ds_read_b128 v[144:147], v8 offset:8192
    v_mfma_f32_16x16x32_bf16 v[220:223], v[44:47], v[76:79], v[220:223]
    ds_read_b128 v[148:151], v8 offset:9216
    v_mfma_f32_16x16x32_bf16 v[160:163], v[48:51], v[80:83], v[160:163]
    ds_read_b128 v[152:155], v8 offset:10240
    v_mfma_f32_16x16x32_bf16 v[176:179], v[48:51], v[84:87], v[176:179]
    ds_read_b128 v[156:159], v8 offset:11264
    v_mfma_f32_16x16x32_bf16 v[192:195], v[48:51], v[88:91], v[192:195]
    ds_read_b64_tr_b16 v[116:117], v11 offset:8192
    v_mfma_f32_16x16x32_bf16 v[208:211], v[48:51], v[92:95], v[208:211]
    ds_read_b64_tr_b16 v[118:119], v11 offset:12288
    v_mfma_f32_16x16x32_bf16 v[164:167], v[52:55], v[80:83], v[164:167]
    ds_read_b64_tr_b16 v[120:121], v12 offset:8192
    ds_read_b64_tr_b16 v[122:123], v12 offset:12288
    v_mfma_f32_16x16x32_bf16 v[180:183], v[52:55], v[84:87], v[180:183]
    ds_read_b64_tr_b16 v[124:125], v13 offset:8192
    v_mfma_f32_16x16x32_bf16 v[196:199], v[52:55], v[88:91], v[196:199]
    ds_read_b64_tr_b16 v[126:127], v13 offset:12288
    v_mfma_f32_16x16x32_bf16 v[212:215], v[52:55], v[92:95], v[212:215]
    v_mfma_f32_16x16x32_bf16 v[168:171], v[56:59], v[80:83], v[168:171]
    v_mfma_f32_16x16x32_bf16 v[184:187], v[56:59], v[84:87], v[184:187]
    v_mfma_f32_16x16x32_bf16 v[200:203], v[56:59], v[88:91], v[200:203]
    v_mfma_f32_16x16x32_bf16 v[216:219], v[56:59], v[92:95], v[216:219]
    v_mfma_f32_16x16x32_bf16 v[172:175], v[60:63], v[80:83], v[172:175]
    v_mfma_f32_16x16x32_bf16 v[188:191], v[60:63], v[84:87], v[188:191]
    v_mfma_f32_16x16x32_bf16 v[204:207], v[60:63], v[88:91], v[204:207]
    v_mfma_f32_16x16x32_bf16 v[220:223], v[60:63], v[92:95], v[220:223]
    s_waitcnt lgkmcnt(0)
    s_barrier
    s_lshl_b32 s29, s2, 2
    s_add_u32 s29, s29, s28
    s_lshl_b32 s74, s29, 13
    s_xor_b32 s75, s74, 0x8000
    s_lshl_b32 s86, s29, 6
    s_xor_b32 s87, s86, 256
    v_and_b32 v4, 15, v2
    v_bfe_u32 v5, v1, 1, 1
    v_lshl_add_u32 v4, v5, 6, v4
    s_lshl_b32 s29, s25, 7
    s_lshl_b32 s38, s23, 5
    s_add_u32 s29, s29, s38
    s_add_u32 s29, s29, 0
    v_add_u32 v4, s29, v4
    v_lshrrev_b32 v5, 4, v2
    v_lshlrev_b32 v5, 2, v5
    v_and_b32 v6, 1, v1
    v_lshl_add_u32 v5, v6, 6, v5
    s_lshl_b32 s29, s26, 7
    v_add_u32 v5, s29, v5
    v_lshlrev_b32 v6, 11, v4
    v_lshl_add_u32 v6, v5, 1, v6
    s_movk_i32 s29, 2176
    s_cmp_ge_u32 s26, 4
    s_cbranch_scc1 L_mir_recurr_25
    v_mul_lo_u32 v7, v4, s29
    v_lshl_add_u32 v7, v5, 2, v7
    buffer_load_dwordx4 v[32:35], v7, s[52:55], 0 offen offset:0 sc1
    buffer_load_dwordx4 v[36:39], v7, s[52:55], 0 offen offset:64 sc1
    buffer_load_dwordx4 v[40:43], v7, s[52:55], 0 offen offset:128 sc1
    buffer_load_dwordx4 v[44:47], v7, s[52:55], 0 offen offset:192 sc1
    s_branch L_md_recurr_26
L_mir_recurr_25:
    v_sub_u32 v20, 1021, v5
    v_sub_u32 v21, 2048, v4
    v_and_b32 v21, 2047, v21
    v_mul_lo_u32 v7, v21, s29
    v_lshl_add_u32 v7, v20, 2, v7
    v_subrev_u32 v7, 192, v7
    buffer_load_dwordx4 v[32:35], v7, s[52:55], 0 offen offset:192 sc1
    buffer_load_dwordx4 v[36:39], v7, s[52:55], 0 offen offset:128 sc1
    buffer_load_dwordx4 v[40:43], v7, s[52:55], 0 offen offset:64 sc1
    buffer_load_dwordx4 v[44:47], v7, s[52:55], 0 offen offset:0 sc1
L_md_recurr_26:
    buffer_load_dwordx2 v[48:49], v6, s[80:83], 0 offen offset:0
    buffer_load_dwordx2 v[50:51], v6, s[80:83], 0 offen offset:32
    buffer_load_dwordx2 v[52:53], v6, s[80:83], 0 offen offset:64
    buffer_load_dwordx2 v[54:55], v6, s[80:83], 0 offen offset:96
    s_lshl_b32 s29, s28, 12
    v_add_u32 v9, s29, v3
    s_cmp_eq_u32 s23, 0
    s_cbranch_scc0 L_g2_tail1
    v_mfma_f32_16x16x32_bf16 v[192:195], v[96:99], v[136:139], v[192:195]
    v_mfma_f32_16x16x32_bf16 v[208:211], v[96:99], v[140:143], v[208:211]
    v_mfma_f32_16x16x32_bf16 v[196:199], v[100:103], v[136:139], v[196:199]
    v_mfma_f32_16x16x32_bf16 v[212:215], v[100:103], v[140:143], v[212:215]
    v_mfma_f32_16x16x32_bf16 v[200:203], v[104:107], v[136:139], v[200:203]
    v_mfma_f32_16x16x32_bf16 v[216:219], v[104:107], v[140:143], v[216:219]
    v_mfma_f32_16x16x32_bf16 v[204:207], v[108:111], v[136:139], v[204:207]
    v_mfma_f32_16x16x32_bf16 v[220:223], v[108:111], v[140:143], v[220:223]
    v_mfma_f32_16x16x32_bf16 v[192:195], v[112:115], v[152:155], v[192:195]
    v_mfma_f32_16x16x32_bf16 v[208:211], v[112:115], v[156:159], v[208:211]
    v_mfma_f32_16x16x32_bf16 v[196:199], v[116:119], v[152:155], v[196:199]
    v_mfma_f32_16x16x32_bf16 v[212:215], v[116:119], v[156:159], v[212:215]
    v_mfma_f32_16x16x32_bf16 v[200:203], v[120:123], v[152:155], v[200:203]
    v_mfma_f32_16x16x32_bf16 v[216:219], v[120:123], v[156:159], v[216:219]
    v_mfma_f32_16x16x32_bf16 v[204:207], v[124:127], v[152:155], v[204:207]
    v_mfma_f32_16x16x32_bf16 v[220:223], v[124:127], v[156:159], v[220:223]
    v_mfma_f32_16x16x32_bf16 v[160:163], v[96:99], v[128:131], v[160:163]
    v_mfma_f32_16x16x32_bf16 v[176:179], v[96:99], v[132:135], v[176:179]
    v_mfma_f32_16x16x32_bf16 v[164:167], v[100:103], v[128:131], v[164:167]
    v_mfma_f32_16x16x32_bf16 v[180:183], v[100:103], v[132:135], v[180:183]
    v_mfma_f32_16x16x32_bf16 v[168:171], v[104:107], v[128:131], v[168:171]
    v_mfma_f32_16x16x32_bf16 v[184:187], v[104:107], v[132:135], v[184:187]
    v_mfma_f32_16x16x32_bf16 v[172:175], v[108:111], v[128:131], v[172:175]
    v_mfma_f32_16x16x32_bf16 v[188:191], v[108:111], v[132:135], v[188:191]
    v_mfma_f32_16x16x32_bf16 v[160:163], v[112:115], v[144:147], v[160:163]
    buffer_store_dwordx4 v[192:195], v3, s[56:59], s74 offen offset:0 sc1
    v_mfma_f32_16x16x32_bf16 v[176:179], v[112:115], v[148:151], v[176:179]
    buffer_store_dwordx4 v[196:199], v3, s[56:59], s74 offen offset:1024 sc1
    v_mfma_f32_16x16x32_bf16 v[164:167], v[116:119], v[144:147], v[164:167]
    buffer_store_dwordx4 v[200:203], v3, s[56:59], s74 offen offset:2048 sc1
    v_mfma_f32_16x16x32_bf16 v[180:183], v[116:119], v[148:151], v[180:183]
    buffer_store_dwordx4 v[204:207], v3, s[56:59], s74 offen offset:3072 sc1
    v_mfma_f32_16x16x32_bf16 v[168:171], v[120:123], v[144:147], v[168:171]
    s_add_u32 s74, s74, 4096
    buffer_store_dwordx4 v[208:211], v3, s[56:59], s74 offen offset:0 sc1
    v_mfma_f32_16x16x32_bf16 v[184:187], v[120:123], v[148:151], v[184:187]
    buffer_store_dwordx4 v[212:215], v3, s[56:59], s74 offen offset:1024 sc1
    v_mfma_f32_16x16x32_bf16 v[172:175], v[124:127], v[144:147], v[172:175]
    buffer_store_dwordx4 v[216:219], v3, s[56:59], s74 offen offset:2048 sc1
    v_mfma_f32_16x16x32_bf16 v[188:191], v[124:127], v[148:151], v[188:191]
    buffer_store_dwordx4 v[220:223], v3, s[56:59], s74 offen offset:3072 sc1
    s_nop 15
    ds_write_b128 v9, v[176:179] offset:0
    ds_write_b128 v9, v[180:183] offset:1024
    ds_write_b128 v9, v[184:187] offset:2048
    ds_write_b128 v9, v[188:191] offset:3072
    s_branch L_g2_tailj
L_g2_tail1:
    v_mfma_f32_16x16x32_bf16 v[160:163], v[96:99], v[128:131], v[160:163]
    v_mfma_f32_16x16x32_bf16 v[176:179], v[96:99], v[132:135], v[176:179]
    v_mfma_f32_16x16x32_bf16 v[164:167], v[100:103], v[128:131], v[164:167]
    v_mfma_f32_16x16x32_bf16 v[180:183], v[100:103], v[132:135], v[180:183]
    v_mfma_f32_16x16x32_bf16 v[168:171], v[104:107], v[128:131], v[168:171]
    v_mfma_f32_16x16x32_bf16 v[184:187], v[104:107], v[132:135], v[184:187]
    v_mfma_f32_16x16x32_bf16 v[172:175], v[108:111], v[128:131], v[172:175]
    v_mfma_f32_16x16x32_bf16 v[188:191], v[108:111], v[132:135], v[188:191]
    v_mfma_f32_16x16x32_bf16 v[160:163], v[112:115], v[144:147], v[160:163]
    v_mfma_f32_16x16x32_bf16 v[176:179], v[112:115], v[148:151], v[176:179]
    v_mfma_f32_16x16x32_bf16 v[164:167], v[116:119], v[144:147], v[164:167]
    v_mfma_f32_16x16x32_bf16 v[180:183], v[116:119], v[148:151], v[180:183]
    v_mfma_f32_16x16x32_bf16 v[168:171], v[120:123], v[144:147], v[168:171]
    v_mfma_f32_16x16x32_bf16 v[184:187], v[120:123], v[148:151], v[184:187]
    v_mfma_f32_16x16x32_bf16 v[172:175], v[124:127], v[144:147], v[172:175]
    v_mfma_f32_16x16x32_bf16 v[188:191], v[124:127], v[148:151], v[188:191]
    v_mfma_f32_16x16x32_bf16 v[192:195], v[96:99], v[136:139], v[192:195]
    v_mfma_f32_16x16x32_bf16 v[208:211], v[96:99], v[140:143], v[208:211]
    v_mfma_f32_16x16x32_bf16 v[196:199], v[100:103], v[136:139], v[196:199]
    v_mfma_f32_16x16x32_bf16 v[212:215], v[100:103], v[140:143], v[212:215]
    v_mfma_f32_16x16x32_bf16 v[200:203], v[104:107], v[136:139], v[200:203]
    v_mfma_f32_16x16x32_bf16 v[216:219], v[104:107], v[140:143], v[216:219]
    v_mfma_f32_16x16x32_bf16 v[204:207], v[108:111], v[136:139], v[204:207]
    v_mfma_f32_16x16x32_bf16 v[220:223], v[108:111], v[140:143], v[220:223]
    v_mfma_f32_16x16x32_bf16 v[192:195], v[112:115], v[152:155], v[192:195]
    buffer_store_dwordx4 v[160:163], v3, s[56:59], s74 offen offset:0 sc1
    v_mfma_f32_16x16x32_bf16 v[208:211], v[112:115], v[156:159], v[208:211]
    buffer_store_dwordx4 v[164:167], v3, s[56:59], s74 offen offset:1024 sc1
    v_mfma_f32_16x16x32_bf16 v[196:199], v[116:119], v[152:155], v[196:199]
    buffer_store_dwordx4 v[168:171], v3, s[56:59], s74 offen offset:2048 sc1
    v_mfma_f32_16x16x32_bf16 v[212:215], v[116:119], v[156:159], v[212:215]
    buffer_store_dwordx4 v[172:175], v3, s[56:59], s74 offen offset:3072 sc1
    v_mfma_f32_16x16x32_bf16 v[200:203], v[120:123], v[152:155], v[200:203]
    s_add_u32 s74, s74, 4096
    buffer_store_dwordx4 v[176:179], v3, s[56:59], s74 offen offset:0 sc1
    v_mfma_f32_16x16x32_bf16 v[216:219], v[120:123], v[156:159], v[216:219]
    buffer_store_dwordx4 v[180:183], v3, s[56:59], s74 offen offset:1024 sc1
    v_mfma_f32_16x16x32_bf16 v[204:207], v[124:127], v[152:155], v[204:207]
    buffer_store_dwordx4 v[184:187], v3, s[56:59], s74 offen offset:2048 sc1
    v_mfma_f32_16x16x32_bf16 v[220:223], v[124:127], v[156:159], v[220:223]
    buffer_store_dwordx4 v[188:191], v3, s[56:59], s74 offen offset:3072 sc1
    s_nop 15
    ds_write_b128 v9, v[208:211] offset:0
    ds_write_b128 v9, v[212:215] offset:1024
    ds_write_b128 v9, v[216:219] offset:2048
    ds_write_b128 v9, v[220:223] offset:3072
    v_mov_b32 v160, v192
    v_mov_b32 v161, v193
    v_mov_b32 v162, v194
    v_mov_b32 v163, v195
    v_mov_b32 v164, v196
    v_mov_b32 v165, v197
    v_mov_b32 v166, v198
    v_mov_b32 v167, v199
    v_mov_b32 v168, v200
    v_mov_b32 v169, v201
    v_mov_b32 v170, v202
    v_mov_b32 v171, v203
    v_mov_b32 v172, v204
    v_mov_b32 v173, v205
    v_mov_b32 v174, v206
    v_mov_b32 v175, v207
L_g2_tailj:
    s_waitcnt lgkmcnt(0)
    s_barrier
    s_waitcnt vmcnt(0)
    v_mov_b32 v96, 1
    v_mov_b32 v97, 0
    s_mov_b64 exec, 1
    buffer_store_dword v96, v97, s[76:79], s86 offen sc1
    s_mov_b64 exec, -1
    v_mov_b32 v97, 0
    s_mov_b64 exec, 1
    s_mov_b32 s100, 0x40000
L_xp_recurr_27:
    s_sub_u32 s100, s100, 1
    s_cmp_eq_u32 s100, 0
    s_cbranch_scc1 L_xg_recurr_28
    buffer_load_dword v98, v97, s[76:79], s87 offen sc1
    s_waitcnt vmcnt(0)
    v_readfirstlane_b32 s29, v98
    s_cmp_lg_u32 s29, 0
    s_cbranch_scc1 L_xg_recurr_28
    s_sleep 1
    s_branch L_xp_recurr_27
L_xg_recurr_28:
    s_mov_b64 exec, -1
    buffer_load_dwordx4 v[96:99], v3, s[56:59], s75 offen offset:0 sc1
    buffer_load_dwordx4 v[100:103], v3, s[56:59], s75 offen offset:1024 sc1
    buffer_load_dwordx4 v[104:107], v3, s[56:59], s75 offen offset:2048 sc1
    buffer_load_dwordx4 v[108:111], v3, s[56:59], s75 offen offset:3072 sc1
    s_mov_b32 s35, 0xbfb8aa3b
    s_waitcnt vmcnt(0)
    v_pk_add_f32 v[160:161], v[160:161], v[96:97]
    v_pk_add_f32 v[162:163], v[162:163], v[98:99]
    v_pk_add_f32 v[164:165], v[164:165], v[100:101]
    v_pk_add_f32 v[166:167], v[166:167], v[102:103]
    v_pk_add_f32 v[168:169], v[168:169], v[104:105]
    v_pk_add_f32 v[170:171], v[170:171], v[106:107]
    v_pk_add_f32 v[172:173], v[172:173], v[108:109]
    v_pk_add_f32 v[174:175], v[174:175], v[110:111]
    s_cmp_ge_u32 s26, 4
    s_cbranch_scc1 L_fm_recurr_29
    v_cvt_pk_bf16_f32 v128, v160, v161
    v_cvt_pk_bf16_f32 v129, v162, v163
    v_lshlrev_b32 v130, 16, v128
    v_and_b32 v131, 0xffff0000, v128
    v_lshlrev_b32 v132, 16, v129
    v_and_b32 v133, 0xffff0000, v129
    v_mul_f32 v134, s35, v130
    v_mul_f32 v135, s35, v131
    v_mul_f32 v136, s35, v132
    v_mul_f32 v137, s35, v133
    v_exp_f32 v134, v134
    v_exp_f32 v135, v135
    v_exp_f32 v136, v136
    v_exp_f32 v137, v137
    v_cvt_pk_bf16_f32 v128, v32, v33
    v_cvt_pk_bf16_f32 v129, v34, v35
    v_add_f32 v134, 1.0, v134
    v_add_f32 v135, 1.0, v135
    v_add_f32 v136, 1.0, v136
    v_add_f32 v137, 1.0, v137
    v_rcp_f32 v134, v134
    v_rcp_f32 v135, v135
    v_rcp_f32 v136, v136
    v_rcp_f32 v137, v137
    v_lshlrev_b32 v138, 16, v128
    v_and_b32 v139, 0xffff0000, v128
    v_lshlrev_b32 v140, 16, v129
    v_and_b32 v141, 0xffff0000, v129
    v_mul_f32 v130, v130, v134
    v_mul_f32 v131, v131, v135
    v_mul_f32 v132, v132, v136
    v_mul_f32 v133, v133, v137
    v_cvt_pk_bf16_f32 v128, v130, v131
    v_cvt_pk_bf16_f32 v129, v132, v133
    v_lshlrev_b32 v130, 16, v128
    v_and_b32 v131, 0xffff0000, v128
    v_lshlrev_b32 v132, 16, v129
    v_and_b32 v133, 0xffff0000, v129
    v_mul_f32 v130, v130, v138
    v_mul_f32 v131, v131, v139
    v_mul_f32 v132, v132, v140
    v_mul_f32 v133, v133, v141
    v_cvt_pk_bf16_f32 v128, v130, v131
    v_cvt_pk_bf16_f32 v129, v132, v133
    v_lshlrev_b32 v130, 16, v128
    v_lshlrev_b32 v134, 16, v48
    v_and_b32 v131, 0xffff0000, v128
    v_and_b32 v135, 0xffff0000, v48
    v_lshlrev_b32 v132, 16, v129
    v_lshlrev_b32 v136, 16, v49
    v_and_b32 v133, 0xffff0000, v129
    v_and_b32 v137, 0xffff0000, v49
    v_add_f32 v130, v130, v134
    v_add_f32 v131, v131, v135
    v_add_f32 v132, v132, v136
    v_add_f32 v133, v133, v137
    v_cvt_pk_bf16_f32 v144, v130, v131
    v_cvt_pk_bf16_f32 v145, v132, v133
    buffer_store_dwordx2 v[144:145], v6, s[16:19], 0 offen offset:0
    v_cvt_pk_bf16_f32 v128, v164, v165
    v_cvt_pk_bf16_f32 v129, v166, v167
    v_lshlrev_b32 v130, 16, v128
    v_and_b32 v131, 0xffff0000, v128
    v_lshlrev_b32 v132, 16, v129
    v_and_b32 v133, 0xffff0000, v129
    v_mul_f32 v134, s35, v130
    v_mul_f32 v135, s35, v131
    v_mul_f32 v136, s35, v132
    v_mul_f32 v137, s35, v133
    v_exp_f32 v134, v134
    v_exp_f32 v135, v135
    v_exp_f32 v136, v136
    v_exp_f32 v137, v137
    v_cvt_pk_bf16_f32 v128, v36, v37
    v_cvt_pk_bf16_f32 v129, v38, v39
    v_add_f32 v134, 1.0, v134
    v_add_f32 v135, 1.0, v135
    v_add_f32 v136, 1.0, v136
    v_add_f32 v137, 1.0, v137
    v_rcp_f32 v134, v134
    v_rcp_f32 v135, v135
    v_rcp_f32 v136, v136
    v_rcp_f32 v137, v137
    v_lshlrev_b32 v138, 16, v128
    v_and_b32 v139, 0xffff0000, v128
    v_lshlrev_b32 v140, 16, v129
    v_and_b32 v141, 0xffff0000, v129
    v_mul_f32 v130, v130, v134
    v_mul_f32 v131, v131, v135
    v_mul_f32 v132, v132, v136
    v_mul_f32 v133, v133, v137
    v_cvt_pk_bf16_f32 v128, v130, v131
    v_cvt_pk_bf16_f32 v129, v132, v133
    v_lshlrev_b32 v130, 16, v128
    v_and_b32 v131, 0xffff0000, v128
    v_lshlrev_b32 v132, 16, v129
    v_and_b32 v133, 0xffff0000, v129
    v_mul_f32 v130, v130, v138
    v_mul_f32 v131, v131, v139
    v_mul_f32 v132, v132, v140
    v_mul_f32 v133, v133, v141
    v_cvt_pk_bf16_f32 v128, v130, v131
    v_cvt_pk_bf16_f32 v129, v132, v133
    v_lshlrev_b32 v130, 16, v128
    v_lshlrev_b32 v134, 16, v50
    v_and_b32 v131, 0xffff0000, v128
    v_and_b32 v135, 0xffff0000, v50
    v_lshlrev_b32 v132, 16, v129
    v_lshlrev_b32 v136, 16, v51
    v_and_b32 v133, 0xffff0000, v129
    v_and_b32 v137, 0xffff0000, v51
    v_add_f32 v130, v130, v134
    v_add_f32 v131, v131, v135
    v_add_f32 v132, v132, v136
    v_add_f32 v133, v133, v137
    v_cvt_pk_bf16_f32 v146, v130, v131
    v_cvt_pk_bf16_f32 v147, v132, v133
    buffer_store_dwordx2 v[146:147], v6, s[16:19], 0 offen offset:32
    v_cvt_pk_bf16_f32 v128, v168, v169
    v_cvt_pk_bf16_f32 v129, v170, v171
    v_lshlrev_b32 v130, 16, v128
    v_and_b32 v131, 0xffff0000, v128
    v_lshlrev_b32 v132, 16, v129
    v_and_b32 v133, 0xffff0000, v129
    v_mul_f32 v134, s35, v130
    v_mul_f32 v135, s35, v131
    v_mul_f32 v136, s35, v132
    v_mul_f32 v137, s35, v133
    v_exp_f32 v134, v134
    v_exp_f32 v135, v135
    v_exp_f32 v136, v136
    v_exp_f32 v137, v137
    v_cvt_pk_bf16_f32 v128, v40, v41
    v_cvt_pk_bf16_f32 v129, v42, v43
    v_add_f32 v134, 1.0, v134
    v_add_f32 v135, 1.0, v135
    v_add_f32 v136, 1.0, v136
    v_add_f32 v137, 1.0, v137
    v_rcp_f32 v134, v134
    v_rcp_f32 v135, v135
    v_rcp_f32 v136, v136
    v_rcp_f32 v137, v137
    v_lshlrev_b32 v138, 16, v128
    v_and_b32 v139, 0xffff0000, v128
    v_lshlrev_b32 v140, 16, v129
    v_and_b32 v141, 0xffff0000, v129
    v_mul_f32 v130, v130, v134
    v_mul_f32 v131, v131, v135
    v_mul_f32 v132, v132, v136
    v_mul_f32 v133, v133, v137
    v_cvt_pk_bf16_f32 v128, v130, v131
    v_cvt_pk_bf16_f32 v129, v132, v133
    v_lshlrev_b32 v130, 16, v128
    v_and_b32 v131, 0xffff0000, v128
    v_lshlrev_b32 v132, 16, v129
    v_and_b32 v133, 0xffff0000, v129
    v_mul_f32 v130, v130, v138
    v_mul_f32 v131, v131, v139
    v_mul_f32 v132, v132, v140
    v_mul_f32 v133, v133, v141
    v_cvt_pk_bf16_f32 v128, v130, v131
    v_cvt_pk_bf16_f32 v129, v132, v133
    v_lshlrev_b32 v130, 16, v128
    v_lshlrev_b32 v134, 16, v52
    v_and_b32 v131, 0xffff0000, v128
    v_and_b32 v135, 0xffff0000, v52
    v_lshlrev_b32 v132, 16, v129
    v_lshlrev_b32 v136, 16, v53
    v_and_b32 v133, 0xffff0000, v129
    v_and_b32 v137, 0xffff0000, v53
    v_add_f32 v130, v130, v134
    v_add_f32 v131, v131, v135
    v_add_f32 v132, v132, v136
    v_add_f32 v133, v133, v137
    v_cvt_pk_bf16_f32 v148, v130, v131
    v_cvt_pk_bf16_f32 v149, v132, v133
    buffer_store_dwordx2 v[148:149], v6, s[16:19], 0 offen offset:64
    v_cvt_pk_bf16_f32 v128, v172, v173
    v_cvt_pk_bf16_f32 v129, v174, v175
    v_lshlrev_b32 v130, 16, v128
    v_and_b32 v131, 0xffff0000, v128
    v_lshlrev_b32 v132, 16, v129
    v_and_b32 v133, 0xffff0000, v129
    v_mul_f32 v134, s35, v130
    v_mul_f32 v135, s35, v131
    v_mul_f32 v136, s35, v132
    v_mul_f32 v137, s35, v133
    v_exp_f32 v134, v134
    v_exp_f32 v135, v135
    v_exp_f32 v136, v136
    v_exp_f32 v137, v137
    v_cvt_pk_bf16_f32 v128, v44, v45
    v_cvt_pk_bf16_f32 v129, v46, v47
    v_add_f32 v134, 1.0, v134
    v_add_f32 v135, 1.0, v135
    v_add_f32 v136, 1.0, v136
    v_add_f32 v137, 1.0, v137
    v_rcp_f32 v134, v134
    v_rcp_f32 v135, v135
    v_rcp_f32 v136, v136
    v_rcp_f32 v137, v137
    v_lshlrev_b32 v138, 16, v128
    v_and_b32 v139, 0xffff0000, v128
    v_lshlrev_b32 v140, 16, v129
    v_and_b32 v141, 0xffff0000, v129
    v_mul_f32 v130, v130, v134
    v_mul_f32 v131, v131, v135
    v_mul_f32 v132, v132, v136
    v_mul_f32 v133, v133, v137
    v_cvt_pk_bf16_f32 v128, v130, v131
    v_cvt_pk_bf16_f32 v129, v132, v133
    v_lshlrev_b32 v130, 16, v128
    v_and_b32 v131, 0xffff0000, v128
    v_lshlrev_b32 v132, 16, v129
    v_and_b32 v133, 0xffff0000, v129
    v_mul_f32 v130, v130, v138
    v_mul_f32 v131, v131, v139
    v_mul_f32 v132, v132, v140
    v_mul_f32 v133, v133, v141
    v_cvt_pk_bf16_f32 v128, v130, v131
    v_cvt_pk_bf16_f32 v129, v132, v133
    v_lshlrev_b32 v130, 16, v128
    v_lshlrev_b32 v134, 16, v54
    v_and_b32 v131, 0xffff0000, v128
    v_and_b32 v135, 0xffff0000, v54
    v_lshlrev_b32 v132, 16, v129
    v_lshlrev_b32 v136, 16, v55
    v_and_b32 v133, 0xffff0000, v129
    v_and_b32 v137, 0xffff0000, v55
    v_add_f32 v130, v130, v134
    v_add_f32 v131, v131, v135
    v_add_f32 v132, v132, v136
    v_add_f32 v133, v133, v137
    v_cvt_pk_bf16_f32 v150, v130, v131
    v_cvt_pk_bf16_f32 v151, v132, v133
    buffer_store_dwordx2 v[150:151], v6, s[16:19], 0 offen offset:96
    s_branch L_fd_recurr_30
L_fm_recurr_29:
    v_cvt_pk_bf16_f32 v128, v160, v161
    v_cvt_pk_bf16_f32 v129, v162, v163
    v_lshlrev_b32 v130, 16, v128
    v_and_b32 v131, 0xffff0000, v128
    v_lshlrev_b32 v132, 16, v129
    v_and_b32 v133, 0xffff0000, v129
    v_mul_f32 v134, s35, v130
    v_mul_f32 v135, s35, v131
    v_mul_f32 v136, s35, v132
    v_mul_f32 v137, s35, v133
    v_exp_f32 v134, v134
    v_exp_f32 v135, v135
    v_exp_f32 v136, v136
    v_exp_f32 v137, v137
    v_cvt_pk_bf16_f32 v128, v35, v34
    v_cvt_pk_bf16_f32 v129, v33, v32
    v_add_f32 v134, 1.0, v134
    v_add_f32 v135, 1.0, v135
    v_add_f32 v136, 1.0, v136
    v_add_f32 v137, 1.0, v137
    v_rcp_f32 v134, v134
    v_rcp_f32 v135, v135
    v_rcp_f32 v136, v136
    v_rcp_f32 v137, v137
    v_lshlrev_b32 v138, 16, v128
    v_and_b32 v139, 0xffff0000, v128
    v_lshlrev_b32 v140, 16, v129
    v_and_b32 v141, 0xffff0000, v129
    v_mul_f32 v130, v130, v134
    v_mul_f32 v131, v131, v135
    v_mul_f32 v132, v132, v136
    v_mul_f32 v133, v133, v137
    v_cvt_pk_bf16_f32 v128, v130, v131
    v_cvt_pk_bf16_f32 v129, v132, v133
    v_lshlrev_b32 v130, 16, v128
    v_and_b32 v131, 0xffff0000, v128
    v_lshlrev_b32 v132, 16, v129
    v_and_b32 v133, 0xffff0000, v129
    v_mul_f32 v130, v130, v138
    v_mul_f32 v131, v131, v139
    v_mul_f32 v132, v132, v140
    v_mul_f32 v133, v133, v141
    v_cvt_pk_bf16_f32 v128, v130, v131
    v_cvt_pk_bf16_f32 v129, v132, v133
    v_lshlrev_b32 v130, 16, v128
    v_lshlrev_b32 v134, 16, v48
    v_and_b32 v131, 0xffff0000, v128
    v_and_b32 v135, 0xffff0000, v48
    v_lshlrev_b32 v132, 16, v129
    v_lshlrev_b32 v136, 16, v49
    v_and_b32 v133, 0xffff0000, v129
    v_and_b32 v137, 0xffff0000, v49
    v_add_f32 v130, v130, v134
    v_add_f32 v131, v131, v135
    v_add_f32 v132, v132, v136
    v_add_f32 v133, v133, v137
    v_cvt_pk_bf16_f32 v144, v130, v131
    v_cvt_pk_bf16_f32 v145, v132, v133
    buffer_store_dwordx2 v[144:145], v6, s[16:19], 0 offen offset:0
    v_cvt_pk_bf16_f32 v128, v164, v165
    v_cvt_pk_bf16_f32 v129, v166, v167
    v_lshlrev_b32 v130, 16, v128
    v_and_b32 v131, 0xffff0000, v128
    v_lshlrev_b32 v132, 16, v129
    v_and_b32 v133, 0xffff0000, v129
    v_mul_f32 v134, s35, v130
    v_mul_f32 v135, s35, v131
    v_mul_f32 v136, s35, v132
    v_mul_f32 v137, s35, v133
    v_exp_f32 v134, v134
    v_exp_f32 v135, v135
    v_exp_f32 v136, v136
    v_exp_f32 v137, v137
    v_cvt_pk_bf16_f32 v128, v39, v38
    v_cvt_pk_bf16_f32 v129, v37, v36
    v_add_f32 v134, 1.0, v134
    v_add_f32 v135, 1.0, v135
    v_add_f32 v136, 1.0, v136
    v_add_f32 v137, 1.0, v137
    v_rcp_f32 v134, v134
    v_rcp_f32 v135, v135
    v_rcp_f32 v136, v136
    v_rcp_f32 v137, v137
    v_lshlrev_b32 v138, 16, v128
    v_and_b32 v139, 0xffff0000, v128
    v_lshlrev_b32 v140, 16, v129
    v_and_b32 v141, 0xffff0000, v129
    v_mul_f32 v130, v130, v134
    v_mul_f32 v131, v131, v135
    v_mul_f32 v132, v132, v136
    v_mul_f32 v133, v133, v137
    v_cvt_pk_bf16_f32 v128, v130, v131
    v_cvt_pk_bf16_f32 v129, v132, v133
    v_lshlrev_b32 v130, 16, v128
    v_and_b32 v131, 0xffff0000, v128
    v_lshlrev_b32 v132, 16, v129
    v_and_b32 v133, 0xffff0000, v129
    v_mul_f32 v130, v130, v138
    v_mul_f32 v131, v131, v139
    v_mul_f32 v132, v132, v140
    v_mul_f32 v133, v133, v141
    v_cvt_pk_bf16_f32 v128, v130, v131
    v_cvt_pk_bf16_f32 v129, v132, v133
    v_lshlrev_b32 v130, 16, v128
    v_lshlrev_b32 v134, 16, v50
    v_and_b32 v131, 0xffff0000, v128
    v_and_b32 v135, 0xffff0000, v50
    v_lshlrev_b32 v132, 16, v129
    v_lshlrev_b32 v136, 16, v51
    v_and_b32 v133, 0xffff0000, v129
    v_and_b32 v137, 0xffff0000, v51
    v_add_f32 v130, v130, v134
    v_add_f32 v131, v131, v135
    v_add_f32 v132, v132, v136
    v_add_f32 v133, v133, v137
    v_cvt_pk_bf16_f32 v146, v130, v131
    v_cvt_pk_bf16_f32 v147, v132, v133
    buffer_store_dwordx2 v[146:147], v6, s[16:19], 0 offen offset:32
    v_cvt_pk_bf16_f32 v128, v168, v169
    v_cvt_pk_bf16_f32 v129, v170, v171
    v_lshlrev_b32 v130, 16, v128
    v_and_b32 v131, 0xffff0000, v128
    v_lshlrev_b32 v132, 16, v129
    v_and_b32 v133, 0xffff0000, v129
    v_mul_f32 v134, s35, v130
    v_mul_f32 v135, s35, v131
    v_mul_f32 v136, s35, v132
    v_mul_f32 v137, s35, v133
    v_exp_f32 v134, v134
    v_exp_f32 v135, v135
    v_exp_f32 v136, v136
    v_exp_f32 v137, v137
    v_cvt_pk_bf16_f32 v128, v43, v42
    v_cvt_pk_bf16_f32 v129, v41, v40
    v_add_f32 v134, 1.0, v134
    v_add_f32 v135, 1.0, v135
    v_add_f32 v136, 1.0, v136
    v_add_f32 v137, 1.0, v137
    v_rcp_f32 v134, v134
    v_rcp_f32 v135, v135
    v_rcp_f32 v136, v136
    v_rcp_f32 v137, v137
    v_lshlrev_b32 v138, 16, v128
    v_and_b32 v139, 0xffff0000, v128
    v_lshlrev_b32 v140, 16, v129
    v_and_b32 v141, 0xffff0000, v129
    v_mul_f32 v130, v130, v134
    v_mul_f32 v131, v131, v135
    v_mul_f32 v132, v132, v136
    v_mul_f32 v133, v133, v137
    v_cvt_pk_bf16_f32 v128, v130, v131
    v_cvt_pk_bf16_f32 v129, v132, v133
    v_lshlrev_b32 v130, 16, v128
    v_and_b32 v131, 0xffff0000, v128
    v_lshlrev_b32 v132, 16, v129
    v_and_b32 v133, 0xffff0000, v129
    v_mul_f32 v130, v130, v138
    v_mul_f32 v131, v131, v139
    v_mul_f32 v132, v132, v140
    v_mul_f32 v133, v133, v141
    v_cvt_pk_bf16_f32 v128, v130, v131
    v_cvt_pk_bf16_f32 v129, v132, v133
    v_lshlrev_b32 v130, 16, v128
    v_lshlrev_b32 v134, 16, v52
    v_and_b32 v131, 0xffff0000, v128
    v_and_b32 v135, 0xffff0000, v52
    v_lshlrev_b32 v132, 16, v129
    v_lshlrev_b32 v136, 16, v53
    v_and_b32 v133, 0xffff0000, v129
    v_and_b32 v137, 0xffff0000, v53
    v_add_f32 v130, v130, v134
    v_add_f32 v131, v131, v135
    v_add_f32 v132, v132, v136
    v_add_f32 v133, v133, v137
    v_cvt_pk_bf16_f32 v148, v130, v131
    v_cvt_pk_bf16_f32 v149, v132, v133
    buffer_store_dwordx2 v[148:149], v6, s[16:19], 0 offen offset:64
    v_cvt_pk_bf16_f32 v128, v172, v173
    v_cvt_pk_bf16_f32 v129, v174, v175
    v_lshlrev_b32 v130, 16, v128
    v_and_b32 v131, 0xffff0000, v128
    v_lshlrev_b32 v132, 16, v129
    v_and_b32 v133, 0xffff0000, v129
    v_mul_f32 v134, s35, v130
    v_mul_f32 v135, s35, v131
    v_mul_f32 v136, s35, v132
    v_mul_f32 v137, s35, v133
    v_exp_f32 v134, v134
    v_exp_f32 v135, v135
    v_exp_f32 v136, v136
    v_exp_f32 v137, v137
    v_cvt_pk_bf16_f32 v128, v47, v46
    v_cvt_pk_bf16_f32 v129, v45, v44
    v_add_f32 v134, 1.0, v134
    v_add_f32 v135, 1.0, v135
    v_add_f32 v136, 1.0, v136
    v_add_f32 v137, 1.0, v137
    v_rcp_f32 v134, v134
    v_rcp_f32 v135, v135
    v_rcp_f32 v136, v136
    v_rcp_f32 v137, v137
    v_lshlrev_b32 v138, 16, v128
    v_and_b32 v139, 0xffff0000, v128
    v_lshlrev_b32 v140, 16, v129
    v_and_b32 v141, 0xffff0000, v129
    v_mul_f32 v130, v130, v134
    v_mul_f32 v131, v131, v135
    v_mul_f32 v132, v132, v136
    v_mul_f32 v133, v133, v137
    v_cvt_pk_bf16_f32 v128, v130, v131
    v_cvt_pk_bf16_f32 v129, v132, v133
    v_lshlrev_b32 v130, 16, v128
    v_and_b32 v131, 0xffff0000, v128
    v_lshlrev_b32 v132, 16, v129
    v_and_b32 v133, 0xffff0000, v129
    v_mul_f32 v130, v130, v138
    v_mul_f32 v131, v131, v139
    v_mul_f32 v132, v132, v140
    v_mul_f32 v133, v133, v141
    v_cvt_pk_bf16_f32 v128, v130, v131
    v_cvt_pk_bf16_f32 v129, v132, v133
    v_lshlrev_b32 v130, 16, v128
    v_lshlrev_b32 v134, 16, v54
    v_and_b32 v131, 0xffff0000, v128
    v_and_b32 v135, 0xffff0000, v54
    v_lshlrev_b32 v132, 16, v129
    v_lshlrev_b32 v136, 16, v55
    v_and_b32 v133, 0xffff0000, v129
    v_and_b32 v137, 0xffff0000, v55
    v_add_f32 v130, v130, v134
    v_add_f32 v131, v131, v135
    v_add_f32 v132, v132, v136
    v_add_f32 v133, v133, v137
    v_cvt_pk_bf16_f32 v150, v130, v131
    v_cvt_pk_bf16_f32 v151, v132, v133
    buffer_store_dwordx2 v[150:151], v6, s[16:19], 0 offen offset:96
L_fd_recurr_30:
    s_branch L_g2_done
L_g2_loader:
    v_and_b32 v21, 3, v1
    v_lshl_add_u32 v4, v21, 12, v3
    s_mul_i32 s30, s25, 112
    s_mul_i32 s29, s23, 56
    s_add_u32 s30, s30, s29
    s_lshl_b32 s30, s30, 13
    v_lshrrev_b32 v16, 4, v2
    v_and_b32 v17, 15, v2
    v_lshlrev_b32 v18, 1, v16
    v_xor_b32 v17, v17, v18
    v_lshl_add_u32 v16, v21, 4, v16
    v_lshlrev_b32 v16, 11, v16
    s_lshl_b32 s29, s26, 8
    v_add_u32 v16, s29, v16
    v_xor_b32 v18, 0, v17
    v_lshl_add_u32 v18, v18, 4, v16
    v_add_u32 v6, 0, v18
    v_xor_b32 v18, 8, v17
    v_lshl_add_u32 v18, v18, 4, v16
    v_add_u32 v7, 7168, v18
    v_xor_b32 v18, 0, v17
    v_lshl_add_u32 v18, v18, 4, v16
    v_add_u32 v14, 14336, v18
    v_xor_b32 v18, 8, v17
    v_lshl_add_u32 v18, v18, 4, v16
    v_add_u32 v15, 21504, v18
    s_mul_i32 s31, s23, 3670016
    s_and_b32 s33, s28, 3
    s_lshl_b32 s33, s33, 12
    s_waitcnt lgkmcnt(0)
    s_add_u32 s8, s4, 0x400000
    s_addc_u32 s9, s5, 0
    s_mov_b32 s10, 0xe00000
    s_mov_b32 s11, 0x00020000
    s_mov_b32 s12, s36
    s_mov_b32 s13, s37
    s_mov_b32 s14, 0x700000
    s_mov_b32 s15, 0x00020000
    s_add_u32 s44, s4, 0x2920000
    s_addc_u32 s45, s5, 0
    s_mov_b32 s46, 0x1000
    s_mov_b32 s47, 0x00020000
    s_add_u32 m0, s33, 16384
    s_nop 0
    buffer_load_dwordx4 v6, s[12:15], s31 offen lds
    buffer_load_dwordx4 v7, s[12:15], s31 offen offset:1024 lds
    buffer_load_dwordx4 v14, s[12:15], s31 offen offset:2048 lds
    buffer_load_dwordx4 v15, s[12:15], s31 offen offset:3072 lds
    s_add_u32 s31, s31, 131072
    s_add_u32 m0, s33, 49152
    s_nop 0
    buffer_load_dwordx4 v6, s[12:15], s31 offen lds
    buffer_load_dwordx4 v7, s[12:15], s31 offen offset:1024 lds
    buffer_load_dwordx4 v14, s[12:15], s31 offen offset:2048 lds
    buffer_load_dwordx4 v15, s[12:15], s31 offen offset:3072 lds
    s_add_u32 s31, s31, 131072
    s_add_u32 m0, s33, 81920
    s_nop 0
    buffer_load_dwordx4 v6, s[12:15], s31 offen lds
    buffer_load_dwordx4 v7, s[12:15], s31 offen offset:1024 lds
    buffer_load_dwordx4 v14, s[12:15], s31 offen offset:2048 lds
    buffer_load_dwordx4 v15, s[12:15], s31 offen offset:3072 lds
    s_add_u32 s31, s31, 131072
    s_add_u32 m0, s33, 114688
    s_nop 0
    buffer_load_dwordx4 v6, s[12:15], s31 offen lds
    buffer_load_dwordx4 v7, s[12:15], s31 offen offset:1024 lds
    buffer_load_dwordx4 v14, s[12:15], s31 offen offset:2048 lds
    buffer_load_dwordx4 v15, s[12:15], s31 offen offset:3072 lds
    s_add_u32 s31, s31, 131072
    s_cmp_lg_u32 s28, 4
    s_cbranch_scc1 L_pd_recurr_31
    s_lshr_b32 s29, s25, 1
    s_lshl_b32 s29, s29, 1
    s_add_u32 s29, s29, s23
    s_lshl_b32 s71, s29, 7
    v_mov_b32 v17, 0
    s_mov_b64 exec, 1
    s_mov_b32 s100, 0x40000
L_pl_recurr_32:
    s_sub_u32 s100, s100, 1
    s_cmp_eq_u32 s100, 0
    s_cbranch_scc1 L_pd_recurr_31x
    buffer_load_dword v16, v17, s[44:47], s71 offen sc1
    s_waitcnt vmcnt(0)
    v_readfirstlane_b32 s29, v16
    s_cmp_ge_u32 s29, 14
    s_cbranch_scc1 L_pd_recurr_31x
    s_sleep 1
    s_branch L_pl_recurr_32
L_pd_recurr_31x:
    s_mov_b64 exec, -1
L_pd_recurr_31:
    s_barrier
    s_add_u32 m0, s33, 0
    s_nop 0
    buffer_load_dwordx4 v4, s[8:11], s30 offen sc1 lds
    buffer_load_dwordx4 v4, s[8:11], s30 offen offset:1024 sc1 lds
    buffer_load_dwordx4 v4, s[8:11], s30 offen offset:2048 sc1 lds
    buffer_load_dwordx4 v4, s[8:11], s30 offen offset:3072 sc1 lds
    s_add_u32 s30, s30, 16384
    s_add_u32 m0, s33, 32768
    s_nop 0
    buffer_load_dwordx4 v4, s[8:11], s30 offen sc1 lds
    buffer_load_dwordx4 v4, s[8:11], s30 offen offset:1024 sc1 lds
    buffer_load_dwordx4 v4, s[8:11], s30 offen offset:2048 sc1 lds
    buffer_load_dwordx4 v4, s[8:11], s30 offen offset:3072 sc1 lds
    s_add_u32 s30, s30, 16384
    s_add_u32 m0, s33, 65536
    s_nop 0
    buffer_load_dwordx4 v4, s[8:11], s30 offen sc1 lds
    buffer_load_dwordx4 v4, s[8:11], s30 offen offset:1024 sc1 lds
    buffer_load_dwordx4 v4, s[8:11], s30 offen offset:2048 sc1 lds
    buffer_load_dwordx4 v4, s[8:11], s30 offen offset:3072 sc1 lds
    s_add_u32 s30, s30, 16384
    s_add_u32 m0, s33, 98304
    s_nop 0
    buffer_load_dwordx4 v4, s[8:11], s30 offen sc1 lds
    buffer_load_dwordx4 v4, s[8:11], s30 offen offset:1024 sc1 lds
    buffer_load_dwordx4 v4, s[8:11], s30 offen offset:2048 sc1 lds
    buffer_load_dwordx4 v4, s[8:11], s30 offen offset:3072 sc1 lds
    s_add_u32 s30, s30, 16384
    s_waitcnt vmcnt(12)
    s_barrier
    s_mov_b32 s34, 131072
    s_waitcnt vmcnt(8)
    s_barrier
    s_add_u32 s29, s33, s34
    s_add_u32 m0, s29, 16384
    s_nop 0
    buffer_load_dwordx4 v6, s[12:15], s31 offen lds
    buffer_load_dwordx4 v7, s[12:15], s31 offen offset:1024 lds
    buffer_load_dwordx4 v14, s[12:15], s31 offen offset:2048 lds
    buffer_load_dwordx4 v15, s[12:15], s31 offen offset:3072 lds
    s_add_u32 s31, s31, 131072
    s_add_u32 m0, s33, s34
    s_nop 0
    buffer_load_dwordx4 v4, s[8:11], s30 offen sc1 lds
    buffer_load_dwordx4 v4, s[8:11], s30 offen offset:1024 sc1 lds
    buffer_load_dwordx4 v4, s[8:11], s30 offen offset:2048 sc1 lds
    buffer_load_dwordx4 v4, s[8:11], s30 offen offset:3072 sc1 lds
    s_add_u32 s30, s30, 16384
    s_add_u32 s34, s34, 32768
    s_cmp_eq_u32 s34, 163840
    s_cselect_b32 s34, 0, s34
    s_waitcnt vmcnt(12)
    s_barrier
    s_add_u32 s29, s33, s34
    s_add_u32 m0, s29, 16384
    s_nop 0
    buffer_load_dwordx4 v6, s[12:15], s31 offen lds
    buffer_load_dwordx4 v7, s[12:15], s31 offen offset:1024 lds
    buffer_load_dwordx4 v14, s[12:15], s31 offen offset:2048 lds
    buffer_load_dwordx4 v15, s[12:15], s31 offen offset:3072 lds
    s_add_u32 s31, s31, 131072
    s_add_u32 m0, s33, s34
    s_nop 0
    buffer_load_dwordx4 v4, s[8:11], s30 offen sc1 lds
    buffer_load_dwordx4 v4, s[8:11], s30 offen offset:1024 sc1 lds
    buffer_load_dwordx4 v4, s[8:11], s30 offen offset:2048 sc1 lds
    buffer_load_dwordx4 v4, s[8:11], s30 offen offset:3072 sc1 lds
    s_add_u32 s30, s30, 16384
    s_add_u32 s34, s34, 32768
    s_cmp_eq_u32 s34, 163840
    s_cselect_b32 s34, 0, s34
    s_mov_b32 s70, 22
L_g2_lloop:
    s_waitcnt vmcnt(16)
    s_barrier
    s_add_u32 s29, s33, s34
    s_add_u32 m0, s29, 16384
    s_nop 0
    buffer_load_dwordx4 v6, s[12:15], s31 offen lds
    buffer_load_dwordx4 v7, s[12:15], s31 offen offset:1024 lds
    buffer_load_dwordx4 v14, s[12:15], s31 offen offset:2048 lds
    buffer_load_dwordx4 v15, s[12:15], s31 offen offset:3072 lds
    s_add_u32 s31, s31, 131072
    s_add_u32 m0, s33, s34
    s_nop 0
    buffer_load_dwordx4 v4, s[8:11], s30 offen sc1 lds
    buffer_load_dwordx4 v4, s[8:11], s30 offen offset:1024 sc1 lds
    buffer_load_dwordx4 v4, s[8:11], s30 offen offset:2048 sc1 lds
    buffer_load_dwordx4 v4, s[8:11], s30 offen offset:3072 sc1 lds
    s_add_u32 s30, s30, 16384
    s_add_u32 s34, s34, 32768
    s_cmp_eq_u32 s34, 163840
    s_cselect_b32 s34, 0, s34
    s_sub_u32 s70, s70, 1
    s_cmp_lg_u32 s70, 0
    s_cbranch_scc1 L_g2_lloop
    s_waitcnt vmcnt(16)
    s_barrier
    s_cmp_lg_u32 s28, 4
    s_cbranch_scc1 L_pd_recurr_33
    s_movk_i32 s71, 2048
    v_mov_b32 v17, 0
    s_mov_b64 exec, 1
    s_mov_b32 s100, 0x40000
L_pl_recurr_34:
    s_sub_u32 s100, s100, 1
    s_cmp_eq_u32 s100, 0
    s_cbranch_scc1 L_pd_recurr_33x
    buffer_load_dword v16, v17, s[44:47], s71 offen sc1
    s_waitcnt vmcnt(0)
    v_readfirstlane_b32 s29, v16
    s_cmp_ge_u32 s29, 32
    s_cbranch_scc1 L_pd_recurr_33x
    s_sleep 1
    s_branch L_pl_recurr_34
L_pd_recurr_33x:
    s_mov_b64 exec, -1
L_pd_recurr_33:
    s_waitcnt vmcnt(8)
    s_barrier
    s_waitcnt vmcnt(0)
    s_barrier
    s_mov_b32 s16, s38
    s_mov_b32 s17, s39
    s_mov_b32 s18, 0x400000
    s_mov_b32 s19, 0x00020000
    s_mov_b32 s80, s40
    s_mov_b32 s81, s41
    s_mov_b32 s82, 0x400000
    s_mov_b32 s83, 0x00020000
    s_add_u32 s52, s4, 0x1400000
    s_addc_u32 s53, s5, 0
    s_mov_b32 s54, 0x440000
    s_mov_b32 s55, 0x00020000
    s_add_u32 s56, s4, 0x2000000
    s_addc_u32 s57, s5, 0
    s_mov_b32 s58, 0x800000
    s_mov_b32 s59, 0x00020000
    s_mov_b32 s60, s42
    s_mov_b32 s61, s43
    s_mov_b32 s62, 0x100
    s_mov_b32 s63, 0x00020000
    s_add_u32 s76, s4, 0x2900000
    s_addc_u32 s77, s5, 0
    s_mov_b32 s78, 0x20000
    s_mov_b32 s79, 0x00020000
    s_waitcnt vmcnt(0)
    s_barrier
    v_and_b32 v4, 15, v2
    v_bfe_u32 v5, v1, 1, 1
    v_lshl_add_u32 v4, v5, 6, v4
    s_lshl_b32 s29, s25, 7
    s_lshl_b32 s38, s23, 5
    s_add_u32 s29, s29, s38
    s_add_u32 s29, s29, 16
    v_add_u32 v4, s29, v4
    v_lshrrev_b32 v5, 4, v2
    v_lshlrev_b32 v5, 2, v5
    v_and_b32 v6, 1, v1
    v_lshl_add_u32 v5, v6, 6, v5
    s_lshl_b32 s29, s26, 7
    v_add_u32 v5, s29, v5
    v_lshlrev_b32 v6, 11, v4
    v_lshl_add_u32 v6, v5, 1, v6
    s_movk_i32 s29, 2176
    s_cmp_ge_u32 s26, 4
    s_cbranch_scc1 L_mir_recurr_35
    v_mul_lo_u32 v7, v4, s29
    v_lshl_add_u32 v7, v5, 2, v7
    buffer_load_dwordx4 v[32:35], v7, s[52:55], 0 offen offset:0 sc1
    buffer_load_dwordx4 v[36:39], v7, s[52:55], 0 offen offset:64 sc1
    buffer_load_dwordx4 v[40:43], v7, s[52:55], 0 offen offset:128 sc1
    buffer_load_dwordx4 v[44:47], v7, s[52:55], 0 offen offset:192 sc1
    s_branch L_md_recurr_36
L_mir_recurr_35:
    v_sub_u32 v20, 1021, v5
    v_sub_u32 v21, 2048, v4
    v_and_b32 v21, 2047, v21
    v_mul_lo_u32 v7, v21, s29
    v_lshl_add_u32 v7, v20, 2, v7
    v_subrev_u32 v7, 192, v7
    buffer_load_dwordx4 v[32:35], v7, s[52:55], 0 offen offset:192 sc1
    buffer_load_dwordx4 v[36:39], v7, s[52:55], 0 offen offset:128 sc1
    buffer_load_dwordx4 v[40:43], v7, s[52:55], 0 offen offset:64 sc1
    buffer_load_dwordx4 v[44:47], v7, s[52:55], 0 offen offset:0 sc1
L_md_recurr_36:
    buffer_load_dwordx2 v[48:49], v6, s[80:83], 0 offen offset:0
    buffer_load_dwordx2 v[50:51], v6, s[80:83], 0 offen offset:32
    buffer_load_dwordx2 v[52:53], v6, s[80:83], 0 offen offset:64
    buffer_load_dwordx2 v[54:55], v6, s[80:83], 0 offen offset:96
    s_and_b32 s29, s28, 3
    s_lshl_b32 s38, s2, 2
    s_add_u32 s29, s29, s38
    s_lshl_b32 s74, s29, 13
    s_xor_b32 s75, s74, 0x8000
    s_lshl_b32 s86, s29, 6
    s_xor_b32 s87, s86, 256
    s_and_b32 s29, s28, 3
    s_lshl_b32 s29, s29, 12
    v_add_u32 v9, s29, v3
    s_barrier
    ds_read_b128 v[160:163], v9 offset:0
    ds_read_b128 v[164:167], v9 offset:1024
    ds_read_b128 v[168:171], v9 offset:2048
    ds_read_b128 v[172:175], v9 offset:3072
    s_waitcnt lgkmcnt(0)
    v_mov_b32 v97, 0
    s_mov_b64 exec, 1
    s_mov_b32 s100, 0x40000
L_xp_recurr_37:
    s_sub_u32 s100, s100, 1
    s_cmp_eq_u32 s100, 0
    s_cbranch_scc1 L_xg_recurr_38
    buffer_load_dword v98, v97, s[76:79], s87 offen sc1
    s_waitcnt vmcnt(0)
    v_readfirstlane_b32 s29, v98
    s_cmp_lg_u32 s29, 0
    s_cbranch_scc1 L_xg_recurr_38
    s_sleep 1
    s_branch L_xp_recurr_37
L_xg_recurr_38:
    s_mov_b64 exec, -1
    s_add_u32 s75, s75, 4096
    buffer_load_dwordx4 v[96:99], v3, s[56:59], s75 offen offset:0 sc1
    buffer_load_dwordx4 v[100:103], v3, s[56:59], s75 offen offset:1024 sc1
    buffer_load_dwordx4 v[104:107], v3, s[56:59], s75 offen offset:2048 sc1
    buffer_load_dwordx4 v[108:111], v3, s[56:59], s75 offen offset:3072 sc1
    s_mov_b32 s35, 0xbfb8aa3b
    s_waitcnt vmcnt(0)
    v_pk_add_f32 v[160:161], v[160:161], v[96:97]
    v_pk_add_f32 v[162:163], v[162:163], v[98:99]
    v_pk_add_f32 v[164:165], v[164:165], v[100:101]
    v_pk_add_f32 v[166:167], v[166:167], v[102:103]
    v_pk_add_f32 v[168:169], v[168:169], v[104:105]
    v_pk_add_f32 v[170:171], v[170:171], v[106:107]
    v_pk_add_f32 v[172:173], v[172:173], v[108:109]
    v_pk_add_f32 v[174:175], v[174:175], v[110:111]
    s_cmp_ge_u32 s26, 4
    s_cbranch_scc1 L_fm_recurr_39
    v_cvt_pk_bf16_f32 v128, v160, v161
    v_cvt_pk_bf16_f32 v129, v162, v163
    v_lshlrev_b32 v130, 16, v128
    v_and_b32 v131, 0xffff0000, v128
    v_lshlrev_b32 v132, 16, v129
    v_and_b32 v133, 0xffff0000, v129
    v_mul_f32 v134, s35, v130
    v_mul_f32 v135, s35, v131
    v_mul_f32 v136, s35, v132
    v_mul_f32 v137, s35, v133
    v_exp_f32 v134, v134
    v_exp_f32 v135, v135
    v_exp_f32 v136, v136
    v_exp_f32 v137, v137
    v_cvt_pk_bf16_f32 v128, v32, v33
    v_cvt_pk_bf16_f32 v129, v34, v35
    v_add_f32 v134, 1.0, v134
    v_add_f32 v135, 1.0, v135
    v_add_f32 v136, 1.0, v136
    v_add_f32 v137, 1.0, v137
    v_rcp_f32 v134, v134
    v_rcp_f32 v135, v135
    v_rcp_f32 v136, v136
    v_rcp_f32 v137, v137
    v_lshlrev_b32 v138, 16, v128
    v_and_b32 v139, 0xffff0000, v128
    v_lshlrev_b32 v140, 16, v129
    v_and_b32 v141, 0xffff0000, v129
    v_mul_f32 v130, v130, v134
    v_mul_f32 v131, v131, v135
    v_mul_f32 v132, v132, v136
    v_mul_f32 v133, v133, v137
    v_cvt_pk_bf16_f32 v128, v130, v131
    v_cvt_pk_bf16_f32 v129, v132, v133
    v_lshlrev_b32 v130, 16, v128
    v_and_b32 v131, 0xffff0000, v128
    v_lshlrev_b32 v132, 16, v129
    v_and_b32 v133, 0xffff0000, v129
    v_mul_f32 v130, v130, v138
    v_mul_f32 v131, v131, v139
    v_mul_f32 v132, v132, v140
    v_mul_f32 v133, v133, v141
    v_cvt_pk_bf16_f32 v128, v130, v131
    v_cvt_pk_bf16_f32 v129, v132, v133
    v_lshlrev_b32 v130, 16, v128
    v_lshlrev_b32 v134, 16, v48
    v_and_b32 v131, 0xffff0000, v128
    v_and_b32 v135, 0xffff0000, v48
    v_lshlrev_b32 v132, 16, v129
    v_lshlrev_b32 v136, 16, v49
    v_and_b32 v133, 0xffff0000, v129
    v_and_b32 v137, 0xffff0000, v49
    v_add_f32 v130, v130, v134
    v_add_f32 v131, v131, v135
    v_add_f32 v132, v132, v136
    v_add_f32 v133, v133, v137
    v_cvt_pk_bf16_f32 v144, v130, v131
    v_cvt_pk_bf16_f32 v145, v132, v133
    buffer_store_dwordx2 v[144:145], v6, s[16:19], 0 offen offset:0
    v_cvt_pk_bf16_f32 v128, v164, v165
    v_cvt_pk_bf16_f32 v129, v166, v167
    v_lshlrev_b32 v130, 16, v128
    v_and_b32 v131, 0xffff0000, v128
    v_lshlrev_b32 v132, 16, v129
    v_and_b32 v133, 0xffff0000, v129
    v_mul_f32 v134, s35, v130
    v_mul_f32 v135, s35, v131
    v_mul_f32 v136, s35, v132
    v_mul_f32 v137, s35, v133
    v_exp_f32 v134, v134
    v_exp_f32 v135, v135
    v_exp_f32 v136, v136
    v_exp_f32 v137, v137
    v_cvt_pk_bf16_f32 v128, v36, v37
    v_cvt_pk_bf16_f32 v129, v38, v39
    v_add_f32 v134, 1.0, v134
    v_add_f32 v135, 1.0, v135
    v_add_f32 v136, 1.0, v136
    v_add_f32 v137, 1.0, v137
    v_rcp_f32 v134, v134
    v_rcp_f32 v135, v135
    v_rcp_f32 v136, v136
    v_rcp_f32 v137, v137
    v_lshlrev_b32 v138, 16, v128
    v_and_b32 v139, 0xffff0000, v128
    v_lshlrev_b32 v140, 16, v129
    v_and_b32 v141, 0xffff0000, v129
    v_mul_f32 v130, v130, v134
    v_mul_f32 v131, v131, v135
    v_mul_f32 v132, v132, v136
    v_mul_f32 v133, v133, v137
    v_cvt_pk_bf16_f32 v128, v130, v131
    v_cvt_pk_bf16_f32 v129, v132, v133
    v_lshlrev_b32 v130, 16, v128
    v_and_b32 v131, 0xffff0000, v128
    v_lshlrev_b32 v132, 16, v129
    v_and_b32 v133, 0xffff0000, v129
    v_mul_f32 v130, v130, v138
    v_mul_f32 v131, v131, v139
    v_mul_f32 v132, v132, v140
    v_mul_f32 v133, v133, v141
    v_cvt_pk_bf16_f32 v128, v130, v131
    v_cvt_pk_bf16_f32 v129, v132, v133
    v_lshlrev_b32 v130, 16, v128
    v_lshlrev_b32 v134, 16, v50
    v_and_b32 v131, 0xffff0000, v128
    v_and_b32 v135, 0xffff0000, v50
    v_lshlrev_b32 v132, 16, v129
    v_lshlrev_b32 v136, 16, v51
    v_and_b32 v133, 0xffff0000, v129
    v_and_b32 v137, 0xffff0000, v51
    v_add_f32 v130, v130, v134
    v_add_f32 v131, v131, v135
    v_add_f32 v132, v132, v136
    v_add_f32 v133, v133, v137
    v_cvt_pk_bf16_f32 v146, v130, v131
    v_cvt_pk_bf16_f32 v147, v132, v133
    buffer_store_dwordx2 v[146:147], v6, s[16:19], 0 offen offset:32
    v_cvt_pk_bf16_f32 v128, v168, v169
    v_cvt_pk_bf16_f32 v129, v170, v171
    v_lshlrev_b32 v130, 16, v128
    v_and_b32 v131, 0xffff0000, v128
    v_lshlrev_b32 v132, 16, v129
    v_and_b32 v133, 0xffff0000, v129
    v_mul_f32 v134, s35, v130
    v_mul_f32 v135, s35, v131
    v_mul_f32 v136, s35, v132
    v_mul_f32 v137, s35, v133
    v_exp_f32 v134, v134
    v_exp_f32 v135, v135
    v_exp_f32 v136, v136
    v_exp_f32 v137, v137
    v_cvt_pk_bf16_f32 v128, v40, v41
    v_cvt_pk_bf16_f32 v129, v42, v43
    v_add_f32 v134, 1.0, v134
    v_add_f32 v135, 1.0, v135
    v_add_f32 v136, 1.0, v136
    v_add_f32 v137, 1.0, v137
    v_rcp_f32 v134, v134
    v_rcp_f32 v135, v135
    v_rcp_f32 v136, v136
    v_rcp_f32 v137, v137
    v_lshlrev_b32 v138, 16, v128
    v_and_b32 v139, 0xffff0000, v128
    v_lshlrev_b32 v140, 16, v129
    v_and_b32 v141, 0xffff0000, v129
    v_mul_f32 v130, v130, v134
    v_mul_f32 v131, v131, v135
    v_mul_f32 v132, v132, v136
    v_mul_f32 v133, v133, v137
    v_cvt_pk_bf16_f32 v128, v130, v131
    v_cvt_pk_bf16_f32 v129, v132, v133
    v_lshlrev_b32 v130, 16, v128
    v_and_b32 v131, 0xffff0000, v128
    v_lshlrev_b32 v132, 16, v129
    v_and_b32 v133, 0xffff0000, v129
    v_mul_f32 v130, v130, v138
    v_mul_f32 v131, v131, v139
    v_mul_f32 v132, v132, v140
    v_mul_f32 v133, v133, v141
    v_cvt_pk_bf16_f32 v128, v130, v131
    v_cvt_pk_bf16_f32 v129, v132, v133
    v_lshlrev_b32 v130, 16, v128
    v_lshlrev_b32 v134, 16, v52
    v_and_b32 v131, 0xffff0000, v128
    v_and_b32 v135, 0xffff0000, v52
    v_lshlrev_b32 v132, 16, v129
    v_lshlrev_b32 v136, 16, v53
    v_and_b32 v133, 0xffff0000, v129
    v_and_b32 v137, 0xffff0000, v53
    v_add_f32 v130, v130, v134
    v_add_f32 v131, v131, v135
    v_add_f32 v132, v132, v136
    v_add_f32 v133, v133, v137
    v_cvt_pk_bf16_f32 v148, v130, v131
    v_cvt_pk_bf16_f32 v149, v132, v133
    buffer_store_dwordx2 v[148:149], v6, s[16:19], 0 offen offset:64
    v_cvt_pk_bf16_f32 v128, v172, v173
    v_cvt_pk_bf16_f32 v129, v174, v175
    v_lshlrev_b32 v130, 16, v128
    v_and_b32 v131, 0xffff0000, v128
    v_lshlrev_b32 v132, 16, v129
    v_and_b32 v133, 0xffff0000, v129
    v_mul_f32 v134, s35, v130
    v_mul_f32 v135, s35, v131
    v_mul_f32 v136, s35, v132
    v_mul_f32 v137, s35, v133
    v_exp_f32 v134, v134
    v_exp_f32 v135, v135
    v_exp_f32 v136, v136
    v_exp_f32 v137, v137
    v_cvt_pk_bf16_f32 v128, v44, v45
    v_cvt_pk_bf16_f32 v129, v46, v47
    v_add_f32 v134, 1.0, v134
    v_add_f32 v135, 1.0, v135
    v_add_f32 v136, 1.0, v136
    v_add_f32 v137, 1.0, v137
    v_rcp_f32 v134, v134
    v_rcp_f32 v135, v135
    v_rcp_f32 v136, v136
    v_rcp_f32 v137, v137
    v_lshlrev_b32 v138, 16, v128
    v_and_b32 v139, 0xffff0000, v128
    v_lshlrev_b32 v140, 16, v129
    v_and_b32 v141, 0xffff0000, v129
    v_mul_f32 v130, v130, v134
    v_mul_f32 v131, v131, v135
    v_mul_f32 v132, v132, v136
    v_mul_f32 v133, v133, v137
    v_cvt_pk_bf16_f32 v128, v130, v131
    v_cvt_pk_bf16_f32 v129, v132, v133
    v_lshlrev_b32 v130, 16, v128
    v_and_b32 v131, 0xffff0000, v128
    v_lshlrev_b32 v132, 16, v129
    v_and_b32 v133, 0xffff0000, v129
    v_mul_f32 v130, v130, v138
    v_mul_f32 v131, v131, v139
    v_mul_f32 v132, v132, v140
    v_mul_f32 v133, v133, v141
    v_cvt_pk_bf16_f32 v128, v130, v131
    v_cvt_pk_bf16_f32 v129, v132, v133
    v_lshlrev_b32 v130, 16, v128
    v_lshlrev_b32 v134, 16, v54
    v_and_b32 v131, 0xffff0000, v128
    v_and_b32 v135, 0xffff0000, v54
    v_lshlrev_b32 v132, 16, v129
    v_lshlrev_b32 v136, 16, v55
    v_and_b32 v133, 0xffff0000, v129
    v_and_b32 v137, 0xffff0000, v55
    v_add_f32 v130, v130, v134
    v_add_f32 v131, v131, v135
    v_add_f32 v132, v132, v136
    v_add_f32 v133, v133, v137
    v_cvt_pk_bf16_f32 v150, v130, v131
    v_cvt_pk_bf16_f32 v151, v132, v133
    buffer_store_dwordx2 v[150:151], v6, s[16:19], 0 offen offset:96
    s_branch L_fd_recurr_40
L_fm_recurr_39:
    v_cvt_pk_bf16_f32 v128, v160, v161
    v_cvt_pk_bf16_f32 v129, v162, v163
    v_lshlrev_b32 v130, 16, v128
    v_and_b32 v131, 0xffff0000, v128
    v_lshlrev_b32 v132, 16, v129
    v_and_b32 v133, 0xffff0000, v129
    v_mul_f32 v134, s35, v130
    v_mul_f32 v135, s35, v131
    v_mul_f32 v136, s35, v132
    v_mul_f32 v137, s35, v133
    v_exp_f32 v134, v134
    v_exp_f32 v135, v135
    v_exp_f32 v136, v136
    v_exp_f32 v137, v137
    v_cvt_pk_bf16_f32 v128, v35, v34
    v_cvt_pk_bf16_f32 v129, v33, v32
    v_add_f32 v134, 1.0, v134
    v_add_f32 v135, 1.0, v135
    v_add_f32 v136, 1.0, v136
    v_add_f32 v137, 1.0, v137
    v_rcp_f32 v134, v134
    v_rcp_f32 v135, v135
    v_rcp_f32 v136, v136
    v_rcp_f32 v137, v137
    v_lshlrev_b32 v138, 16, v128
    v_and_b32 v139, 0xffff0000, v128
    v_lshlrev_b32 v140, 16, v129
    v_and_b32 v141, 0xffff0000, v129
    v_mul_f32 v130, v130, v134
    v_mul_f32 v131, v131, v135
    v_mul_f32 v132, v132, v136
    v_mul_f32 v133, v133, v137
    v_cvt_pk_bf16_f32 v128, v130, v131
    v_cvt_pk_bf16_f32 v129, v132, v133
    v_lshlrev_b32 v130, 16, v128
    v_and_b32 v131, 0xffff0000, v128
    v_lshlrev_b32 v132, 16, v129
    v_and_b32 v133, 0xffff0000, v129
    v_mul_f32 v130, v130, v138
    v_mul_f32 v131, v131, v139
    v_mul_f32 v132, v132, v140
    v_mul_f32 v133, v133, v141
    v_cvt_pk_bf16_f32 v128, v130, v131
    v_cvt_pk_bf16_f32 v129, v132, v133
    v_lshlrev_b32 v130, 16, v128
    v_lshlrev_b32 v134, 16, v48
    v_and_b32 v131, 0xffff0000, v128
    v_and_b32 v135, 0xffff0000, v48
    v_lshlrev_b32 v132, 16, v129
    v_lshlrev_b32 v136, 16, v49
    v_and_b32 v133, 0xffff0000, v129
    v_and_b32 v137, 0xffff0000, v49
    v_add_f32 v130, v130, v134
    v_add_f32 v131, v131, v135
    v_add_f32 v132, v132, v136
    v_add_f32 v133, v133, v137
    v_cvt_pk_bf16_f32 v144, v130, v131
    v_cvt_pk_bf16_f32 v145, v132, v133
    buffer_store_dwordx2 v[144:145], v6, s[16:19], 0 offen offset:0
    v_cvt_pk_bf16_f32 v128, v164, v165
    v_cvt_pk_bf16_f32 v129, v166, v167
    v_lshlrev_b32 v130, 16, v128
    v_and_b32 v131, 0xffff0000, v128
    v_lshlrev_b32 v132, 16, v129
    v_and_b32 v133, 0xffff0000, v129
    v_mul_f32 v134, s35, v130
    v_mul_f32 v135, s35, v131
    v_mul_f32 v136, s35, v132
    v_mul_f32 v137, s35, v133
    v_exp_f32 v134, v134
    v_exp_f32 v135, v135
    v_exp_f32 v136, v136
    v_exp_f32 v137, v137
    v_cvt_pk_bf16_f32 v128, v39, v38
    v_cvt_pk_bf16_f32 v129, v37, v36
    v_add_f32 v134, 1.0, v134
    v_add_f32 v135, 1.0, v135
    v_add_f32 v136, 1.0, v136
    v_add_f32 v137, 1.0, v137
    v_rcp_f32 v134, v134
    v_rcp_f32 v135, v135
    v_rcp_f32 v136, v136
    v_rcp_f32 v137, v137
    v_lshlrev_b32 v138, 16, v128
    v_and_b32 v139, 0xffff0000, v128
    v_lshlrev_b32 v140, 16, v129
    v_and_b32 v141, 0xffff0000, v129
    v_mul_f32 v130, v130, v134
    v_mul_f32 v131, v131, v135
    v_mul_f32 v132, v132, v136
    v_mul_f32 v133, v133, v137
    v_cvt_pk_bf16_f32 v128, v130, v131
    v_cvt_pk_bf16_f32 v129, v132, v133
    v_lshlrev_b32 v130, 16, v128
    v_and_b32 v131, 0xffff0000, v128
    v_lshlrev_b32 v132, 16, v129
    v_and_b32 v133, 0xffff0000, v129
    v_mul_f32 v130, v130, v138
    v_mul_f32 v131, v131, v139
    v_mul_f32 v132, v132, v140
    v_mul_f32 v133, v133, v141
    v_cvt_pk_bf16_f32 v128, v130, v131
    v_cvt_pk_bf16_f32 v129, v132, v133
    v_lshlrev_b32 v130, 16, v128
    v_lshlrev_b32 v134, 16, v50
    v_and_b32 v131, 0xffff0000, v128
    v_and_b32 v135, 0xffff0000, v50
    v_lshlrev_b32 v132, 16, v129
    v_lshlrev_b32 v136, 16, v51
    v_and_b32 v133, 0xffff0000, v129
    v_and_b32 v137, 0xffff0000, v51
    v_add_f32 v130, v130, v134
    v_add_f32 v131, v131, v135
    v_add_f32 v132, v132, v136
    v_add_f32 v133, v133, v137
    v_cvt_pk_bf16_f32 v146, v130, v131
    v_cvt_pk_bf16_f32 v147, v132, v133
    buffer_store_dwordx2 v[146:147], v6, s[16:19], 0 offen offset:32
    v_cvt_pk_bf16_f32 v128, v168, v169
    v_cvt_pk_bf16_f32 v129, v170, v171
    v_lshlrev_b32 v130, 16, v128
    v_and_b32 v131, 0xffff0000, v128
    v_lshlrev_b32 v132, 16, v129
    v_and_b32 v133, 0xffff0000, v129
    v_mul_f32 v134, s35, v130
    v_mul_f32 v135, s35, v131
    v_mul_f32 v136, s35, v132
    v_mul_f32 v137, s35, v133
    v_exp_f32 v134, v134
    v_exp_f32 v135, v135
    v_exp_f32 v136, v136
    v_exp_f32 v137, v137
    v_cvt_pk_bf16_f32 v128, v43, v42
    v_cvt_pk_bf16_f32 v129, v41, v40
    v_add_f32 v134, 1.0, v134
    v_add_f32 v135, 1.0, v135
    v_add_f32 v136, 1.0, v136
    v_add_f32 v137, 1.0, v137
    v_rcp_f32 v134, v134
    v_rcp_f32 v135, v135
    v_rcp_f32 v136, v136
    v_rcp_f32 v137, v137
    v_lshlrev_b32 v138, 16, v128
    v_and_b32 v139, 0xffff0000, v128
    v_lshlrev_b32 v140, 16, v129
    v_and_b32 v141, 0xffff0000, v129
    v_mul_f32 v130, v130, v134
    v_mul_f32 v131, v131, v135
    v_mul_f32 v132, v132, v136
    v_mul_f32 v133, v133, v137
    v_cvt_pk_bf16_f32 v128, v130, v131
    v_cvt_pk_bf16_f32 v129, v132, v133
    v_lshlrev_b32 v130, 16, v128
    v_and_b32 v131, 0xffff0000, v128
    v_lshlrev_b32 v132, 16, v129
    v_and_b32 v133, 0xffff0000, v129
    v_mul_f32 v130, v130, v138
    v_mul_f32 v131, v131, v139
    v_mul_f32 v132, v132, v140
    v_mul_f32 v133, v133, v141
    v_cvt_pk_bf16_f32 v128, v130, v131
    v_cvt_pk_bf16_f32 v129, v132, v133
    v_lshlrev_b32 v130, 16, v128
    v_lshlrev_b32 v134, 16, v52
    v_and_b32 v131, 0xffff0000, v128
    v_and_b32 v135, 0xffff0000, v52
    v_lshlrev_b32 v132, 16, v129
    v_lshlrev_b32 v136, 16, v53
    v_and_b32 v133, 0xffff0000, v129
    v_and_b32 v137, 0xffff0000, v53
    v_add_f32 v130, v130, v134
    v_add_f32 v131, v131, v135
    v_add_f32 v132, v132, v136
    v_add_f32 v133, v133, v137
    v_cvt_pk_bf16_f32 v148, v130, v131
    v_cvt_pk_bf16_f32 v149, v132, v133
    buffer_store_dwordx2 v[148:149], v6, s[16:19], 0 offen offset:64
    v_cvt_pk_bf16_f32 v128, v172, v173
    v_cvt_pk_bf16_f32 v129, v174, v175
    v_lshlrev_b32 v130, 16, v128
    v_and_b32 v131, 0xffff0000, v128
    v_lshlrev_b32 v132, 16, v129
    v_and_b32 v133, 0xffff0000, v129
    v_mul_f32 v134, s35, v130
    v_mul_f32 v135, s35, v131
    v_mul_f32 v136, s35, v132
    v_mul_f32 v137, s35, v133
    v_exp_f32 v134, v134
    v_exp_f32 v135, v135
    v_exp_f32 v136, v136
    v_exp_f32 v137, v137
    v_cvt_pk_bf16_f32 v128, v47, v46
    v_cvt_pk_bf16_f32 v129, v45, v44
    v_add_f32 v134, 1.0, v134
    v_add_f32 v135, 1.0, v135
    v_add_f32 v136, 1.0, v136
    v_add_f32 v137, 1.0, v137
    v_rcp_f32 v134, v134
    v_rcp_f32 v135, v135
    v_rcp_f32 v136, v136
    v_rcp_f32 v137, v137
    v_lshlrev_b32 v138, 16, v128
    v_and_b32 v139, 0xffff0000, v128
    v_lshlrev_b32 v140, 16, v129
    v_and_b32 v141, 0xffff0000, v129
    v_mul_f32 v130, v130, v134
    v_mul_f32 v131, v131, v135
    v_mul_f32 v132, v132, v136
    v_mul_f32 v133, v133, v137
    v_cvt_pk_bf16_f32 v128, v130, v131
    v_cvt_pk_bf16_f32 v129, v132, v133
    v_lshlrev_b32 v130, 16, v128
    v_and_b32 v131, 0xffff0000, v128
    v_lshlrev_b32 v132, 16, v129
    v_and_b32 v133, 0xffff0000, v129
    v_mul_f32 v130, v130, v138
    v_mul_f32 v131, v131, v139
    v_mul_f32 v132, v132, v140
    v_mul_f32 v133, v133, v141
    v_cvt_pk_bf16_f32 v128, v130, v131
    v_cvt_pk_bf16_f32 v129, v132, v133
    v_lshlrev_b32 v130, 16, v128
    v_lshlrev_b32 v134, 16, v54
    v_and_b32 v131, 0xffff0000, v128
    v_and_b32 v135, 0xffff0000, v54
    v_lshlrev_b32 v132, 16, v129
    v_lshlrev_b32 v136, 16, v55
    v_and_b32 v133, 0xffff0000, v129
    v_and_b32 v137, 0xffff0000, v55
    v_add_f32 v130, v130, v134
    v_add_f32 v131, v131, v135
    v_add_f32 v132, v132, v136
    v_add_f32 v133, v133, v137
    v_cvt_pk_bf16_f32 v150, v130, v131
    v_cvt_pk_bf16_f32 v151, v132, v133
    buffer_store_dwordx2 v[150:151], v6, s[16:19], 0 offen offset:96
L_fd_recurr_40:
L_g2_done:
L_g1_end:
L_g1_end2:
    s_endpgm
.p2align 8
.type fft_table,@object
fft_table:
.long 0x3c003c00,0x3c003c00,0x3c003c00,0x3c003c00,0x3bd93c00,0x3aa73b64,0x387239a8,0x323e361f
.long 0x3b643c00,0x361f39a8,0xb61f0000,0xbb64b9a8,0x3aa73c00,0xb23e361f,0xbbd9b9a8,0xb872bb64
.long 0x39a83c00,0xb9a80000,0xb9a8bc00,0x39a88000,0x38723c00,0xbbd9b61f,0x323eb9a8,0x3aa73b64
.long 0x361f3c00,0xbb64b9a8,0x3b648000,0xb61f39a8,0x323e3c00,0xb872bb64,0x3aa739a8,0xbbd9b61f
.long 0x3c00,0x8000bc00,0x3c00,0x8000bc00,0xb23e3c00,0x3872bb64,0xbaa739a8,0x3bd9b61f
.long 0xb61f3c00,0x3b64b9a8,0xbb640000,0x361f39a8,0xb8723c00,0x3bd9b61f,0xb23eb9a8,0xbaa73b64
.long 0xb9a83c00,0x39a88000,0x39a8bc00,0xb9a80000,0xbaa73c00,0x323e361f,0x3bd9b9a8,0x3872bb64
.long 0xbb643c00,0xb61f39a8,0x361f8000,0x3b64b9a8,0xbbd93c00,0xbaa73b64,0xb87239a8,0xb23e361f
.long 0xbc003c00,0xbc003c00,0xbc003c00,0xbc003c00,0xbbd93c00,0xbaa73b64,0xb87239a8,0xb23e361f
.long 0xbb643c00,0xb61f39a8,0x361f0000,0x3b64b9a8,0xbaa73c00,0x323e361f,0x3bd9b9a8,0x3872bb64
.long 0xb9a83c00,0x39a80000,0x39a8bc00,0xb9a88000,0xb8723c00,0x3bd9b61f,0xb23eb9a8,0xbaa73b64
.long 0xb61f3c00,0x3b64b9a8,0xbb648000,0x361f39a8,0xb23e3c00,0x3872bb64,0xbaa739a8,0x3bd9b61f
.long 0x80003c00,0xbc00,0x80003c00,0xbc00,0x323e3c00,0xb872bb64,0x3aa739a8,0xbbd9b61f
.long 0x361f3c00,0xbb64b9a8,0x3b640000,0xb61f39a8,0x38723c00,0xbbd9b61f,0x323eb9a8,0x3aa73b64
.long 0x39a83c00,0xb9a88000,0xb9a8bc00,0x39a80000,0x3aa73c00,0xb23e361f,0xbbd9b9a8,0xb872bb64
.long 0x3b643c00,0x361f39a8,0xb61f8000,0xbb64b9a8,0x3bd93c00,0x3aa73b64,0x387239a8,0x323e361f
.long 0x3c003c00,0x3c003c00,0x3c003c00,0x3c003c00,0xb23e0000,0xb872b61f,0xbaa7b9a8,0xbbd9bb64
.long 0xbb64bc00,0xb61fb9a8,0x361f8000,0x3b6439a8,0x38728000,0x3bd93b64,0x323e39a8,0xbaa7b61f
.long 0x39a83c00,0xb9a80000,0xb9a8bc00,0x39a88000,0xbaa70000,0xb23ebb64,0x3bd939a8,0xb872361f
.long 0xb61fbc00,0x3b6439a8,0xbb640000,0x361fb9a8,0x3bd98000,0xbaa7361f,0x3872b9a8,0xb23e3b64
.long 0x3c00,0x8000bc00,0x3c00,0x8000bc00,0xbbd90000,0x3aa7361f,0xb872b9a8,0x323e3b64
.long 0x361fbc00,0xbb6439a8,0x3b648000,0xb61fb9a8,0x3aa78000,0x323ebb64,0xbbd939a8,0x3872361f
.long 0xb9a83c00,0x39a88000,0x39a8bc00,0xb9a80000,0xb8720000,0xbbd93b64,0xb23e39a8,0x3aa7b61f
.long 0x3b64bc00,0x361fb9a8,0xb61f0000,0xbb6439a8,0x323e8000,0x3872b61f,0x3aa7b9a8,0x3bd9bb64
.long 0xbc003c00,0xbc003c00,0xbc003c00,0xbc003c00,0x323e0000,0x3872b61f,0x3aa7b9a8,0x3bd9bb64
.long 0x3b64bc00,0x361fb9a8,0xb61f8000,0xbb6439a8,0xb8728000,0xbbd93b64,0xb23e39a8,0x3aa7b61f
.long 0xb9a83c00,0x39a80000,0x39a8bc00,0xb9a88000,0x3aa70000,0x323ebb64,0xbbd939a8,0x3872361f
.long 0x361fbc00,0xbb6439a8,0x3b640000,0xb61fb9a8,0xbbd98000,0x3aa7361f,0xb872b9a8,0x323e3b64
.long 0x80003c00,0xbc00,0x80003c00,0xbc00,0x3bd90000,0xbaa7361f,0x3872b9a8,0xb23e3b64
.long 0xb61fbc00,0x3b6439a8,0xbb648000,0x361fb9a8,0xbaa78000,0xb23ebb64,0x3bd939a8,0xb872361f
.long 0x39a83c00,0xb9a88000,0xb9a8bc00,0x39a80000,0x38720000,0x3bd93b64,0x323e39a8,0xbaa7b61f
.long 0xbb64bc00,0xb61fb9a8,0x361f0000,0x3b6439a8,0xb23e8000,0xb872b61f,0xbaa7b9a8,0xbbd9bb64
.long 0x80008000,0x80008000,0x80008000,0x80008000,0xb23e8000,0xb872b61f,0xbaa7b9a8,0xbbd9bb64
.long 0xb61f8000,0xbb64b9a8,0xbb64bc00,0xb61fb9a8,0xb8728000,0xbbd9bb64,0xb23eb9a8,0x3aa7361f
.long 0xb9a88000,0xb9a8bc00,0x39a88000,0x39a83c00,0xbaa78000,0xb23ebb64,0x3bd939a8,0xb872361f
.long 0xbb648000,0x361fb9a8,0x361f3c00,0xbb64b9a8,0xbbd98000,0x3aa7b61f,0xb87239a8,0x323ebb64
.long 0xbc008000,0x3c008000,0xbc008000,0x3c008000,0xbbd98000,0x3aa7361f,0xb872b9a8,0x323e3b64
.long 0xbb648000,0x361f39a8,0x361fbc00,0xbb6439a8,0xbaa78000,0xb23e3b64,0x3bd9b9a8,0xb872b61f
.long 0xb9a88000,0xb9a83c00,0x39a88000,0x39a8bc00,0xb8728000,0xbbd93b64,0xb23e39a8,0x3aa7b61f
.long 0xb61f8000,0xbb6439a8,0xbb643c00,0xb61f39a8,0xb23e8000,0xb872361f,0xbaa739a8,0xbbd93b64
.long 0x80008000,0x80008000,0x80008000,0x80008000,0x323e8000,0x3872b61f,0x3aa7b9a8,0x3bd9bb64
.long 0x361f8000,0x3b64b9a8,0x3b64bc00,0x361fb9a8,0x38728000,0x3bd9bb64,0x323eb9a8,0xbaa7361f
.long 0x39a88000,0x39a8bc00,0xb9a88000,0xb9a83c00,0x3aa78000,0x323ebb64,0xbbd939a8,0x3872361f
.long 0x3b648000,0xb61fb9a8,0xb61f3c00,0x3b64b9a8,0x3bd98000,0xbaa7b61f,0x387239a8,0xb23ebb64
.long 0x3c008000,0xbc008000,0x3c008000,0xbc008000,0x3bd98000,0xbaa7361f,0x3872b9a8,0xb23e3b64
.long 0x3b648000,0xb61f39a8,0xb61fbc00,0x3b6439a8,0x3aa78000,0x323e3b64,0xbbd9b9a8,0x3872b61f
.long 0x39a88000,0x39a83c00,0xb9a88000,0xb9a8bc00,0x38728000,0x3bd93b64,0x323e39a8,0xbaa7b61f
.long 0x361f8000,0x3b6439a8,0x3b643c00,0x361f39a8,0x323e8000,0x3872361f,0x3aa739a8,0x3bd93b64
.long 0x80008000,0x80008000,0x80008000,0x80008000,0xbbd9bc00,0xbaa7bb64,0xb872b9a8,0xb23eb61f
.long 0x361f8000,0x3b6439a8,0x3b643c00,0x361f39a8,0x3aa73c00,0xb23e361f,0xbbd9b9a8,0xb872bb64
.long 0xb9a88000,0xb9a8bc00,0x39a88000,0x39a83c00,0xb872bc00,0x3bd9361f,0xb23e39a8,0xbaa7bb64
.long 0x3b648000,0xb61f39a8,0xb61fbc00,0x3b6439a8,0x323e3c00,0xb872bb64,0x3aa739a8,0xbbd9b61f
.long 0xbc008000,0x3c008000,0xbc008000,0x3c008000,0x323ebc00,0xb8723b64,0x3aa7b9a8,0xbbd9361f
.long 0x3b648000,0xb61fb9a8,0xb61f3c00,0x3b64b9a8,0xb8723c00,0x3bd9b61f,0xb23eb9a8,0xbaa73b64
.long 0xb9a88000,0xb9a83c00,0x39a88000,0x39a8bc00,0x3aa7bc00,0xb23eb61f,0xbbd939a8,0xb8723b64
.long 0x361f8000,0x3b64b9a8,0x3b64bc00,0x361fb9a8,0xbbd93c00,0xbaa73b64,0xb87239a8,0xb23e361f
.long 0x80008000,0x80008000,0x80008000,0x80008000,0x3bd9bc00,0x3aa7bb64,0x3872b9a8,0x323eb61f
.long 0xb61f8000,0xbb6439a8,0xbb643c00,0xb61f39a8,0xbaa73c00,0x323e361f,0x3bd9b9a8,0x3872bb64
.long 0x39a88000,0x39a8bc00,0xb9a88000,0xb9a83c00,0x3872bc00,0xbbd9361f,0x323e39a8,0x3aa7bb64
.long 0xbb648000,0x361f39a8,0x361fbc00,0xbb6439a8,0xb23e3c00,0x3872bb64,0xbaa739a8,0x3bd9b61f
.long 0x3c008000,0xbc008000,0x3c008000,0xbc008000,0xb23ebc00,0x38723b64,0xbaa7b9a8,0x3bd9361f
.long 0xbb648000,0x361fb9a8,0x361f3c00,0xbb64b9a8,0x38723c00,0xbbd9b61f,0x323eb9a8,0x3aa73b64
.long 0x39a88000,0x39a83c00,0xb9a88000,0xb9a8bc00,0xbaa7bc00,0x323eb61f,0x3bd939a8,0x38723b64
.long 0xb61f8000,0xbb64b9a8,0xbb64bc00,0xb61fb9a8,0x3bd93c00,0x3aa73b64,0x387239a8,0x323e361f
.long 0x3c003c00,0x3c003c00,0x3c003c00,0x3c003c00,0xbbd9bc00,0xbaa7bb64,0xb872b9a8,0xb23eb61f
.long 0x3b643c00,0x361f39a8,0xb61f0000,0xbb64b9a8,0xbaa7bc00,0x323eb61f,0x3bd939a8,0x38723b64
.long 0x39a83c00,0xb9a80000,0xb9a8bc00,0x39a88000,0xb872bc00,0x3bd9361f,0xb23e39a8,0xbaa7bb64
.long 0x361f3c00,0xbb64b9a8,0x3b648000,0xb61f39a8,0xb23ebc00,0x38723b64,0xbaa7b9a8,0x3bd9361f
.long 0x3c00,0x8000bc00,0x3c00,0x8000bc00,0x323ebc00,0xb8723b64,0x3aa7b9a8,0xbbd9361f
.long 0xb61f3c00,0x3b64b9a8,0xbb640000,0x361f39a8,0x3872bc00,0xbbd9361f,0x323e39a8,0x3aa7bb64
.long 0xb9a83c00,0x39a88000,0x39a8bc00,0xb9a80000,0x3aa7bc00,0xb23eb61f,0xbbd939a8,0xb8723b64
.long 0xbb643c00,0xb61f39a8,0x361f8000,0x3b64b9a8,0x3bd9bc00,0x3aa7bb64,0x3872b9a8,0x323eb61f
.long 0xbc003c00,0xbc003c00,0xbc003c00,0xbc003c00,0x3bd9bc00,0x3aa7bb64,0x3872b9a8,0x323eb61f
.long 0xbb643c00,0xb61f39a8,0x361f0000,0x3b64b9a8,0x3aa7bc00,0xb23eb61f,0xbbd939a8,0xb8723b64
.long 0xb9a83c00,0x39a80000,0x39a8bc00,0xb9a88000,0x3872bc00,0xbbd9361f,0x323e39a8,0x3aa7bb64
.long 0xb61f3c00,0x3b64b9a8,0xbb648000,0x361f39a8,0x323ebc00,0xb8723b64,0x3aa7b9a8,0xbbd9361f
.long 0x80003c00,0xbc00,0x80003c00,0xbc00,0xb23ebc00,0x38723b64,0xbaa7b9a8,0x3bd9361f
.long 0x361f3c00,0xbb64b9a8,0x3b640000,0xb61f39a8,0xb872bc00,0x3bd9361f,0xb23e39a8,0xbaa7bb64
.long 0x39a83c00,0xb9a88000,0xb9a8bc00,0x39a80000,0xbaa7bc00,0x323eb61f,0x3bd939a8,0x38723b64
.long 0x3b643c00,0x361f39a8,0xb61f8000,0xbb64b9a8,0xbbd9bc00,0xbaa7bb64,0xb872b9a8,0xb23eb61f
.long 0x3c003c00,0x3c003c00,0x3c003c00,0x3c003c00,0x323e8000,0x3872361f,0x3aa739a8,0x3bd93b64
.long 0xbb64bc00,0xb61fb9a8,0x361f8000,0x3b6439a8,0xb8720000,0xbbd9bb64,0xb23eb9a8,0x3aa7361f
.long 0x39a83c00,0xb9a80000,0xb9a8bc00,0x39a88000,0x3aa78000,0x323e3b64,0xbbd9b9a8,0x3872b61f
.long 0xb61fbc00,0x3b6439a8,0xbb640000,0x361fb9a8,0xbbd90000,0x3aa7b61f,0xb87239a8,0x323ebb64
.long 0x3c00,0x8000bc00,0x3c00,0x8000bc00,0x3bd98000,0xbaa7b61f,0x387239a8,0xb23ebb64
.long 0x361fbc00,0xbb6439a8,0x3b648000,0xb61fb9a8,0xbaa70000,0xb23e3b64,0x3bd9b9a8,0xb872b61f
.long 0xb9a83c00,0x39a88000,0x39a8bc00,0xb9a80000,0x38728000,0x3bd9bb64,0x323eb9a8,0xbaa7361f
.long 0x3b64bc00,0x361fb9a8,0xb61f0000,0xbb6439a8,0xb23e0000,0xb872361f,0xbaa739a8,0xbbd93b64
.long 0xbc003c00,0xbc003c00,0xbc003c00,0xbc003c00,0xb23e8000,0xb872361f,0xbaa739a8,0xbbd93b64
.long 0x3b64bc00,0x361fb9a8,0xb61f8000,0xbb6439a8,0x38720000,0x3bd9bb64,0x323eb9a8,0xbaa7361f
.long 0xb9a83c00,0x39a80000,0x39a8bc00,0xb9a88000,0xbaa78000,0xb23e3b64,0x3bd9b9a8,0xb872b61f
.long 0x361fbc00,0xbb6439a8,0x3b640000,0xb61fb9a8,0x3bd90000,0xbaa7b61f,0x387239a8,0xb23ebb64
.long 0x80003c00,0xbc00,0x80003c00,0xbc00,0xbbd98000,0x3aa7b61f,0xb87239a8,0x323ebb64
.long 0xb61fbc00,0x3b6439a8,0xbb648000,0x361fb9a8,0x3aa70000,0x323e3b64,0xbbd9b9a8,0x3872b61f
.long 0x39a83c00,0xb9a88000,0xb9a8bc00,0x39a80000,0xb8728000,0xbbd9bb64,0xb23eb9a8,0x3aa7361f
.long 0xbb64bc00,0xb61fb9a8,0x361f0000,0x3b6439a8,0x323e0000,0x3872361f,0x3aa739a8,0x3bd93b64
.long 0x80008000,0x80008000,0x80008000,0x80008000,0x323e8000,0x3872361f,0x3aa739a8,0x3bd93b64
.long 0xb61f8000,0xbb64b9a8,0xbb64bc00,0xb61fb9a8,0x38728000,0x3bd93b64,0x323e39a8,0xbaa7b61f
.long 0xb9a88000,0xb9a8bc00,0x39a88000,0x39a83c00,0x3aa78000,0x323e3b64,0xbbd9b9a8,0x3872b61f
.long 0xbb648000,0x361fb9a8,0x361f3c00,0xbb64b9a8,0x3bd98000,0xbaa7361f,0x3872b9a8,0xb23e3b64
.long 0xbc008000,0x3c008000,0xbc008000,0x3c008000,0x3bd98000,0xbaa7b61f,0x387239a8,0xb23ebb64
.long 0xbb648000,0x361f39a8,0x361fbc00,0xbb6439a8,0x3aa78000,0x323ebb64,0xbbd939a8,0x3872361f
.long 0xb9a88000,0xb9a83c00,0x39a88000,0x39a8bc00,0x38728000,0x3bd9bb64,0x323eb9a8,0xbaa7361f
.long 0xb61f8000,0xbb6439a8,0xbb643c00,0xb61f39a8,0x323e8000,0x3872b61f,0x3aa7b9a8,0x3bd9bb64
.long 0x80008000,0x80008000,0x80008000,0x80008000,0xb23e8000,0xb872361f,0xbaa739a8,0xbbd93b64
.long 0x361f8000,0x3b64b9a8,0x3b64bc00,0x361fb9a8,0xb8728000,0xbbd93b64,0xb23e39a8,0x3aa7b61f
.long 0x39a88000,0x39a8bc00,0xb9a88000,0xb9a83c00,0xbaa78000,0xb23e3b64,0x3bd9b9a8,0xb872b61f
.long 0x3b648000,0xb61fb9a8,0xb61f3c00,0x3b64b9a8,0xbbd98000,0x3aa7361f,0xb872b9a8,0x323e3b64
.long 0x3c008000,0xbc008000,0x3c008000,0xbc008000,0xbbd98000,0x3aa7b61f,0xb87239a8,0x323ebb64
.long 0x3b648000,0xb61f39a8,0xb61fbc00,0x3b6439a8,0xbaa78000,0xb23ebb64,0x3bd939a8,0xb872361f
.long 0x39a88000,0x39a83c00,0xb9a88000,0xb9a8bc00,0xb8728000,0xbbd9bb64,0xb23eb9a8,0x3aa7361f
.long 0x361f8000,0x3b6439a8,0x3b643c00,0x361f39a8,0xb23e8000,0xb872b61f,0xbaa7b9a8,0xbbd9bb64
.long 0x80008000,0x80008000,0x80008000,0x80008000,0x3bd93c00,0x3aa73b64,0x387239a8,0x323e361f
.long 0x361f8000,0x3b6439a8,0x3b643c00,0x361f39a8,0xbaa7bc00,0x323eb61f,0x3bd939a8,0x38723b64
.long 0xb9a88000,0xb9a8bc00,0x39a88000,0x39a83c00,0x38723c00,0xbbd9b61f,0x323eb9a8,0x3aa73b64
.long 0x3b648000,0xb61f39a8,0xb61fbc00,0x3b6439a8,0xb23ebc00,0x38723b64,0xbaa7b9a8,0x3bd9361f
.long 0xbc008000,0x3c008000,0xbc008000,0x3c008000,0xb23e3c00,0x3872bb64,0xbaa739a8,0x3bd9b61f
.long 0x3b648000,0xb61fb9a8,0xb61f3c00,0x3b64b9a8,0x3872bc00,0xbbd9361f,0x323e39a8,0x3aa7bb64
.long 0xb9a88000,0xb9a83c00,0x39a88000,0x39a8bc00,0xbaa73c00,0x323e361f,0x3bd9b9a8,0x3872bb64
.long 0x361f8000,0x3b64b9a8,0x3b64bc00,0x361fb9a8,0x3bd9bc00,0x3aa7bb64,0x3872b9a8,0x323eb61f
.long 0x80008000,0x80008000,0x80008000,0x80008000,0xbbd93c00,0xbaa73b64,0xb87239a8,0xb23e361f
.long 0xb61f8000,0xbb6439a8,0xbb643c00,0xb61f39a8,0x3aa7bc00,0xb23eb61f,0xbbd939a8,0xb8723b64
.long 0x39a88000,0x39a8bc00,0xb9a88000,0xb9a83c00,0xb8723c00,0x3bd9b61f,0xb23eb9a8,0xbaa73b64
.long 0xbb648000,0x361f39a8,0x361fbc00,0xbb6439a8,0x323ebc00,0xb8723b64,0x3aa7b9a8,0xbbd9361f
.long 0x3c008000,0xbc008000,0x3c008000,0xbc008000,0x323e3c00,0xb872bb64,0x3aa739a8,0xbbd9b61f
.long 0xbb648000,0x361fb9a8,0x361f3c00,0xbb64b9a8,0xb872bc00,0x3bd9361f,0xb23e39a8,0xbaa7bb64
.long 0x39a88000,0x39a83c00,0xb9a88000,0xb9a8bc00,0x3aa73c00,0xb23e361f,0xbbd9b9a8,0xb872bb64
.long 0xb61f8000,0xbb64b9a8,0xbb64bc00,0xb61fb9a8,0xbbd9bc00,0xbaa7bb64,0xb872b9a8,0xb23eb61f
.long 0x3c003c00,0x3c003c00,0x3c003c00,0x3c003c00,0x3bd93c00,0x3aa73b64,0xb23e0000,0xb872b61f
.long 0x3b643c00,0x361f39a8,0xbb64bc00,0xb61fb9a8,0x3aa73c00,0xb23e361f,0x38728000,0x3bd93b64
.long 0x39a83c00,0xb9a80000,0x39a83c00,0xb9a80000,0x38723c00,0xbbd9b61f,0xbaa70000,0xb23ebb64
.long 0x361f3c00,0xbb64b9a8,0xb61fbc00,0x3b6439a8,0x323e3c00,0xb872bb64,0x3bd98000,0xbaa7361f
.long 0x3c00,0x8000bc00,0x3c00,0x8000bc00,0xb23e3c00,0x3872bb64,0xbbd90000,0x3aa7361f
.long 0xb61f3c00,0x3b64b9a8,0x361fbc00,0xbb6439a8,0xb8723c00,0x3bd9b61f,0x3aa78000,0x323ebb64
.long 0xb9a83c00,0x39a88000,0xb9a83c00,0x39a88000,0xbaa73c00,0x323e361f,0xb8720000,0xbbd93b64
.long 0xbb643c00,0xb61f39a8,0x3b64bc00,0x361fb9a8,0xbbd93c00,0xbaa73b64,0x323e8000,0x3872b61f
.long 0x80008000,0x80008000,0x80008000,0x80008000,0xb23e8000,0xb872b61f,0xbbd9bc00,0xbaa7bb64
.long 0xb61f8000,0xbb64b9a8,0x361f8000,0x3b6439a8,0xb8728000,0xbbd9bb64,0x3aa73c00,0xb23e361f
.long 0xb9a88000,0xb9a8bc00,0xb9a88000,0xb9a8bc00,0xbaa78000,0xb23ebb64,0xb872bc00,0x3bd9361f
.long 0xbb648000,0x361fb9a8,0x3b648000,0xb61f39a8,0xbbd98000,0x3aa7b61f,0x323e3c00,0xb872bb64
.long 0xbc008000,0x3c008000,0xbc008000,0x3c008000,0xbbd98000,0x3aa7361f,0x323ebc00,0xb8723b64
.long 0xbb648000,0x361f39a8,0x3b648000,0xb61fb9a8,0xbaa78000,0xb23e3b64,0xb8723c00,0x3bd9b61f
.long 0xb9a88000,0xb9a83c00,0xb9a88000,0xb9a83c00,0xb8728000,0xbbd93b64,0x3aa7bc00,0xb23eb61f
.long 0xb61f8000,0xbb6439a8,0x361f8000,0x3b64b9a8,0xb23e8000,0xb872361f,0xbbd93c00,0xbaa73b64
.long 0x3c003c00,0x3c003c00,0x3c003c00,0x3c003c00,0x387239a8,0x323e361f,0xbaa7b9a8,0xbbd9bb64
.long 0xb61f0000,0xbb64b9a8,0x361f8000,0x3b6439a8,0xbbd9b9a8,0xb872bb64,0x323e39a8,0xbaa7b61f
.long 0xb9a8bc00,0x39a88000,0xb9a8bc00,0x39a88000,0x323eb9a8,0x3aa73b64,0x3bd939a8,0xb872361f
.long 0x3b648000,0xb61f39a8,0xbb640000,0x361fb9a8,0x3aa739a8,0xbbd9b61f,0x3872b9a8,0xb23e3b64
.long 0x3c00,0x8000bc00,0x3c00,0x8000bc00,0xbaa739a8,0x3bd9b61f,0xb872b9a8,0x323e3b64
.long 0xbb640000,0x361f39a8,0x3b648000,0xb61fb9a8,0xb23eb9a8,0xbaa73b64,0xbbd939a8,0x3872361f
.long 0x39a8bc00,0xb9a80000,0x39a8bc00,0xb9a80000,0x3bd9b9a8,0x3872bb64,0xb23e39a8,0x3aa7b61f
.long 0x361f8000,0x3b64b9a8,0xb61f0000,0xbb6439a8,0xb87239a8,0xb23e361f,0x3aa7b9a8,0x3bd9bb64
.long 0x80008000,0x80008000,0x80008000,0x80008000,0xbaa7b9a8,0xbbd9bb64,0xb872b9a8,0xb23eb61f
.long 0xbb64bc00,0xb61fb9a8,0x3b643c00,0x361f39a8,0xb23eb9a8,0x3aa7361f,0xbbd9b9a8,0xb872bb64
.long 0x39a88000,0x39a83c00,0x39a88000,0x39a83c00,0x3bd939a8,0xb872361f,0xb23e39a8,0xbaa7bb64
.long 0x361f3c00,0xbb64b9a8,0xb61fbc00,0x3b6439a8,0xb87239a8,0x323ebb64,0x3aa739a8,0xbbd9b61f
.long 0xbc008000,0x3c008000,0xbc008000,0x3c008000,0xb872b9a8,0x323e3b64,0x3aa7b9a8,0xbbd9361f
.long 0x361fbc00,0xbb6439a8,0xb61f3c00,0x3b64b9a8,0x3bd9b9a8,0xb872b61f,0xb23eb9a8,0xbaa73b64
.long 0x39a88000,0x39a8bc00,0x39a88000,0x39a8bc00,0xb23e39a8,0x3aa7b61f,0xbbd939a8,0xb8723b64
.long 0xbb643c00,0xb61f39a8,0x3b64bc00,0x361fb9a8,0xbaa739a8,0xbbd93b64,0xb87239a8,0xb23e361f
.long 0x0,0x0,0x0,0x0,0x323e0000,0x3872361f,0x3bd93c00,0x3aa73b64
.long 0x361f0000,0x3b6439a8,0xb61f0000,0xbb64b9a8,0x38720000,0x3bd93b64,0xbaa7bc00,0x323eb61f
.long 0x39a80000,0x39a83c00,0x39a80000,0x39a83c00,0x3aa70000,0x323e3b64,0x38723c00,0xbbd9b61f
.long 0x3b640000,0xb61f39a8,0xbb640000,0x361fb9a8,0x3bd90000,0xbaa7361f,0xb23ebc00,0x38723b64
.long 0x3c000000,0xbc000000,0x3c000000,0xbc000000,0x3bd90000,0xbaa7b61f,0xb23e3c00,0x3872bb64
.long 0x3b640000,0xb61fb9a8,0xbb640000,0x361f39a8,0x3aa70000,0x323ebb64,0x3872bc00,0xbbd9361f
.long 0x39a80000,0x39a8bc00,0x39a80000,0x39a8bc00,0x38720000,0x3bd9bb64,0xbaa73c00,0x323e361f
.long 0x361f0000,0x3b64b9a8,0xb61f0000,0xbb6439a8,0x323e0000,0x3872b61f,0x3bd9bc00,0x3aa7bb64
.long 0x3c003c00,0x3c003c00,0x3c003c00,0x3c003c00,0x3bd93c00,0x3aa73b64,0xb23e0000,0xb872b61f
.long 0x3b643c00,0x361f39a8,0xbb64bc00,0xb61fb9a8,0x3aa73c00,0xb23e361f,0x38728000,0x3bd93b64
.long 0x39a83c00,0xb9a80000,0x39a83c00,0xb9a80000,0x38723c00,0xbbd9b61f,0xbaa70000,0xb23ebb64
.long 0x361f3c00,0xbb64b9a8,0xb61fbc00,0x3b6439a8,0x323e3c00,0xb872bb64,0x3bd98000,0xbaa7361f
.long 0x3c00,0x8000bc00,0x3c00,0x8000bc00,0xb23e3c00,0x3872bb64,0xbbd90000,0x3aa7361f
.long 0xb61f3c00,0x3b64b9a8,0x361fbc00,0xbb6439a8,0xb8723c00,0x3bd9b61f,0x3aa78000,0x323ebb64
.long 0xb9a83c00,0x39a88000,0xb9a83c00,0x39a88000,0xbaa73c00,0x323e361f,0xb8720000,0xbbd93b64
.long 0xbb643c00,0xb61f39a8,0x3b64bc00,0x361fb9a8,0xbbd93c00,0xbaa73b64,0x323e8000,0x3872b61f
.long 0x0,0x0,0x0,0x0,0x3aa739a8,0x3bd93b64,0x387239a8,0x323e361f
.long 0x3b643c00,0x361f39a8,0xbb64bc00,0xb61fb9a8,0x323e39a8,0xbaa7b61f,0x3bd939a8,0x38723b64
.long 0xb9a80000,0xb9a8bc00,0xb9a80000,0xb9a8bc00,0xbbd9b9a8,0x3872b61f,0x323eb9a8,0x3aa73b64
.long 0xb61fbc00,0x3b6439a8,0x361f3c00,0xbb64b9a8,0x3872b9a8,0xb23e3b64,0xbaa7b9a8,0x3bd9361f
.long 0x3c000000,0xbc000000,0x3c000000,0xbc000000,0x387239a8,0xb23ebb64,0xbaa739a8,0x3bd9b61f
.long 0xb61f3c00,0x3b64b9a8,0x361fbc00,0xbb6439a8,0xbbd939a8,0x3872361f,0x323e39a8,0x3aa7bb64
.long 0xb9a80000,0xb9a83c00,0xb9a80000,0xb9a83c00,0x323eb9a8,0xbaa7361f,0x3bd9b9a8,0x3872bb64
.long 0x3b64bc00,0x361fb9a8,0xbb643c00,0xb61f39a8,0x3aa7b9a8,0x3bd9bb64,0x3872b9a8,0x323eb61f
.long 0x3c003c00,0x3c003c00,0x3c003c00,0x3c003c00,0x387239a8,0x323e361f,0xbaa7b9a8,0xbbd9bb64
.long 0xb61f0000,0xbb64b9a8,0x361f8000,0x3b6439a8,0xbbd9b9a8,0xb872bb64,0x323e39a8,0xbaa7b61f
.long 0xb9a8bc00,0x39a88000,0xb9a8bc00,0x39a88000,0x323eb9a8,0x3aa73b64,0x3bd939a8,0xb872361f
.long 0x3b648000,0xb61f39a8,0xbb640000,0x361fb9a8,0x3aa739a8,0xbbd9b61f,0x3872b9a8,0xb23e3b64
.long 0x3c00,0x8000bc00,0x3c00,0x8000bc00,0xbaa739a8,0x3bd9b61f,0xb872b9a8,0x323e3b64
.long 0xbb640000,0x361f39a8,0x3b648000,0xb61fb9a8,0xb23eb9a8,0xbaa73b64,0xbbd939a8,0x3872361f
.long 0x39a8bc00,0xb9a80000,0x39a8bc00,0xb9a80000,0x3bd9b9a8,0x3872bb64,0xb23e39a8,0x3aa7b61f
.long 0x361f8000,0x3b64b9a8,0xb61f0000,0xbb6439a8,0xb87239a8,0xb23e361f,0x3aa7b9a8,0x3bd9bb64
.long 0x3c003c00,0x3c003c00,0x3c003c00,0x3c003c00,0xbbd9bc00,0xbaa7bb64,0x323e8000,0x3872361f
.long 0x3b643c00,0x361f39a8,0xbb64bc00,0xb61fb9a8,0xbaa7bc00,0x323eb61f,0xb8720000,0xbbd9bb64
.long 0x39a83c00,0xb9a80000,0x39a83c00,0xb9a80000,0xb872bc00,0x3bd9361f,0x3aa78000,0x323e3b64
.long 0x361f3c00,0xbb64b9a8,0xb61fbc00,0x3b6439a8,0xb23ebc00,0x38723b64,0xbbd90000,0x3aa7b61f
.long 0x3c00,0x8000bc00,0x3c00,0x8000bc00,0x323ebc00,0xb8723b64,0x3bd98000,0xbaa7b61f
.long 0xb61f3c00,0x3b64b9a8,0x361fbc00,0xbb6439a8,0x3872bc00,0xbbd9361f,0xbaa70000,0xb23e3b64
.long 0xb9a83c00,0x39a88000,0xb9a83c00,0x39a88000,0x3aa7bc00,0xb23eb61f,0x38728000,0x3bd9bb64
.long 0xbb643c00,0xb61f39a8,0x3b64bc00,0x361fb9a8,0x3bd9bc00,0x3aa7bb64,0xb23e0000,0xb872361f
.long 0x80008000,0x80008000,0x80008000,0x80008000,0x323e8000,0x3872361f,0x3bd93c00,0x3aa73b64
.long 0xb61f8000,0xbb64b9a8,0x361f8000,0x3b6439a8,0x38728000,0x3bd93b64,0xbaa7bc00,0x323eb61f
.long 0xb9a88000,0xb9a8bc00,0xb9a88000,0xb9a8bc00,0x3aa78000,0x323e3b64,0x38723c00,0xbbd9b61f
.long 0xbb648000,0x361fb9a8,0x3b648000,0xb61f39a8,0x3bd98000,0xbaa7361f,0xb23ebc00,0x38723b64
.long 0xbc008000,0x3c008000,0xbc008000,0x3c008000,0x3bd98000,0xbaa7b61f,0xb23e3c00,0x3872bb64
.long 0xbb648000,0x361f39a8,0x3b648000,0xb61fb9a8,0x3aa78000,0x323ebb64,0x3872bc00,0xbbd9361f
.long 0xb9a88000,0xb9a83c00,0xb9a88000,0xb9a83c00,0x38728000,0x3bd9bb64,0xbaa73c00,0x323e361f
.long 0xb61f8000,0xbb6439a8,0x361f8000,0x3b64b9a8,0x323e8000,0x3872b61f,0x3bd9bc00,0x3aa7bb64
.long 0x3c003c00,0x3c003c00,0x3c003c00,0x3c003c00,0xb872b9a8,0xb23eb61f,0x3aa739a8,0x3bd93b64
.long 0xb61f0000,0xbb64b9a8,0x361f8000,0x3b6439a8,0x3bd939a8,0x38723b64,0xb23eb9a8,0x3aa7361f
.long 0xb9a8bc00,0x39a88000,0xb9a8bc00,0x39a88000,0xb23e39a8,0xbaa7bb64,0xbbd9b9a8,0x3872b61f
.long 0x3b648000,0xb61f39a8,0xbb640000,0x361fb9a8,0xbaa7b9a8,0x3bd9361f,0xb87239a8,0x323ebb64
.long 0x3c00,0x8000bc00,0x3c00,0x8000bc00,0x3aa7b9a8,0xbbd9361f,0x387239a8,0xb23ebb64
.long 0xbb640000,0x361f39a8,0x3b648000,0xb61fb9a8,0x323e39a8,0x3aa7bb64,0x3bd9b9a8,0xb872b61f
.long 0x39a8bc00,0xb9a80000,0x39a8bc00,0xb9a80000,0xbbd939a8,0xb8723b64,0x323eb9a8,0xbaa7361f
.long 0x361f8000,0x3b64b9a8,0xb61f0000,0xbb6439a8,0x3872b9a8,0x323eb61f,0xbaa739a8,0xbbd93b64
.long 0x80008000,0x80008000,0x80008000,0x80008000,0x3aa739a8,0x3bd93b64,0x387239a8,0x323e361f
.long 0xbb64bc00,0xb61fb9a8,0x3b643c00,0x361f39a8,0x323e39a8,0xbaa7b61f,0x3bd939a8,0x38723b64
.long 0x39a88000,0x39a83c00,0x39a88000,0x39a83c00,0xbbd9b9a8,0x3872b61f,0x323eb9a8,0x3aa73b64
.long 0x361f3c00,0xbb64b9a8,0xb61fbc00,0x3b6439a8,0x3872b9a8,0xb23e3b64,0xbaa7b9a8,0x3bd9361f
.long 0xbc008000,0x3c008000,0xbc008000,0x3c008000,0x387239a8,0xb23ebb64,0xbaa739a8,0x3bd9b61f
.long 0x361fbc00,0xbb6439a8,0xb61f3c00,0x3b64b9a8,0xbbd939a8,0x3872361f,0x323e39a8,0x3aa7bb64
.long 0x39a88000,0x39a8bc00,0x39a88000,0x39a8bc00,0x323eb9a8,0xbaa7361f,0x3bd9b9a8,0x3872bb64
.long 0xbb643c00,0xb61f39a8,0x3b64bc00,0x361fb9a8,0x3aa7b9a8,0x3bd9bb64,0x3872b9a8,0x323eb61f
.long 0x0,0x0,0x0,0x0,0xb23e0000,0xb872b61f,0xbbd9bc00,0xbaa7bb64
.long 0x361f0000,0x3b6439a8,0xb61f0000,0xbb64b9a8,0xb8720000,0xbbd9bb64,0x3aa73c00,0xb23e361f
.long 0x39a80000,0x39a83c00,0x39a80000,0x39a83c00,0xbaa70000,0xb23ebb64,0xb872bc00,0x3bd9361f
.long 0x3b640000,0xb61f39a8,0xbb640000,0x361fb9a8,0xbbd90000,0x3aa7b61f,0x323e3c00,0xb872bb64
.long 0x3c000000,0xbc000000,0x3c000000,0xbc000000,0xbbd90000,0x3aa7361f,0x323ebc00,0xb8723b64
.long 0x3b640000,0xb61fb9a8,0xbb640000,0x361f39a8,0xbaa70000,0xb23e3b64,0xb8723c00,0x3bd9b61f
.long 0x39a80000,0x39a8bc00,0x39a80000,0x39a8bc00,0xb8720000,0xbbd93b64,0x3aa7bc00,0xb23eb61f
.long 0x361f0000,0x3b64b9a8,0xb61f0000,0xbb6439a8,0xb23e0000,0xb872361f,0xbbd93c00,0xbaa73b64
.long 0x3c003c00,0x3c003c00,0x3c003c00,0x3c003c00,0xbbd9bc00,0xbaa7bb64,0x323e8000,0x3872361f
.long 0x3b643c00,0x361f39a8,0xbb64bc00,0xb61fb9a8,0xbaa7bc00,0x323eb61f,0xb8720000,0xbbd9bb64
.long 0x39a83c00,0xb9a80000,0x39a83c00,0xb9a80000,0xb872bc00,0x3bd9361f,0x3aa78000,0x323e3b64
.long 0x361f3c00,0xbb64b9a8,0xb61fbc00,0x3b6439a8,0xb23ebc00,0x38723b64,0xbbd90000,0x3aa7b61f
.long 0x3c00,0x8000bc00,0x3c00,0x8000bc00,0x323ebc00,0xb8723b64,0x3bd98000,0xbaa7b61f
.long 0xb61f3c00,0x3b64b9a8,0x361fbc00,0xbb6439a8,0x3872bc00,0xbbd9361f,0xbaa70000,0xb23e3b64
.long 0xb9a83c00,0x39a88000,0xb9a83c00,0x39a88000,0x3aa7bc00,0xb23eb61f,0x38728000,0x3bd9bb64
.long 0xbb643c00,0xb61f39a8,0x3b64bc00,0x361fb9a8,0x3bd9bc00,0x3aa7bb64,0xb23e0000,0xb872361f
.long 0x0,0x0,0x0,0x0,0xbaa7b9a8,0xbbd9bb64,0xb872b9a8,0xb23eb61f
.long 0x3b643c00,0x361f39a8,0xbb64bc00,0xb61fb9a8,0xb23eb9a8,0x3aa7361f,0xbbd9b9a8,0xb872bb64
.long 0xb9a80000,0xb9a8bc00,0xb9a80000,0xb9a8bc00,0x3bd939a8,0xb872361f,0xb23e39a8,0xbaa7bb64
.long 0xb61fbc00,0x3b6439a8,0x361f3c00,0xbb64b9a8,0xb87239a8,0x323ebb64,0x3aa739a8,0xbbd9b61f
.long 0x3c000000,0xbc000000,0x3c000000,0xbc000000,0xb872b9a8,0x323e3b64,0x3aa7b9a8,0xbbd9361f
.long 0xb61f3c00,0x3b64b9a8,0x361fbc00,0xbb6439a8,0x3bd9b9a8,0xb872b61f,0xb23eb9a8,0xbaa73b64
.long 0xb9a80000,0xb9a83c00,0xb9a80000,0xb9a83c00,0xb23e39a8,0x3aa7b61f,0xbbd939a8,0xb8723b64
.long 0x3b64bc00,0x361fb9a8,0xbb643c00,0xb61f39a8,0xbaa739a8,0xbbd93b64,0xb87239a8,0xb23e361f
.long 0x3c003c00,0x3c003c00,0x3c003c00,0x3c003c00,0xb872b9a8,0xb23eb61f,0x3aa739a8,0x3bd93b64
.long 0xb61f0000,0xbb64b9a8,0x361f8000,0x3b6439a8,0x3bd939a8,0x38723b64,0xb23eb9a8,0x3aa7361f
.long 0xb9a8bc00,0x39a88000,0xb9a8bc00,0x39a88000,0xb23e39a8,0xbaa7bb64,0xbbd9b9a8,0x3872b61f
.long 0x3b648000,0xb61f39a8,0xbb640000,0x361fb9a8,0xbaa7b9a8,0x3bd9361f,0xb87239a8,0x323ebb64
.long 0x3c00,0x8000bc00,0x3c00,0x8000bc00,0x3aa7b9a8,0xbbd9361f,0x387239a8,0xb23ebb64
.long 0xbb640000,0x361f39a8,0x3b648000,0xb61fb9a8,0x323e39a8,0x3aa7bb64,0x3bd9b9a8,0xb872b61f
.long 0x39a8bc00,0xb9a80000,0x39a8bc00,0xb9a80000,0xbbd939a8,0xb8723b64,0x323eb9a8,0xbaa7361f
.long 0x361f8000,0x3b64b9a8,0xb61f0000,0xbb6439a8,0x3872b9a8,0x323eb61f,0xbaa739a8,0xbbd93b64
.long 0x3c003c00,0x3c003c00,0x3c003c00,0x3c003c00,0x3bd93c00,0x3aa73b64,0xbbd9bc00,0xbaa7bb64
.long 0x3b643c00,0x361f39a8,0x3b643c00,0x361f39a8,0x3aa73c00,0xb23e361f,0xbaa7bc00,0x323eb61f
.long 0x39a83c00,0xb9a80000,0x39a83c00,0xb9a80000,0x38723c00,0xbbd9b61f,0xb872bc00,0x3bd9361f
.long 0x361f3c00,0xbb64b9a8,0x361f3c00,0xbb64b9a8,0x323e3c00,0xb872bb64,0xb23ebc00,0x38723b64
.long 0x3c00,0x8000bc00,0x3c00,0x8000bc00,0xb23e3c00,0x3872bb64,0x323ebc00,0xb8723b64
.long 0xb61f3c00,0x3b64b9a8,0xb61f3c00,0x3b64b9a8,0xb8723c00,0x3bd9b61f,0x3872bc00,0xbbd9361f
.long 0xb9a83c00,0x39a88000,0xb9a83c00,0x39a88000,0xbaa73c00,0x323e361f,0x3aa7bc00,0xb23eb61f
.long 0xbb643c00,0xb61f39a8,0xbb643c00,0xb61f39a8,0xbbd93c00,0xbaa73b64,0x3bd9bc00,0x3aa7bb64
.long 0x3c003c00,0x3c003c00,0x3c003c00,0x3c003c00,0x387239a8,0x323e361f,0xb872b9a8,0xb23eb61f
.long 0xb61f0000,0xbb64b9a8,0xb61f0000,0xbb64b9a8,0xbbd9b9a8,0xb872bb64,0x3bd939a8,0x38723b64
.long 0xb9a8bc00,0x39a88000,0xb9a8bc00,0x39a88000,0x323eb9a8,0x3aa73b64,0xb23e39a8,0xbaa7bb64
.long 0x3b648000,0xb61f39a8,0x3b648000,0xb61f39a8,0x3aa739a8,0xbbd9b61f,0xbaa7b9a8,0x3bd9361f
.long 0x3c00,0x8000bc00,0x3c00,0x8000bc00,0xbaa739a8,0x3bd9b61f,0x3aa7b9a8,0xbbd9361f
.long 0xbb640000,0x361f39a8,0xbb640000,0x361f39a8,0xb23eb9a8,0xbaa73b64,0x323e39a8,0x3aa7bb64
.long 0x39a8bc00,0xb9a80000,0x39a8bc00,0xb9a80000,0x3bd9b9a8,0x3872bb64,0xbbd939a8,0xb8723b64
.long 0x361f8000,0x3b64b9a8,0x361f8000,0x3b64b9a8,0xb87239a8,0xb23e361f,0x3872b9a8,0x323eb61f
.long 0x3c003c00,0x3c003c00,0x3c003c00,0x3c003c00,0xb23e0000,0xb872b61f,0x323e8000,0x3872361f
.long 0xbb64bc00,0xb61fb9a8,0xbb64bc00,0xb61fb9a8,0x38728000,0x3bd93b64,0xb8720000,0xbbd9bb64
.long 0x39a83c00,0xb9a80000,0x39a83c00,0xb9a80000,0xbaa70000,0xb23ebb64,0x3aa78000,0x323e3b64
.long 0xb61fbc00,0x3b6439a8,0xb61fbc00,0x3b6439a8,0x3bd98000,0xbaa7361f,0xbbd90000,0x3aa7b61f
.long 0x3c00,0x8000bc00,0x3c00,0x8000bc00,0xbbd90000,0x3aa7361f,0x3bd98000,0xbaa7b61f
.long 0x361fbc00,0xbb6439a8,0x361fbc00,0xbb6439a8,0x3aa78000,0x323ebb64,0xbaa70000,0xb23e3b64
.long 0xb9a83c00,0x39a88000,0xb9a83c00,0x39a88000,0xb8720000,0xbbd93b64,0x38728000,0x3bd9bb64
.long 0x3b64bc00,0x361fb9a8,0x3b64bc00,0x361fb9a8,0x323e8000,0x3872b61f,0xb23e0000,0xb872361f
.long 0x3c003c00,0x3c003c00,0x3c003c00,0x3c003c00,0xbaa7b9a8,0xbbd9bb64,0x3aa739a8,0x3bd93b64
.long 0x361f8000,0x3b6439a8,0x361f8000,0x3b6439a8,0x323e39a8,0xbaa7b61f,0xb23eb9a8,0x3aa7361f
.long 0xb9a8bc00,0x39a88000,0xb9a8bc00,0x39a88000,0x3bd939a8,0xb872361f,0xbbd9b9a8,0x3872b61f
.long 0xbb640000,0x361fb9a8,0xbb640000,0x361fb9a8,0x3872b9a8,0xb23e3b64,0xb87239a8,0x323ebb64
.long 0x3c00,0x8000bc00,0x3c00,0x8000bc00,0xb872b9a8,0x323e3b64,0x387239a8,0xb23ebb64
.long 0x3b648000,0xb61fb9a8,0x3b648000,0xb61fb9a8,0xbbd939a8,0x3872361f,0x3bd9b9a8,0xb872b61f
.long 0x39a8bc00,0xb9a80000,0x39a8bc00,0xb9a80000,0xb23e39a8,0x3aa7b61f,0x323eb9a8,0xbaa7361f
.long 0xb61f0000,0xbb6439a8,0xb61f0000,0xbb6439a8,0x3aa7b9a8,0x3bd9bb64,0xbaa739a8,0xbbd93b64
.long 0xbc003c00,0xbc003c00,0xbc003c00,0xbc003c00,0xbbd93c00,0xbaa73b64,0x3bd9bc00,0x3aa7bb64
.long 0xbb643c00,0xb61f39a8,0xbb643c00,0xb61f39a8,0xbaa73c00,0x323e361f,0x3aa7bc00,0xb23eb61f
.long 0xb9a83c00,0x39a80000,0xb9a83c00,0x39a80000,0xb8723c00,0x3bd9b61f,0x3872bc00,0xbbd9361f
.long 0xb61f3c00,0x3b64b9a8,0xb61f3c00,0x3b64b9a8,0xb23e3c00,0x3872bb64,0x323ebc00,0xb8723b64
.long 0x80003c00,0xbc00,0x80003c00,0xbc00,0x323e3c00,0xb872bb64,0xb23ebc00,0x38723b64
.long 0x361f3c00,0xbb64b9a8,0x361f3c00,0xbb64b9a8,0x38723c00,0xbbd9b61f,0xb872bc00,0x3bd9361f
.long 0x39a83c00,0xb9a88000,0x39a83c00,0xb9a88000,0x3aa73c00,0xb23e361f,0xbaa7bc00,0x323eb61f
.long 0x3b643c00,0x361f39a8,0x3b643c00,0x361f39a8,0x3bd93c00,0x3aa73b64,0xbbd9bc00,0xbaa7bb64
.long 0xbc003c00,0xbc003c00,0xbc003c00,0xbc003c00,0xb87239a8,0xb23e361f,0x3872b9a8,0x323eb61f
.long 0x361f0000,0x3b64b9a8,0x361f0000,0x3b64b9a8,0x3bd9b9a8,0x3872bb64,0xbbd939a8,0xb8723b64
.long 0x39a8bc00,0xb9a88000,0x39a8bc00,0xb9a88000,0xb23eb9a8,0xbaa73b64,0x323e39a8,0x3aa7bb64
.long 0xbb648000,0x361f39a8,0xbb648000,0x361f39a8,0xbaa739a8,0x3bd9b61f,0x3aa7b9a8,0xbbd9361f
.long 0x80003c00,0xbc00,0x80003c00,0xbc00,0x3aa739a8,0xbbd9b61f,0xbaa7b9a8,0x3bd9361f
.long 0x3b640000,0xb61f39a8,0x3b640000,0xb61f39a8,0x323eb9a8,0x3aa73b64,0xb23e39a8,0xbaa7bb64
.long 0xb9a8bc00,0x39a80000,0xb9a8bc00,0x39a80000,0xbbd9b9a8,0xb872bb64,0x3bd939a8,0x38723b64
.long 0xb61f8000,0xbb64b9a8,0xb61f8000,0xbb64b9a8,0x387239a8,0x323e361f,0xb872b9a8,0xb23eb61f
.long 0xbc003c00,0xbc003c00,0xbc003c00,0xbc003c00,0x323e0000,0x3872b61f,0xb23e8000,0xb872361f
.long 0x3b64bc00,0x361fb9a8,0x3b64bc00,0x361fb9a8,0xb8728000,0xbbd93b64,0x38720000,0x3bd9bb64
.long 0xb9a83c00,0x39a80000,0xb9a83c00,0x39a80000,0x3aa70000,0x323ebb64,0xbaa78000,0xb23e3b64
.long 0x361fbc00,0xbb6439a8,0x361fbc00,0xbb6439a8,0xbbd98000,0x3aa7361f,0x3bd90000,0xbaa7b61f
.long 0x80003c00,0xbc00,0x80003c00,0xbc00,0x3bd90000,0xbaa7361f,0xbbd98000,0x3aa7b61f
.long 0xb61fbc00,0x3b6439a8,0xb61fbc00,0x3b6439a8,0xbaa78000,0xb23ebb64,0x3aa70000,0x323e3b64
.long 0x39a83c00,0xb9a88000,0x39a83c00,0xb9a88000,0x38720000,0x3bd93b64,0xb8728000,0xbbd9bb64
.long 0xbb64bc00,0xb61fb9a8,0xbb64bc00,0xb61fb9a8,0xb23e8000,0xb872b61f,0x323e0000,0x3872361f
.long 0xbc003c00,0xbc003c00,0xbc003c00,0xbc003c00,0x3aa7b9a8,0x3bd9bb64,0xbaa739a8,0xbbd93b64
.long 0xb61f8000,0xbb6439a8,0xb61f8000,0xbb6439a8,0xb23e39a8,0x3aa7b61f,0x323eb9a8,0xbaa7361f
.long 0x39a8bc00,0xb9a88000,0x39a8bc00,0xb9a88000,0xbbd939a8,0x3872361f,0x3bd9b9a8,0xb872b61f
.long 0x3b640000,0xb61fb9a8,0x3b640000,0xb61fb9a8,0xb872b9a8,0x323e3b64,0x387239a8,0xb23ebb64
.long 0x80003c00,0xbc00,0x80003c00,0xbc00,0x3872b9a8,0xb23e3b64,0xb87239a8,0x323ebb64
.long 0xbb648000,0x361fb9a8,0xbb648000,0x361fb9a8,0x3bd939a8,0xb872361f,0xbbd9b9a8,0x3872b61f
.long 0xb9a8bc00,0x39a80000,0xb9a8bc00,0x39a80000,0x323e39a8,0xbaa7b61f,0xb23eb9a8,0x3aa7361f
.long 0x361f0000,0x3b6439a8,0x361f0000,0x3b6439a8,0xbaa7b9a8,0xbbd9bb64,0x3aa739a8,0x3bd93b64
.long 0x0,0x0,0x0,0x0,0x323e0000,0x3872361f,0xb23e0000,0xb872b61f
.long 0x361f0000,0x3b6439a8,0x361f0000,0x3b6439a8,0x38720000,0x3bd93b64,0xb8720000,0xbbd9bb64
.long 0x39a80000,0x39a83c00,0x39a80000,0x39a83c00,0x3aa70000,0x323e3b64,0xbaa70000,0xb23ebb64
.long 0x3b640000,0xb61f39a8,0x3b640000,0xb61f39a8,0x3bd90000,0xbaa7361f,0xbbd90000,0x3aa7b61f
.long 0x3c000000,0xbc000000,0x3c000000,0xbc000000,0x3bd90000,0xbaa7b61f,0xbbd90000,0x3aa7361f
.long 0x3b640000,0xb61fb9a8,0x3b640000,0xb61fb9a8,0x3aa70000,0x323ebb64,0xbaa70000,0xb23e3b64
.long 0x39a80000,0x39a8bc00,0x39a80000,0x39a8bc00,0x38720000,0x3bd9bb64,0xb8720000,0xbbd93b64
.long 0x361f0000,0x3b64b9a8,0x361f0000,0x3b64b9a8,0x323e0000,0x3872b61f,0xb23e0000,0xb872361f
.long 0x0,0x0,0x0,0x0,0x3aa739a8,0x3bd93b64,0xbaa7b9a8,0xbbd9bb64
.long 0x3b643c00,0x361f39a8,0x3b643c00,0x361f39a8,0x323e39a8,0xbaa7b61f,0xb23eb9a8,0x3aa7361f
.long 0xb9a80000,0xb9a8bc00,0xb9a80000,0xb9a8bc00,0xbbd9b9a8,0x3872b61f,0x3bd939a8,0xb872361f
.long 0xb61fbc00,0x3b6439a8,0xb61fbc00,0x3b6439a8,0x3872b9a8,0xb23e3b64,0xb87239a8,0x323ebb64
.long 0x3c000000,0xbc000000,0x3c000000,0xbc000000,0x387239a8,0xb23ebb64,0xb872b9a8,0x323e3b64
.long 0xb61f3c00,0x3b64b9a8,0xb61f3c00,0x3b64b9a8,0xbbd939a8,0x3872361f,0x3bd9b9a8,0xb872b61f
.long 0xb9a80000,0xb9a83c00,0xb9a80000,0xb9a83c00,0x323eb9a8,0xbaa7361f,0xb23e39a8,0x3aa7b61f
.long 0x3b64bc00,0x361fb9a8,0x3b64bc00,0x361fb9a8,0x3aa7b9a8,0x3bd9bb64,0xbaa739a8,0xbbd93b64
.long 0x0,0x0,0x0,0x0,0x3bd93c00,0x3aa73b64,0xbbd9bc00,0xbaa7bb64
.long 0xb61f0000,0xbb64b9a8,0xb61f0000,0xbb64b9a8,0xbaa7bc00,0x323eb61f,0x3aa73c00,0xb23e361f
.long 0x39a80000,0x39a83c00,0x39a80000,0x39a83c00,0x38723c00,0xbbd9b61f,0xb872bc00,0x3bd9361f
.long 0xbb640000,0x361fb9a8,0xbb640000,0x361fb9a8,0xb23ebc00,0x38723b64,0x323e3c00,0xb872bb64
.long 0x3c000000,0xbc000000,0x3c000000,0xbc000000,0xb23e3c00,0x3872bb64,0x323ebc00,0xb8723b64
.long 0xbb640000,0x361f39a8,0xbb640000,0x361f39a8,0x3872bc00,0xbbd9361f,0xb8723c00,0x3bd9b61f
.long 0x39a80000,0x39a8bc00,0x39a80000,0x39a8bc00,0xbaa73c00,0x323e361f,0x3aa7bc00,0xb23eb61f
.long 0xb61f0000,0xbb6439a8,0xb61f0000,0xbb6439a8,0x3bd9bc00,0x3aa7bb64,0xbbd93c00,0xbaa73b64
.long 0x0,0x0,0x0,0x0,0x387239a8,0x323e361f,0xb872b9a8,0xb23eb61f
.long 0xbb64bc00,0xb61fb9a8,0xbb64bc00,0xb61fb9a8,0x3bd939a8,0x38723b64,0xbbd9b9a8,0xb872bb64
.long 0xb9a80000,0xb9a8bc00,0xb9a80000,0xb9a8bc00,0x323eb9a8,0x3aa73b64,0xb23e39a8,0xbaa7bb64
.long 0x361f3c00,0xbb64b9a8,0x361f3c00,0xbb64b9a8,0xbaa7b9a8,0x3bd9361f,0x3aa739a8,0xbbd9b61f
.long 0x3c000000,0xbc000000,0x3c000000,0xbc000000,0xbaa739a8,0x3bd9b61f,0x3aa7b9a8,0xbbd9361f
.long 0x361fbc00,0xbb6439a8,0x361fbc00,0xbb6439a8,0x323e39a8,0x3aa7bb64,0xb23eb9a8,0xbaa73b64
.long 0xb9a80000,0xb9a83c00,0xb9a80000,0xb9a83c00,0x3bd9b9a8,0x3872bb64,0xbbd939a8,0xb8723b64
.long 0xbb643c00,0xb61f39a8,0xbb643c00,0xb61f39a8,0x3872b9a8,0x323eb61f,0xb87239a8,0xb23e361f
.long 0x0,0x0,0x0,0x0,0xb23e0000,0xb872361f,0x323e0000,0x3872b61f
.long 0xb61f0000,0xbb6439a8,0xb61f0000,0xbb6439a8,0xb8720000,0xbbd93b64,0x38720000,0x3bd9bb64
.long 0xb9a80000,0xb9a83c00,0xb9a80000,0xb9a83c00,0xbaa70000,0xb23e3b64,0x3aa70000,0x323ebb64
.long 0xbb640000,0x361f39a8,0xbb640000,0x361f39a8,0xbbd90000,0x3aa7361f,0x3bd90000,0xbaa7b61f
.long 0xbc000000,0x3c000000,0xbc000000,0x3c000000,0xbbd90000,0x3aa7b61f,0x3bd90000,0xbaa7361f
.long 0xbb640000,0x361fb9a8,0xbb640000,0x361fb9a8,0xbaa70000,0xb23ebb64,0x3aa70000,0x323e3b64
.long 0xb9a80000,0xb9a8bc00,0xb9a80000,0xb9a8bc00,0xb8720000,0xbbd9bb64,0x38720000,0x3bd93b64
.long 0xb61f0000,0xbb64b9a8,0xb61f0000,0xbb64b9a8,0xb23e0000,0xb872b61f,0x323e0000,0x3872361f
.long 0x0,0x0,0x0,0x0,0xbaa739a8,0xbbd93b64,0x3aa7b9a8,0x3bd9bb64
.long 0xbb643c00,0xb61f39a8,0xbb643c00,0xb61f39a8,0xb23e39a8,0x3aa7b61f,0x323eb9a8,0xbaa7361f
.long 0x39a80000,0x39a8bc00,0x39a80000,0x39a8bc00,0x3bd9b9a8,0xb872b61f,0xbbd939a8,0x3872361f
.long 0x361fbc00,0xbb6439a8,0x361fbc00,0xbb6439a8,0xb872b9a8,0x323e3b64,0x387239a8,0xb23ebb64
.long 0xbc000000,0x3c000000,0xbc000000,0x3c000000,0xb87239a8,0x323ebb64,0x3872b9a8,0xb23e3b64
.long 0x361f3c00,0xbb64b9a8,0x361f3c00,0xbb64b9a8,0x3bd939a8,0xb872361f,0xbbd9b9a8,0x3872b61f
.long 0x39a80000,0x39a83c00,0x39a80000,0x39a83c00,0xb23eb9a8,0x3aa7361f,0x323e39a8,0xbaa7b61f
.long 0xbb64bc00,0xb61fb9a8,0xbb64bc00,0xb61fb9a8,0xbaa7b9a8,0xbbd9bb64,0x3aa739a8,0x3bd93b64
.long 0x0,0x0,0x0,0x0,0xbbd93c00,0xbaa73b64,0x3bd9bc00,0x3aa7bb64
.long 0x361f0000,0x3b64b9a8,0x361f0000,0x3b64b9a8,0x3aa7bc00,0xb23eb61f,0xbaa73c00,0x323e361f
.long 0xb9a80000,0xb9a83c00,0xb9a80000,0xb9a83c00,0xb8723c00,0x3bd9b61f,0x3872bc00,0xbbd9361f
.long 0x3b640000,0xb61fb9a8,0x3b640000,0xb61fb9a8,0x323ebc00,0xb8723b64,0xb23e3c00,0x3872bb64
.long 0xbc000000,0x3c000000,0xbc000000,0x3c000000,0x323e3c00,0xb872bb64,0xb23ebc00,0x38723b64
.long 0x3b640000,0xb61f39a8,0x3b640000,0xb61f39a8,0xb872bc00,0x3bd9361f,0x38723c00,0xbbd9b61f
.long 0xb9a80000,0xb9a8bc00,0xb9a80000,0xb9a8bc00,0x3aa73c00,0xb23e361f,0xbaa7bc00,0x323eb61f
.long 0x361f0000,0x3b6439a8,0x361f0000,0x3b6439a8,0xbbd9bc00,0xbaa7bb64,0x3bd93c00,0x3aa73b64
.long 0x0,0x0,0x0,0x0,0xb87239a8,0xb23e361f,0x3872b9a8,0x323eb61f
.long 0x3b64bc00,0x361fb9a8,0x3b64bc00,0x361fb9a8,0xbbd939a8,0xb8723b64,0x3bd9b9a8,0x3872bb64
.long 0x39a80000,0x39a8bc00,0x39a80000,0x39a8bc00,0xb23eb9a8,0xbaa73b64,0x323e39a8,0x3aa7bb64
.long 0xb61f3c00,0x3b64b9a8,0xb61f3c00,0x3b64b9a8,0x3aa7b9a8,0xbbd9361f,0xbaa739a8,0x3bd9b61f
.long 0xbc000000,0x3c000000,0xbc000000,0x3c000000,0x3aa739a8,0xbbd9b61f,0xbaa7b9a8,0x3bd9361f
.long 0xb61fbc00,0x3b6439a8,0xb61fbc00,0x3b6439a8,0xb23e39a8,0xbaa7bb64,0x323eb9a8,0x3aa73b64
.long 0x39a80000,0x39a83c00,0x39a80000,0x39a83c00,0xbbd9b9a8,0xb872bb64,0x3bd939a8,0x38723b64
.long 0x3b643c00,0x361f39a8,0x3b643c00,0x361f39a8,0xb872b9a8,0xb23eb61f,0x387239a8,0x323e361f
.long 0x80008000,0x80008000,0x80008000,0x80008000,0xb23e8000,0xb872b61f,0x323e8000,0x3872361f
.long 0xb61f8000,0xbb64b9a8,0xb61f8000,0xbb64b9a8,0xb8728000,0xbbd9bb64,0x38728000,0x3bd93b64
.long 0xb9a88000,0xb9a8bc00,0xb9a88000,0xb9a8bc00,0xbaa78000,0xb23ebb64,0x3aa78000,0x323e3b64
.long 0xbb648000,0x361fb9a8,0xbb648000,0x361fb9a8,0xbbd98000,0x3aa7b61f,0x3bd98000,0xbaa7361f
.long 0xbc008000,0x3c008000,0xbc008000,0x3c008000,0xbbd98000,0x3aa7361f,0x3bd98000,0xbaa7b61f
.long 0xbb648000,0x361f39a8,0xbb648000,0x361f39a8,0xbaa78000,0xb23e3b64,0x3aa78000,0x323ebb64
.long 0xb9a88000,0xb9a83c00,0xb9a88000,0xb9a83c00,0xb8728000,0xbbd93b64,0x38728000,0x3bd9bb64
.long 0xb61f8000,0xbb6439a8,0xb61f8000,0xbb6439a8,0xb23e8000,0xb872361f,0x323e8000,0x3872b61f
.long 0x80008000,0x80008000,0x80008000,0x80008000,0xbaa7b9a8,0xbbd9bb64,0x3aa739a8,0x3bd93b64
.long 0xbb64bc00,0xb61fb9a8,0xbb64bc00,0xb61fb9a8,0xb23eb9a8,0x3aa7361f,0x323e39a8,0xbaa7b61f
.long 0x39a88000,0x39a83c00,0x39a88000,0x39a83c00,0x3bd939a8,0xb872361f,0xbbd9b9a8,0x3872b61f
.long 0x361f3c00,0xbb64b9a8,0x361f3c00,0xbb64b9a8,0xb87239a8,0x323ebb64,0x3872b9a8,0xb23e3b64
.long 0xbc008000,0x3c008000,0xbc008000,0x3c008000,0xb872b9a8,0x323e3b64,0x387239a8,0xb23ebb64
.long 0x361fbc00,0xbb6439a8,0x361fbc00,0xbb6439a8,0x3bd9b9a8,0xb872b61f,0xbbd939a8,0x3872361f
.long 0x39a88000,0x39a8bc00,0x39a88000,0x39a8bc00,0xb23e39a8,0x3aa7b61f,0x323eb9a8,0xbaa7361f
.long 0xbb643c00,0xb61f39a8,0xbb643c00,0xb61f39a8,0xbaa739a8,0xbbd93b64,0x3aa7b9a8,0x3bd9bb64
.long 0x80008000,0x80008000,0x80008000,0x80008000,0xbbd9bc00,0xbaa7bb64,0x3bd93c00,0x3aa73b64
.long 0x361f8000,0x3b6439a8,0x361f8000,0x3b6439a8,0x3aa73c00,0xb23e361f,0xbaa7bc00,0x323eb61f
.long 0xb9a88000,0xb9a8bc00,0xb9a88000,0xb9a8bc00,0xb872bc00,0x3bd9361f,0x38723c00,0xbbd9b61f
.long 0x3b648000,0xb61f39a8,0x3b648000,0xb61f39a8,0x323e3c00,0xb872bb64,0xb23ebc00,0x38723b64
.long 0xbc008000,0x3c008000,0xbc008000,0x3c008000,0x323ebc00,0xb8723b64,0xb23e3c00,0x3872bb64
.long 0x3b648000,0xb61fb9a8,0x3b648000,0xb61fb9a8,0xb8723c00,0x3bd9b61f,0x3872bc00,0xbbd9361f
.long 0xb9a88000,0xb9a83c00,0xb9a88000,0xb9a83c00,0x3aa7bc00,0xb23eb61f,0xbaa73c00,0x323e361f
.long 0x361f8000,0x3b64b9a8,0x361f8000,0x3b64b9a8,0xbbd93c00,0xbaa73b64,0x3bd9bc00,0x3aa7bb64
.long 0x80008000,0x80008000,0x80008000,0x80008000,0xb872b9a8,0xb23eb61f,0x387239a8,0x323e361f
.long 0x3b643c00,0x361f39a8,0x3b643c00,0x361f39a8,0xbbd9b9a8,0xb872bb64,0x3bd939a8,0x38723b64
.long 0x39a88000,0x39a83c00,0x39a88000,0x39a83c00,0xb23e39a8,0xbaa7bb64,0x323eb9a8,0x3aa73b64
.long 0xb61fbc00,0x3b6439a8,0xb61fbc00,0x3b6439a8,0x3aa739a8,0xbbd9b61f,0xbaa7b9a8,0x3bd9361f
.long 0xbc008000,0x3c008000,0xbc008000,0x3c008000,0x3aa7b9a8,0xbbd9361f,0xbaa739a8,0x3bd9b61f
.long 0xb61f3c00,0x3b64b9a8,0xb61f3c00,0x3b64b9a8,0xb23eb9a8,0xbaa73b64,0x323e39a8,0x3aa7bb64
.long 0x39a88000,0x39a8bc00,0x39a88000,0x39a8bc00,0xbbd939a8,0xb8723b64,0x3bd9b9a8,0x3872bb64
.long 0x3b64bc00,0x361fb9a8,0x3b64bc00,0x361fb9a8,0xb87239a8,0xb23e361f,0x3872b9a8,0x323eb61f
.long 0x80008000,0x80008000,0x80008000,0x80008000,0x323e8000,0x3872b61f,0xb23e8000,0xb872361f
.long 0x361f8000,0x3b64b9a8,0x361f8000,0x3b64b9a8,0x38728000,0x3bd9bb64,0xb8728000,0xbbd93b64
.long 0x39a88000,0x39a8bc00,0x39a88000,0x39a8bc00,0x3aa78000,0x323ebb64,0xbaa78000,0xb23e3b64
.long 0x3b648000,0xb61fb9a8,0x3b648000,0xb61fb9a8,0x3bd98000,0xbaa7b61f,0xbbd98000,0x3aa7361f
.long 0x3c008000,0xbc008000,0x3c008000,0xbc008000,0x3bd98000,0xbaa7361f,0xbbd98000,0x3aa7b61f
.long 0x3b648000,0xb61f39a8,0x3b648000,0xb61f39a8,0x3aa78000,0x323e3b64,0xbaa78000,0xb23ebb64
.long 0x39a88000,0x39a83c00,0x39a88000,0x39a83c00,0x38728000,0x3bd93b64,0xb8728000,0xbbd9bb64
.long 0x361f8000,0x3b6439a8,0x361f8000,0x3b6439a8,0x323e8000,0x3872361f,0xb23e8000,0xb872b61f
.long 0x80008000,0x80008000,0x80008000,0x80008000,0x3aa7b9a8,0x3bd9bb64,0xbaa739a8,0xbbd93b64
.long 0x3b64bc00,0x361fb9a8,0x3b64bc00,0x361fb9a8,0x323eb9a8,0xbaa7361f,0xb23e39a8,0x3aa7b61f
.long 0xb9a88000,0xb9a83c00,0xb9a88000,0xb9a83c00,0xbbd939a8,0x3872361f,0x3bd9b9a8,0xb872b61f
.long 0xb61f3c00,0x3b64b9a8,0xb61f3c00,0x3b64b9a8,0x387239a8,0xb23ebb64,0xb872b9a8,0x323e3b64
.long 0x3c008000,0xbc008000,0x3c008000,0xbc008000,0x3872b9a8,0xb23e3b64,0xb87239a8,0x323ebb64
.long 0xb61fbc00,0x3b6439a8,0xb61fbc00,0x3b6439a8,0xbbd9b9a8,0x3872b61f,0x3bd939a8,0xb872361f
.long 0xb9a88000,0xb9a8bc00,0xb9a88000,0xb9a8bc00,0x323e39a8,0xbaa7b61f,0xb23eb9a8,0x3aa7361f
.long 0x3b643c00,0x361f39a8,0x3b643c00,0x361f39a8,0x3aa739a8,0x3bd93b64,0xbaa7b9a8,0xbbd9bb64
.long 0x80008000,0x80008000,0x80008000,0x80008000,0x3bd9bc00,0x3aa7bb64,0xbbd93c00,0xbaa73b64
.long 0xb61f8000,0xbb6439a8,0xb61f8000,0xbb6439a8,0xbaa73c00,0x323e361f,0x3aa7bc00,0xb23eb61f
.long 0x39a88000,0x39a8bc00,0x39a88000,0x39a8bc00,0x3872bc00,0xbbd9361f,0xb8723c00,0x3bd9b61f
.long 0xbb648000,0x361f39a8,0xbb648000,0x361f39a8,0xb23e3c00,0x3872bb64,0x323ebc00,0xb8723b64
.long 0x3c008000,0xbc008000,0x3c008000,0xbc008000,0xb23ebc00,0x38723b64,0x323e3c00,0xb872bb64
.long 0xbb648000,0x361fb9a8,0xbb648000,0x361fb9a8,0x38723c00,0xbbd9b61f,0xb872bc00,0x3bd9361f
.long 0x39a88000,0x39a83c00,0x39a88000,0x39a83c00,0xbaa7bc00,0x323eb61f,0x3aa73c00,0xb23e361f
.long 0xb61f8000,0xbb64b9a8,0xb61f8000,0xbb64b9a8,0x3bd93c00,0x3aa73b64,0xbbd9bc00,0xbaa7bb64
.long 0x80008000,0x80008000,0x80008000,0x80008000,0x3872b9a8,0x323eb61f,0xb87239a8,0xb23e361f
.long 0xbb643c00,0xb61f39a8,0xbb643c00,0xb61f39a8,0x3bd9b9a8,0x3872bb64,0xbbd939a8,0xb8723b64
.long 0xb9a88000,0xb9a83c00,0xb9a88000,0xb9a83c00,0x323e39a8,0x3aa7bb64,0xb23eb9a8,0xbaa73b64
.long 0x361fbc00,0xbb6439a8,0x361fbc00,0xbb6439a8,0xbaa739a8,0x3bd9b61f,0x3aa7b9a8,0xbbd9361f
.long 0x3c008000,0xbc008000,0x3c008000,0xbc008000,0xbaa7b9a8,0x3bd9361f,0x3aa739a8,0xbbd9b61f
.long 0x361f3c00,0xbb64b9a8,0x361f3c00,0xbb64b9a8,0x323eb9a8,0x3aa73b64,0xb23e39a8,0xbaa7bb64
.long 0xb9a88000,0xb9a8bc00,0xb9a88000,0xb9a8bc00,0x3bd939a8,0x38723b64,0xbbd9b9a8,0xb872bb64
.long 0xbb64bc00,0xb61fb9a8,0xbb64bc00,0xb61fb9a8,0x387239a8,0x323e361f,0xb872b9a8,0xb23eb61f
.long 0x3f800000,0x3f800000,0x3f800000,0x3f800000,0x3f800000,0x3f7ffec4,0x3f7ffb11,0x3f7ff4e6
.long 0x3f800000,0x3f7ffb11,0x3f7fec43,0x3f7fd397,0x3f800000,0x3f7ff4e6,0x3f7fd397,0x3f7f9c18
.long 0x3f800000,0x3f7fec43,0x3f7fb10f,0x3f7f4e6d,0x3f800000,0x3f7fe129,0x3f7f84ab,0x3f7eea9d
.long 0x3f800000,0x3f7fd397,0x3f7f4e6d,0x3f7e70b0,0x3f800000,0x3f7fc38f,0x3f7f0e58,0x3f7de0b1
.long 0x3f800000,0x3f7fb10f,0x3f7ec46d,0x3f7d3aac,0x3f800000,0x3f7f9c18,0x3f7e70b0,0x3f7c7eb0
.long 0x3f800000,0x3f7f84ab,0x3f7e1324,0x3f7baccd,0x3f800000,0x3f7f6ac7,0x3f7dabcc,0x3f7ac516
.long 0x3f800000,0x3f7f4e6d,0x3f7d3aac,0x3f79c79d,0x3f800000,0x3f7f2f9d,0x3f7cbfc9,0x3f78b47b
.long 0x3f800000,0x3f7f0e58,0x3f7c3b28,0x3f778bc5,0x3f800000,0x3f7eea9d,0x3f7baccd,0x3f764d97
.long 0x3f800000,0x3f7ec46d,0x3f7b14be,0x3f74fa0b,0x3f800000,0x3f7e9bc9,0x3f7a7302,0x3f73913f
.long 0x3f800000,0x3f7e70b0,0x3f79c79d,0x3f721352,0x3f800000,0x3f7e4323,0x3f791298,0x3f708066
.long 0x3f800000,0x3f7e1324,0x3f7853f8,0x3f6ed89e,0x3f800000,0x3f7de0b1,0x3f778bc5,0x3f6d1c1d
.long 0x3f800000,0x3f7dabcc,0x3f76ba07,0x3f6b4b0c,0x3f800000,0x3f7d7474,0x3f75dec6,0x3f696591
.long 0x3f800000,0x3f7d3aac,0x3f74fa0b,0x3f676bd8,0x3f800000,0x3f7cfe73,0x3f740bdd,0x3f655e0b
.long 0x3f800000,0x3f7cbfc9,0x3f731447,0x3f633c5a,0x3f800000,0x3f7c7eb0,0x3f721352,0x3f6106f2
.long 0x3f800000,0x3f7c3b28,0x3f710908,0x3f5ebe05,0x3f800000,0x3f7bf531,0x3f6ff573,0x3f5c61c7
.long 0x3f800000,0x3f7baccd,0x3f6ed89e,0x3f59f26a,0x3f800000,0x3f7b61fc,0x3f6db293,0x3f577026
.long 0x3f800000,0x3f800000,0x3f800000,0x3f800000,0x3f7fec43,0x3f7fe129,0x3f7fd397,0x3f7fc38f
.long 0x3f7fb10f,0x3f7f84ab,0x3f7f4e6d,0x3f7f0e58,0x3f7f4e6d,0x3f7eea9d,0x3f7e70b0,0x3f7de0b1
.long 0x3f7ec46d,0x3f7e1324,0x3f7d3aac,0x3f7c3b28,0x3f7e1324,0x3f7cfe73,0x3f7baccd,0x3f7a1e84
.long 0x3f7d3aac,0x3f7baccd,0x3f79c79d,0x3f778bc5,0x3f7c3b28,0x3f7a1e84,0x3f778bc5,0x3f748422
.long 0x3f7b14be,0x3f7853f8,0x3f74fa0b,0x3f710908,0x3f79c79d,0x3f764d97,0x3f721352,0x3f6d1c1d
.long 0x3f7853f8,0x3f740bdd,0x3f6ed89e,0x3f68bf3c,0x3f76ba07,0x3f718f57,0x3f6b4b0c,0x3f63f473
.long 0x3f74fa0b,0x3f6ed89e,0x3f676bd8,0x3f5ebe05,0x3f731447,0x3f6be858,0x3f633c5a,0x3f591e6a
.long 0x3f710908,0x3f68bf3c,0x3f5ebe05,0x3f531849,0x3f6ed89e,0x3f655e0b,0x3f59f26a,0x3f4cae79
.long 0x3f6c835e,0x3f61c598,0x3f54db31,0x3f45e403,0x3f6a09a7,0x3f5df6be,0x3f4f7a1f,0x3f3ebc1b
.long 0x3f676bd8,0x3f59f26a,0x3f49d112,0x3f373a23,0x3f64aa59,0x3f55b993,0x3f43e200,0x3f2f61a5
.long 0x3f61c598,0x3f514d3d,0x3f3daef9,0x3f273656,0x3f5ebe05,0x3f4cae79,0x3f373a23,0x3f1ebc12
.long 0x3f5b941a,0x3f47de65,0x3f3085bb,0x3f15f6d9,0x3f584853,0x3f42de29,0x3f299415,0x3f0cead0
.long 0x3f54db31,0x3f3daef9,0x3f226799,0x3f039c3d,0x3f514d3d,0x3f385216,0x3f1b02c6,0x3ef41f07
.long 0x3f4d9f02,0x3f32c8c9,0x3f13682a,0x3ee0924f,0x3f49d112,0x3f2d1469,0x3f0b9a6b,0x3ecc9b8b
.long 0x3f45e403,0x3f273656,0x3f039c3d,0x3eb8442a,0x3f41d870,0x3f212ff9,0x3ef6e0cb,0x3ea395c5
.long 0x3f3daef9,0x3f1b02c6,0x3ee63375,0x3e8e9a22,0x3f396842,0x3f14b039,0x3ed53641,0x3e72b651
.long 0x3f800000,0x3f800000,0x3f800000,0x3f800000,0x3f7fb10f,0x3f7f9c18,0x3f7f84ab,0x3f7f6ac7
.long 0x3f7ec46d,0x3f7e70b0,0x3f7e1324,0x3f7dabcc,0x3f7d3aac,0x3f7c7eb0,0x3f7baccd,0x3f7ac516
.long 0x3f7b14be,0x3f79c79d,0x3f7853f8,0x3f76ba07,0x3f7853f8,0x3f764d97,0x3f740bdd,0x3f718f57
.long 0x3f74fa0b,0x3f721352,0x3f6ed89e,0x3f6b4b0c,0x3f710908,0x3f6d1c1d,0x3f68bf3c,0x3f63f473
.long 0x3f6c835e,0x3f676bd8,0x3f61c598,0x3f5b941a,0x3f676bd8,0x3f6106f2,0x3f59f26a,0x3f5233c6
.long 0x3f61c598,0x3f59f26a,0x3f514d3d,0x3f47de65,0x3f5b941a,0x3f5233c6,0x3f47de65,0x3f3ca003
.long 0x3f54db31,0x3f49d112,0x3f3daef9,0x3f3085bb,0x3f4d9f02,0x3f40d0da,0x3f32c8c9,0x3f239da9
.long 0x3f45e403,0x3f373a23,0x3f273656,0x3f15f6d9,0x3f3daef9,0x3f2d1469,0x3f1b02c6,0x3f07a136
.long 0x3f3504f3,0x3f226799,0x3f0e39da,0x3ef15aea,0x3f2beb4a,0x3f173c07,0x3f00e7e4,0x3ed25a09
.long 0x3f226799,0x3f0b9a6b,0x3ee63375,0x3eb263ef,0x3f187fc0,0x3eff17b2,0x3ec9b953,0x3e919ddd
.long 0x3f0e39da,0x3ee63375,0x3eac7cd4,0x3e605c13,0x3f039c3d,0x3ecc9b8b,0x3e8e9a22,0x3e1c76de
.long 0x3ef15aea,0x3eb263ef,0x3e605c13,0x3dafb680,0x3edae880,0x3e97a117,0x3e22abb6,0x3c96c9b6
.long 0x3ec3ef15,0x3e78cfcc,0x3dc8bd36,0xbd48fb30,0x3eac7cd4,0x3e419b37,0x3d16c32c,0xbdee3876
.long 0x3e94a031,0x3e09cf86,0xbcc90ab0,0xbe3b6ecf,0x3e78cfcc,0x3da3308c,0xbdafb680,0xbe7ee6e1
.long 0x3e47c5c2,0x3cc90ab0,0xbe164083,0xbea09ae5,0x3e164083,0xbcfb49ba,0xbe541501,0xbec1071e
.long 0x3dc8bd36,0xbdafb680,0xbe888e93,0xbee0924f,0x3d48fb30,0xbe1008b7,0xbea68f12,0xbeff17b2
.long 0x3f800000,0x3f800000,0x3f800000,0x3f800000,0x3f7f4e6d,0x3f7f2f9d,0x3f7f0e58,0x3f7eea9d
.long 0x3f7d3aac,0x3f7cbfc9,0x3f7c3b28,0x3f7baccd,0x3f79c79d,0x3f78b47b,0x3f778bc5,0x3f764d97
.long 0x3f74fa0b,0x3f731447,0x3f710908,0x3f6ed89e,0x3f6ed89e,0x3f6be858,0x3f68bf3c,0x3f655e0b
.long 0x3f676bd8,0x3f633c5a,0x3f5ebe05,0x3f59f26a,0x3f5ebe05,0x3f591e6a,0x3f531849,0x3f4cae79
.long 0x3f54db31,0x3f4d9f02,0x3f45e403,0x3f3daef9,0x3f49d112,0x3f40d0da,0x3f373a23,0x3f2d1469
.long 0x3f3daef9,0x3f32c8c9,0x3f273656,0x3f1b02c6,0x3f3085bb,0x3f239da9,0x3f15f6d9,0x3f07a136
.long 0x3f226799,0x3f13682a,0x3f039c3d,0x3ee63375,0x3f13682a,0x3f0242b1,0x3ee0924f,0x3ebb31a0
.long 0x3f039c3d,0x3ee0924f,0x3eb8442a,0x3e8e9a22,0x3ee63375,0x3ebb31a0,0x3e8e9a22,0x3e419b37
.long 0x3ec3ef15,0x3e94a031,0x3e47c5c2,0x3dc8bd36,0x3ea09ae5,0x3e5a3997,0x3de1bc2e,0x3bc90f88
.long 0x3e78cfcc,0x3e09cf86,0x3cc90ab0,0xbdafb680,0x3e2f10a2,0x3d621469,0xbd7b2b74,0xbe354098
.long 0x3dc8bd36,0xbcc90ab0,0xbe164083,0xbe888e93,0x3cc90ab0,0xbdd53db9,0xbe6c9a7f,0xbeb554ec
.long 0xbd48fb30,0xbe3b6ecf,0xbea09ae5,0xbee0924f,0xbdfab273,0xbe8586ce,0xbec9b953,0xbf04f484
.long 0xbe47c5c2,0xbeac7cd4,0xbef15aea,0xbf187fc0,0xbe888e93,0xbed25a09,0xbf0b9a6b,0xbf2ac082
.long 0xbeac7cd4,0xbef6e0cb,0xbf1d7fd1,0xbf3b8f3b,0xbecf7bca,0xbf0cead0,0xbf2e3bde,0xbf4ac77f
.long 0xbef15aea,0xbf1d7fd1,0xbf3daef9,0xbf584853,0xbf08f59b,0xbf2d1469,0xbf4bbbf8,0xbf63f473
.long 0xbf187fc0,0xbf3b8f3b,0xbf584853,0xbf6db293,0xbf273656,0xbf48d8b3,0xbf633c5a,0xbf756d97
.long 0x3f800000,0x3f800000,0x3f800000,0x3f800000,0x3f7ec46d,0x3f7e9bc9,0x3f7e70b0,0x3f7e4323
.long 0x3f7b14be,0x3f7a7302,0x3f79c79d,0x3f791298,0x3f74fa0b,0x3f73913f,0x3f721352,0x3f708066
.long 0x3f6c835e,0x3f6a09a7,0x3f676bd8,0x3f64aa59,0x3f61c598,0x3f5df6be,0x3f59f26a,0x3f55b993
.long 0x3f54db31,0x3f4f7a1f,0x3f49d112,0x3f43e200,0x3f45e403,0x3f3ebc1b,0x3f373a23,0x3f2f61a5
.long 0x3f3504f3,0x3f2beb4a,0x3f226799,0x3f187fc0,0x3f226799,0x3f173c07,0x3f0b9a6b,0x3eff17b2
.long 0x3f0e39da,0x3f00e7e4,0x3ee63375,0x3ec9b953,0x3ef15aea,0x3ed25a09,0x3eb263ef,0x3e919ddd
.long 0x3ec3ef15,0x3ea09ae5,0x3e78cfcc,0x3e2f10a2,0x3e94a031,0x3e5a3997,0x3e09cf86,0x3d621469
.long 0x3e47c5c2,0x3de1bc2e,0x3cc90ab0,0xbd7b2b74,0x3dc8bd36,0x3bc90f88,0xbdafb680,0xbe354098
.long 0x248d3132,0xbdc8bd36,0xbe47c5c2,0xbe94a031,0xbdc8bd36,0xbe4dee60,0xbe9aa086,0xbecc9b8b
.long 0xbe47c5c2,0xbe9aa086,0xbecf7bca,0xbf00e7e4,0xbe94a031,0xbecc9b8b,0xbf00e7e4,0xbf19c200
.long 0xbec3ef15,0xbefc5d27,0xbf187fc0,0xbf3085bb,0xbef15aea,0xbf14b039,0xbf2e3bde,0xbf44e3f5
.long 0xbf0e39da,0xbf299415,0xbf41d870,0xbf5695e5,0xbf226799,0xbf3ca003,0xbf531849,0xbf655e0b
.long 0xbf3504f3,0xbf4d9f02,0xbf61c598,0xbf710908,0xbf45e403,0xbf5c61c7,0xbf6db293,0xbf796e4e
.long 0xbf54db31,0xbf68bf3c,0xbf76ba07,0xbf7e70b0,0xbf61c598,0xbf7294f8,0xbf7cbfc9,0xbf7ffec4
.long 0xbf6c835e,0xbf79c79d,0xbf7fb10f,0xbf7e1324,0xbf74fa0b,0xbf7e4323,0xbf7f84ab,0xbf78b47b
.long 0xbf7b14be,0xbf7ffb11,0xbf7c3b28,0xbf6ff573,0xbf7ec46d,0xbf7eea9d,0xbf75dec6,0xbf63f473
.long 0x3f800000,0x3f800000,0x3f800000,0x3f800000,0x3f7e1324,0x3f7de0b1,0x3f7dabcc,0x3f7d7474
.long 0x3f7853f8,0x3f778bc5,0x3f76ba07,0x3f75dec6,0x3f6ed89e,0x3f6d1c1d,0x3f6b4b0c,0x3f696591
.long 0x3f61c598,0x3f5ebe05,0x3f5b941a,0x3f584853,0x3f514d3d,0x3f4cae79,0x3f47de65,0x3f42de29
.long 0x3f3daef9,0x3f373a23,0x3f3085bb,0x3f299415,0x3f273656,0x3f1ebc12,0x3f15f6d9,0x3f0cead0
.long 0x3f0e39da,0x3f039c3d,0x3ef15aea,0x3edae880,0x3ee63375,0x3ecc9b8b,0x3eb263ef,0x3e97a117
.long 0x3eac7cd4,0x3e8e9a22,0x3e605c13,0x3e22abb6,0x3e605c13,0x3e1c76de,0x3dafb680,0x3c96c9b6
.long 0x3dc8bd36,0x3cc90ab0,0xbd48fb30,0xbdfab273,0xbcc90ab0,0xbdd53db9,0xbe3b6ecf,0xbe8586ce
.long 0xbe164083,0xbe6c9a7f,0xbea09ae5,0xbec9b953,0xbe888e93,0xbeb554ec,0xbee0924f,0xbf04f484
.long 0xbec3ef15,0xbef15aea,0xbf0e39da,0xbf226799,0xbefc5d27,0xbf14b039,0xbf299415,0xbf3ca003
.long 0xbf187fc0,0xbf2e3bde,0xbf41d870,0xbf531849,0xbf3085bb,0xbf44e3f5,0xbf5695e5,0xbf655e0b
.long 0xbf45e403,0xbf584853,0xbf676bd8,0xbf731447,0xbf584853,0xbf6816a8,0xbf740bdd,0xbf7bf531
.long 0xbf676bd8,0xbf740bdd,0xbf7c3b28,0xbf7fd397,0xbf731447,0xbf7bf531,0xbf7fd397,0xbf7e9bc9
.long 0xbf7b14be,0xbf7fb10f,0xbf7ec46d,0xbf7853f8,0xbf7f4e6d,0xbf7f2f9d,0xbf791298,0xbf6d1c1d
.long 0xbf7fb10f,0xbf7a7302,0xbf6ed89e,0xbf5d2d53,0xbf7c3b28,0xbf718f57,0xbf604621,0xbf48d8b3
.long 0xbf74fa0b,0xbf64aa59,0xbf4d9f02,0xbf3085bb,0xbf6a09a7,0xbf53fac3,0xbf373a23,0xbf14b039
.long 0xbf5b941a,0xbf3fc767,0xbf1d7fd1,0xbeebcbbb,0xbf49d112,0xbf286605,0xbf00e7e4,0xbea986c4
.long 0x3f800000,0x3f800000,0x3f800000,0x3f800000,0x3f7d3aac,0x3f7cfe73,0x3f7cbfc9,0x3f7c7eb0
.long 0x3f74fa0b,0x3f740bdd,0x3f731447,0x3f721352,0x3f676bd8,0x3f655e0b,0x3f633c5a,0x3f6106f2
.long 0x3f54db31,0x3f514d3d,0x3f4d9f02,0x3f49d112,0x3f3daef9,0x3f385216,0x3f32c8c9,0x3f2d1469
.long 0x3f226799,0x3f1b02c6,0x3f13682a,0x3f0b9a6b,0x3f039c3d,0x3ef41f07,0x3ee0924f,0x3ecc9b8b
.long 0x3ec3ef15,0x3eac7cd4,0x3e94a031,0x3e78cfcc,0x3e78cfcc,0x3e419b37,0x3e09cf86,0x3da3308c
.long 0x3dc8bd36,0x3d16c32c,0xbcc90ab0,0xbdafb680,0xbd48fb30,0xbdee3876,0xbe3b6ecf,0xbe7ee6e1
.long 0xbe47c5c2,0xbe888e93,0xbeac7cd4,0xbecf7bca,0xbeac7cd4,0xbed25a09,0xbef6e0cb,0xbf0cead0
.long 0xbef15aea,0xbf0b9a6b,0xbf1d7fd1,0xbf2e3bde,0xbf187fc0,0xbf2ac082,0xbf3b8f3b,0xbf4ac77f
.long 0xbf3504f3,0xbf45e403,0xbf54db31,0xbf61c598,0xbf4d9f02,0xbf5c61c7,0xbf68bf3c,0xbf7294f8
.long 0xbf61c598,0xbf6db293,0xbf76ba07,0xbf7cbfc9,0xbf710908,0xbf796e4e,0xbf7e70b0,0xbf7ffec4
.long 0xbf7b14be,0xbf7f4e6d,0xbf7fb10f,0xbf7c3b28,0xbf7fb10f,0xbf7f2f9d,0xbf7a7302,0xbf718f57
.long 0xbf7ec46d,0xbf791298,0xbf6ed89e,0xbf604621,0xbf7853f8,0xbf6d1c1d,0xbf5d2d53,0xbf48d8b3
.long 0xbf6c835e,0xbf5b941a,0xbf45e403,0xbf2beb4a,0xbf5b941a,0xbf44e3f5,0xbf299415,0xbf0a48ad
.long 0xbf45e403,0xbf299415,0xbf08f59b,0xbec9b953,0xbf2beb4a,0xbf0a48ad,0xbec9b953,0xbe72b651
.long 0xbf0e39da,0xbecf7bca,0xbe78cfcc,0xbd96a905,0xbedae880,0xbe8586ce,0xbdafb680,0x3dbc3ac3
.long 0xbe94a031,0xbde1bc2e,0x3d96a905,0x3e827dc0,0xbe164083,0x3d2fe007,0x3e6c9a7f,0x3ed25a09
.long 0x3f800000,0x3f800000,0x3f800000,0x3f800000,0x3f7c3b28,0x3f7bf531,0x3f7baccd,0x3f7b61fc
.long 0x3f710908,0x3f6ff573,0x3f6ed89e,0x3f6db293,0x3f5ebe05,0x3f5c61c7,0x3f59f26a,0x3f577026
.long 0x3f45e403,0x3f41d870,0x3f3daef9,0x3f396842,0x3f273656,0x3f212ff9,0x3f1b02c6,0x3f14b039
.long 0x3f039c3d,0x3ef6e0cb,0x3ee63375,0x3ed53641,0x3eb8442a,0x3ea395c5,0x3e8e9a22,0x3e72b651
.long 0x3e47c5c2,0x3e164083,0x3dc8bd36,0x3d48fb30,0x3cc90ab0,0xbcfb49ba,0xbdafb680,0xbe1008b7
.long 0xbe164083,0xbe541501,0xbe888e93,0xbea68f12,0xbea09ae5,0xbec1071e,0xbee0924f,0xbeff17b2
.long 0xbef15aea,0xbf08f59b,0xbf187fc0,0xbf273656,0xbf1d7fd1,0xbf2d1469,0xbf3b8f3b,0xbf48d8b3
.long 0xbf3daef9,0xbf4bbbf8,0xbf584853,0xbf633c5a,0xbf584853,0xbf63f473,0xbf6db293,0xbf756d97
.long 0xbf6c835e,0xbf74fa0b,0xbf7b14be,0xbf7ec46d,0xbf79c79d,0xbf7e4323,0xbf7ffb11,0xbf7eea9d
.long 0xbf7fb10f,0xbf7f84ab,0xbf7c3b28,0xbf75dec6,0xbf7e1324,0xbf78b47b,0xbf6ff573,0xbf63f473
.long 0xbf74fa0b,0xbf6a09a7,0xbf5b941a,0xbf49d112,0xbf64aa59,0xbf53fac3,0xbf3fc767,0xbf286605
.long 0xbf4d9f02,0xbf373a23,0xbf1d7fd1,0xbf00e7e4,0xbf3085bb,0xbf14b039,0xbeebcbbb,0xbea986c4
.long 0xbf0e39da,0xbedae880,0xbe94a031,0xbe164083,0xbecf7bca,0xbe8586ce,0xbde1bc2e,0x3d2fe007
.long 0xbe78cfcc,0xbdafb680,0x3d96a905,0x3e6c9a7f,0xbd96a905,0x3dbc3ac3,0x3e827dc0,0x3ed25a09
.long 0x3dc8bd36,0x3e888e93,0x3edae880,0x3f13682a,0x3e888e93,0x3eddbe79,0x3f15f6d9,0x3f385216
.long 0x3edae880,0x3f15f6d9,0x3f396842,0x3f5695e5,0x3f13682a,0x3f385216,0x3f5695e5,0x3f6d1c1d
.long 0x0,0x0,0x0,0x0,0x0,0x3bc90f88,0x3c490e90,0x3c96c9b6
.long 0x0,0x3c490e90,0x3cc90ab0,0x3d16c32c,0x0,0x3c96c9b6,0x3d16c32c,0x3d621469
.long 0x0,0x3cc90ab0,0x3d48fb30,0x3d96a905,0x0,0x3cfb49ba,0x3d7b2b74,0x3dbc3ac3
.long 0x0,0x3d16c32c,0x3d96a905,0x3de1bc2e,0x0,0x3d2fe007,0x3dafb680,0x3e039502
.long 0x0,0x3d48fb30,0x3dc8bd36,0x3e164083,0x0,0x3d621469,0x3de1bc2e,0x3e28defc
.long 0x0,0x3d7b2b74,0x3dfab273,0x3e3b6ecf,0x0,0x3d8a200a,0x3e09cf86,0x3e4dee60
.long 0x0,0x3d96a905,0x3e164083,0x3e605c13,0x0,0x3da3308c,0x3e22abb6,0x3e72b651
.long 0x0,0x3dafb680,0x3e2f10a2,0x3e827dc0,0x0,0x3dbc3ac3,0x3e3b6ecf,0x3e8b9507
.long 0x0,0x3dc8bd36,0x3e47c5c2,0x3e94a031,0x0,0x3dd53db9,0x3e541501,0x3e9d9e78
.long 0x0,0x3de1bc2e,0x3e605c13,0x3ea68f12,0x0,0x3dee3876,0x3e6c9a7f,0x3eaf713a
.long 0x0,0x3dfab273,0x3e78cfcc,0x3eb8442a,0x0,0x3e039502,0x3e827dc0,0x3ec1071e
.long 0x0,0x3e09cf86,0x3e888e93,0x3ec9b953,0x0,0x3e1008b7,0x3e8e9a22,0x3ed25a09
.long 0x0,0x3e164083,0x3e94a031,0x3edae880,0x0,0x3e1c76de,0x3e9aa086,0x3ee363fa
.long 0x0,0x3e22abb6,0x3ea09ae5,0x3eebcbbb,0x0,0x3e28defc,0x3ea68f12,0x3ef41f07
.long 0x0,0x3e2f10a2,0x3eac7cd4,0x3efc5d27,0x0,0x3e354098,0x3eb263ef,0x3f0242b1
.long 0x0,0x3e3b6ecf,0x3eb8442a,0x3f064b82,0x0,0x3e419b37,0x3ebe1d4a,0x3f0a48ad
.long 0x0,0x0,0x0,0x0,0x3cc90ab0,0x3cfb49ba,0x3d16c32c,0x3d2fe007
.long 0x3d48fb30,0x3d7b2b74,0x3d96a905,0x3dafb680,0x3d96a905,0x3dbc3ac3,0x3de1bc2e,0x3e039502
.long 0x3dc8bd36,0x3dfab273,0x3e164083,0x3e2f10a2,0x3dfab273,0x3e1c76de,0x3e3b6ecf,0x3e5a3997
.long 0x3e164083,0x3e3b6ecf,0x3e605c13,0x3e827dc0,0x3e2f10a2,0x3e5a3997,0x3e827dc0,0x3e97a117
.long 0x3e47c5c2,0x3e78cfcc,0x3e94a031,0x3eac7cd4,0x3e605c13,0x3e8b9507,0x3ea68f12,0x3ec1071e
.long 0x3e78cfcc,0x3e9aa086,0x3eb8442a,0x3ed53641,0x3e888e93,0x3ea986c4,0x3ec9b953,0x3ee900b7
.long 0x3e94a031,0x3eb8442a,0x3edae880,0x3efc5d27,0x3ea09ae5,0x3ec6d529,0x3eebcbbb,0x3f07a136
.long 0x3eac7cd4,0x3ed53641,0x3efc5d27,0x3f10d3cd,0x3eb8442a,0x3ee363fa,0x3f064b82,0x3f19c200
.long 0x3ec3ef15,0x3ef15aea,0x3f0e39da,0x3f226799,0x3ecf7bca,0x3eff17b2,0x3f15f6d9,0x3f2ac082
.long 0x3edae880,0x3f064b82,0x3f1d7fd1,0x3f32c8c9,0x3ee63375,0x3f0cead0,0x3f24d225,0x3f3a7ca4
.long 0x3ef15aea,0x3f13682a,0x3f2beb4a,0x3f41d870,0x3efc5d27,0x3f19c200,0x3f32c8c9,0x3f48d8b3
.long 0x3f039c3d,0x3f1ff6cb,0x3f396842,0x3f4f7a1f,0x3f08f59b,0x3f26050a,0x3f3fc767,0x3f55b993
.long 0x3f0e39da,0x3f2beb4a,0x3f45e403,0x3f5b941a,0x3f13682a,0x3f31a81d,0x3f4bbbf8,0x3f6106f2
.long 0x3f187fc0,0x3f373a23,0x3f514d3d,0x3f660f88,0x3f1d7fd1,0x3f3ca003,0x3f5695e5,0x3f6aab7b
.long 0x3f226799,0x3f41d870,0x3f5b941a,0x3f6ed89e,0x3f273656,0x3f46e22a,0x3f604621,0x3f7294f8
.long 0x3f2beb4a,0x3f4bbbf8,0x3f64aa59,0x3f75dec6,0x3f3085bb,0x3f5064af,0x3f68bf3c,0x3f78b47b
.long 0x0,0x0,0x0,0x0,0x3d48fb30,0x3d621469,0x3d7b2b74,0x3d8a200a
.long 0x3dc8bd36,0x3de1bc2e,0x3dfab273,0x3e09cf86,0x3e164083,0x3e28defc,0x3e3b6ecf,0x3e4dee60
.long 0x3e47c5c2,0x3e605c13,0x3e78cfcc,0x3e888e93,0x3e78cfcc,0x3e8b9507,0x3e9aa086,0x3ea986c4
.long 0x3e94a031,0x3ea68f12,0x3eb8442a,0x3ec9b953,0x3eac7cd4,0x3ec1071e,0x3ed53641,0x3ee900b7
.long 0x3ec3ef15,0x3edae880,0x3ef15aea,0x3f039c3d,0x3edae880,0x3ef41f07,0x3f064b82,0x3f121eb0
.long 0x3ef15aea,0x3f064b82,0x3f13682a,0x3f1ff6cb,0x3f039c3d,0x3f121eb0,0x3f1ff6cb,0x3f2d1469
.long 0x3f0e39da,0x3f1d7fd1,0x3f2beb4a,0x3f396842,0x3f187fc0,0x3f286605,0x3f373a23,0x3f44e3f5
.long 0x3f226799,0x3f32c8c9,0x3f41d870,0x3f4f7a1f,0x3f2beb4a,0x3f3ca003,0x3f4bbbf8,0x3f591e6a
.long 0x3f3504f3,0x3f45e403,0x3f54db31,0x3f61c598,0x3f3daef9,0x3f4e8d90,0x3f5d2d53,0x3f696591
.long 0x3f45e403,0x3f5695e5,0x3f64aa59,0x3f6ff573,0x3f4d9f02,0x3f5df6be,0x3f6b4b0c,0x3f756d97
.long 0x3f54db31,0x3f64aa59,0x3f710908,0x3f79c79d,0x3f5b941a,0x3f6aab7b,0x3f75dec6,0x3f7cfe73
.long 0x3f61c598,0x3f6ff573,0x3f79c79d,0x3f7f0e58,0x3f676bd8,0x3f748422,0x3f7cbfc9,0x3f7ff4e6
.long 0x3f6c835e,0x3f7853f8,0x3f7ec46d,0x3f7fb10f,0x3f710908,0x3f7b61fc,0x3f7fd397,0x3f7e4323
.long 0x3f74fa0b,0x3f7dabcc,0x3f7fec43,0x3f7baccd,0x3f7853f8,0x3f7f2f9d,0x3f7f0e58,0x3f77f110
.long 0x3f7b14be,0x3f7fec43,0x3f7d3aac,0x3f731447,0x3f7d3aac,0x3f7fe129,0x3f7a7302,0x3f6d1c1d
.long 0x3f7ec46d,0x3f7f0e58,0x3f76ba07,0x3f660f88,0x3f7fb10f,0x3f7d7474,0x3f721352,0x3f5df6be
.long 0x0,0x0,0x0,0x0,0x3d96a905,0x3da3308c,0x3dafb680,0x3dbc3ac3
.long 0x3e164083,0x3e22abb6,0x3e2f10a2,0x3e3b6ecf,0x3e605c13,0x3e72b651,0x3e827dc0,0x3e8b9507
.long 0x3e94a031,0x3ea09ae5,0x3eac7cd4,0x3eb8442a,0x3eb8442a,0x3ec6d529,0x3ed53641,0x3ee363fa
.long 0x3edae880,0x3eebcbbb,0x3efc5d27,0x3f064b82,0x3efc5d27,0x3f07a136,0x3f10d3cd,0x3f19c200
.long 0x3f0e39da,0x3f187fc0,0x3f226799,0x3f2beb4a,0x3f1d7fd1,0x3f286605,0x3f32c8c9,0x3f3ca003
.long 0x3f2beb4a,0x3f373a23,0x3f41d870,0x3f4bbbf8,0x3f396842,0x3f44e3f5,0x3f4f7a1f,0x3f591e6a
.long 0x3f45e403,0x3f514d3d,0x3f5b941a,0x3f64aa59,0x3f514d3d,0x3f5c61c7,0x3f660f88,0x3f6e46be
.long 0x3f5b941a,0x3f660f88,0x3f6ed89e,0x3f75dec6,0x3f64aa59,0x3f6e46be,0x3f75dec6,0x3f7b61fc
.long 0x3f6c835e,0x3f74fa0b,0x3f7b14be,0x3f7ec46d,0x3f731447,0x3f7a1e84,0x3f7e70b0,0x3f7ffec4
.long 0x3f7853f8,0x3f7dabcc,0x3f7fec43,0x3f7f0e58,0x3f7c3b28,0x3f7f9c18,0x3f7f84ab,0x3f7bf531
.long 0x3f7ec46d,0x3f7fec43,0x3f7d3aac,0x3f76ba07,0x3f7fec43,0x3f7e9bc9,0x3f791298,0x3f6f6830
.long 0x3f7fb10f,0x3f7baccd,0x3f731447,0x3f660f88,0x3f7e1324,0x3f772417,0x3f6b4b0c,0x3f5ac450
.long 0x3f7b14be,0x3f710908,0x3f61c598,0x3f4d9f02,0x3f76ba07,0x3f696591,0x3f5695e5,0x3f3ebc1b
.long 0x3f710908,0x3f604621,0x3f49d112,0x3f2e3bde,0x3f6a09a7,0x3f55b993,0x3f3b8f3b,0x3f1c420c
.long 0x3f61c598,0x3f49d112,0x3f2beb4a,0x3f08f59b,0x3f584853,0x3f3ca003,0x3f1b02c6,0x3ee900b7
.long 0x3f4d9f02,0x3f2e3bde,0x3f08f59b,0x3ebe1d4a,0x3f41d870,0x3f1ebc12,0x3eebcbbb,0x3e919ddd
.long 0x0,0x0,0x0,0x0,0x3dc8bd36,0x3dd53db9,0x3de1bc2e,0x3dee3876
.long 0x3e47c5c2,0x3e541501,0x3e605c13,0x3e6c9a7f,0x3e94a031,0x3e9d9e78,0x3ea68f12,0x3eaf713a
.long 0x3ec3ef15,0x3ecf7bca,0x3edae880,0x3ee63375,0x3ef15aea,0x3eff17b2,0x3f064b82,0x3f0cead0
.long 0x3f0e39da,0x3f15f6d9,0x3f1d7fd1,0x3f24d225,0x3f226799,0x3f2ac082,0x3f32c8c9,0x3f3a7ca4
.long 0x3f3504f3,0x3f3daef9,0x3f45e403,0x3f4d9f02,0x3f45e403,0x3f4e8d90,0x3f5695e5,0x3f5df6be
.long 0x3f54db31,0x3f5d2d53,0x3f64aa59,0x3f6b4b0c,0x3f61c598,0x3f696591,0x3f6ff573,0x3f756d97
.long 0x3f6c835e,0x3f731447,0x3f7853f8,0x3f7c3b28,0x3f74fa0b,0x3f7a1e84,0x3f7dabcc,0x3f7f9c18
.long 0x3f7b14be,0x3f7e70b0,0x3f7fec43,0x3f7f84ab,0x3f7ec46d,0x3f7ffec4,0x3f7f0e58,0x3f7bf531
.long 0x3f800000,0x3f7ec46d,0x3f7b14be,0x3f74fa0b,0x3f7ec46d,0x3f7ac516,0x3f740bdd,0x3f6aab7b
.long 0x3f7b14be,0x3f740bdd,0x3f6a09a7,0x3f5d2d53,0x3f74fa0b,0x3f6aab7b,0x3f5d2d53,0x3f4cae79
.long 0x3f6c835e,0x3f5ebe05,0x3f4d9f02,0x3f396842,0x3f61c598,0x3f5064af,0x3f3b8f3b,0x3f239da9
.long 0x3f54db31,0x3f3fc767,0x3f273656,0x3f0b9a6b,0x3f45e403,0x3f2d1469,0x3f10d3cd,0x3ee363fa
.long 0x3f3504f3,0x3f187fc0,0x3ef15aea,0x3eac7cd4,0x3f226799,0x3f0242b1,0x3ebe1d4a,0x3e667c66
.long 0x3f0e39da,0x3ed53641,0x3e888e93,0x3de1bc2e,0x3ef15aea,0x3ea395c5,0x3e22abb6,0xbbc90f88
.long 0x3ec3ef15,0x3e605c13,0x3d48fb30,0xbdfab273,0x3e94a031,0x3dee3876,0xbd7b2b74,0xbe72b651
.long 0x3e47c5c2,0x3c490e90,0xbe2f10a2,0xbeb263ef,0x3dc8bd36,0xbdbc3ac3,0xbe8e9a22,0xbee900b7
.long 0x0,0x0,0x0,0x0,0x3dfab273,0x3e039502,0x3e09cf86,0x3e1008b7
.long 0x3e78cfcc,0x3e827dc0,0x3e888e93,0x3e8e9a22,0x3eb8442a,0x3ec1071e,0x3ec9b953,0x3ed25a09
.long 0x3ef15aea,0x3efc5d27,0x3f039c3d,0x3f08f59b,0x3f13682a,0x3f19c200,0x3f1ff6cb,0x3f26050a
.long 0x3f2beb4a,0x3f32c8c9,0x3f396842,0x3f3fc767,0x3f41d870,0x3f48d8b3,0x3f4f7a1f,0x3f55b993
.long 0x3f54db31,0x3f5b941a,0x3f61c598,0x3f676bd8,0x3f64aa59,0x3f6aab7b,0x3f6ff573,0x3f748422
.long 0x3f710908,0x3f75dec6,0x3f79c79d,0x3f7cbfc9,0x3f79c79d,0x3f7cfe73,0x3f7f0e58,0x3f7ff4e6
.long 0x3f7ec46d,0x3f7fec43,0x3f7fb10f,0x3f7e1324,0x3f7fec43,0x3f7e9bc9,0x3f7baccd,0x3f772417
.long 0x3f7d3aac,0x3f791298,0x3f731447,0x3f6b4b0c,0x3f76ba07,0x3f6f6830,0x3f660f88,0x3f5ac450
.long 0x3f6c835e,0x3f61c598,0x3f54db31,0x3f45e403,0x3f5ebe05,0x3f5064af,0x3f3fc767,0x3f2d1469
.long 0x3f4d9f02,0x3f3b8f3b,0x3f273656,0x3f10d3cd,0x3f396842,0x3f239da9,0x3f0b9a6b,0x3ee363fa
.long 0x3f226799,0x3f08f59b,0x3edae880,0x3ea09ae5,0x3f08f59b,0x3ed8106b,0x3e9aa086,0x3e354098
.long 0x3edae880,0x3e9aa086,0x3e2f10a2,0x3d16c32c,0x3ea09ae5,0x3e354098,0x3d16c32c,0xbdd53db9
.long 0x3e47c5c2,0x3d48fb30,0xbdc8bd36,0xbe78cfcc,0x3d96a905,0xbda3308c,0xbe6c9a7f,0xbec1071e
.long 0xbd48fb30,0xbe541501,0xbeb8442a,0xbf00e7e4,0xbe2f10a2,0xbea986c4,0xbef6e0cb,0xbf1ebc12
.long 0xbe94a031,0xbee63375,0xbf187fc0,0xbf396842,0xbecf7bca,0xbf0f8784,0xbf32c8c9,0xbf5064af
.long 0xbf039c3d,0xbf299415,0xbf49d112,0xbf633c5a,0xbf1d7fd1,0xbf40d0da,0xbf5d2d53,0xbf718f57
.long 0x0,0x0,0x0,0x0,0x3e164083,0x3e1c76de,0x3e22abb6,0x3e28defc
.long 0x3e94a031,0x3e9aa086,0x3ea09ae5,0x3ea68f12,0x3edae880,0x3ee363fa,0x3eebcbbb,0x3ef41f07
.long 0x3f0e39da,0x3f13682a,0x3f187fc0,0x3f1d7fd1,0x3f2beb4a,0x3f31a81d,0x3f373a23,0x3f3ca003
.long 0x3f45e403,0x3f4bbbf8,0x3f514d3d,0x3f5695e5,0x3f5b941a,0x3f6106f2,0x3f660f88,0x3f6aab7b
.long 0x3f6c835e,0x3f710908,0x3f74fa0b,0x3f7853f8,0x3f7853f8,0x3f7b61fc,0x3f7dabcc,0x3f7f2f9d
.long 0x3f7ec46d,0x3f7fd397,0x3f7fec43,0x3f7f0e58,0x3f7fb10f,0x3f7e4323,0x3f7baccd,0x3f77f110
.long 0x3f7b14be,0x3f76ba07,0x3f710908,0x3f6a09a7,0x3f710908,0x3f696591,0x3f604621,0x3f55b993
.long 0x3f61c598,0x3f5695e5,0x3f49d112,0x3f3b8f3b,0x3f4d9f02,0x3f3ebc1b,0x3f2e3bde,0x3f1c420c
.long 0x3f3504f3,0x3f226799,0x3f0e39da,0x3ef15aea,0x3f187fc0,0x3f0242b1,0x3ed53641,0x3ea395c5
.long 0x3ef15aea,0x3ebe1d4a,0x3e888e93,0x3e22abb6,0x3eac7cd4,0x3e667c66,0x3de1bc2e,0xbbc90f88
.long 0x3e47c5c2,0x3d96a905,0xbd48fb30,0xbe2f10a2,0x3d48fb30,0xbda3308c,0xbe541501,0xbea986c4
.long 0xbdc8bd36,0xbe6c9a7f,0xbeb8442a,0xbef6e0cb,0xbe78cfcc,0xbec1071e,0xbf00e7e4,0xbf1ebc12
.long 0xbec3ef15,0xbf039c3d,0xbf226799,0xbf3daef9,0xbf039c3d,0xbf239da9,0xbf3fc767,0xbf577026
.long 0xbf226799,0xbf3fc767,0xbf584853,0xbf6b4b0c,0xbf3daef9,0xbf577026,0xbf6b4b0c,0xbf78b47b
.long 0xbf54db31,0xbf6a09a7,0xbf7853f8,0xbf7f4e6d,0xbf676bd8,0xbf772417,0xbf7f0e58,0xbf7eea9d
.long 0xbf74fa0b,0xbf7e70b0,0xbf7f4e6d,0xbf778bc5,0xbf7d3aac,0xbf7fc38f,0xbf791298,0xbf696591
.long 0x0,0x0,0x0,0x0,0x3e2f10a2,0x3e354098,0x3e3b6ecf,0x3e419b37
.long 0x3eac7cd4,0x3eb263ef,0x3eb8442a,0x3ebe1d4a,0x3efc5d27,0x3f0242b1,0x3f064b82,0x3f0a48ad
.long 0x3f226799,0x3f273656,0x3f2beb4a,0x3f3085bb,0x3f41d870,0x3f46e22a,0x3f4bbbf8,0x3f5064af
.long 0x3f5b941a,0x3f604621,0x3f64aa59,0x3f68bf3c,0x3f6ed89e,0x3f7294f8,0x3f75dec6,0x3f78b47b
.long 0x3f7b14be,0x3f7d3aac,0x3f7ec46d,0x3f7fb10f,0x3f7fec43,0x3f7fe129,0x3f7f0e58,0x3f7d7474
.long 0x3f7d3aac,0x3f7a7302,0x3f76ba07,0x3f721352,0x3f731447,0x3f6d1c1d,0x3f660f88,0x3f5df6be
.long 0x3f61c598,0x3f584853,0x3f4d9f02,0x3f41d870,0x3f49d112,0x3f3ca003,0x3f2e3bde,0x3f1ebc12
.long 0x3f2beb4a,0x3f1b02c6,0x3f08f59b,0x3eebcbbb,0x3f08f59b,0x3ee900b7,0x3ebe1d4a,0x3e919ddd
.long 0x3ec3ef15,0x3e94a031,0x3e47c5c2,0x3dc8bd36,0x3e605c13,0x3dee3876,0x3c490e90,0xbdbc3ac3
.long 0x3d48fb30,0xbd7b2b74,0xbe2f10a2,0xbe8e9a22,0xbdfab273,0xbe72b651,0xbeb263ef,0xbee900b7
.long 0xbe94a031,0xbecf7bca,0xbf039c3d,0xbf1d7fd1,0xbee63375,0xbf0f8784,0xbf299415,0xbf40d0da
.long 0xbf187fc0,0xbf32c8c9,0xbf49d112,0xbf5d2d53,0xbf396842,0xbf5064af,0xbf633c5a,0xbf718f57
.long 0xbf54db31,0xbf676bd8,0xbf74fa0b,0xbf7d3aac,0xbf6a09a7,0xbf772417,0xbf7e70b0,0xbf7fc38f
.long 0xbf7853f8,0xbf7f0e58,0xbf7f4e6d,0xbf791298,0xbf7f4e6d,0xbf7eea9d,0xbf778bc5,0xbf696591
.long 0xbf7ec46d,0xbf76ba07,0xbf676bd8,0xbf514d3d,0xbf76ba07,0xbf66becc,0xbf4f7a1f,0xbf31a81d
.long 0xbf676bd8,0xbf4f7a1f,0xbf3085bb,0xbf0b9a6b,0xbf514d3d,0xbf31a81d,0xbf0b9a6b,0xbec1071e
.long 0x3c003c00,0x3c003c00,0x3c003c00,0x3c003c00,0x3bf63c00,0x3ba83bd9,0xae460000,0xb4a5b23e
.long 0x3bd93c00,0x3aa73b64,0xbbd9bc00,0xbaa7bb64,0x3ba83c00,0x39133aa7,0x34a58000,0x3a2f3872
.long 0x3b643c00,0x361f39a8,0x3b643c00,0x361f39a8,0x3b0e3c00,0x2e463872,0xb78b0000,0xbbf6baa7
.long 0x3aa73c00,0xb23e361f,0xbaa7bc00,0x323eb61f,0x3a2f3c00,0xb78b323e,0x39138000,0x3b0e3bd9
.long 0x39a83c00,0xb9a80000,0x39a83c00,0xb9a80000,0x39133c00,0xbb0eb23e,0xba2f0000,0xb78bbbd9
.long 0x38723c00,0xbbd9b61f,0xb872bc00,0x3bd9361f,0x378b3c00,0xbbf6b872,0x3b0e8000,0xae463aa7
.long 0x361f3c00,0xbb64b9a8,0x361f3c00,0xbb64b9a8,0x34a53c00,0xba2fbaa7,0xbba80000,0x3913b872
.long 0x323e3c00,0xb872bb64,0xb23ebc00,0x38723b64,0x2e463c00,0xb4a5bbd9,0x3bf68000,0xbba8323e
.long 0x3c003c00,0x3c003c00,0x3c003c00,0x3c003c00,0x3b0e3b64,0x3a2f3aa7,0xb78bb61f,0xb913b872
.long 0x387239a8,0x323e361f,0xb872b9a8,0xb23eb61f,0x2e46361f,0xb78bb23e,0x3bf63b64,0x3b0e3bd9
.long 0xb61f0000,0xbb64b9a8,0xb61f0000,0xbb64b9a8,0xba2fb61f,0xbba8bbd9,0xb913bb64,0x34a5b23e
.long 0xbbd9b9a8,0xb872bb64,0x3bd939a8,0x38723b64,0xbba8bb64,0x2e46b872,0xb4a5361f,0xbbf6baa7
.long 0xb9a8bc00,0x39a88000,0xb9a8bc00,0x39a88000,0xb4a5bb64,0x3bf63872,0x3ba8361f,0x2e463aa7
.long 0x323eb9a8,0x3aa73b64,0xb23e39a8,0xbaa7bb64,0x3913b61f,0x34a53bd9,0xba2fbb64,0x3ba8323e
.long 0x3b648000,0xb61f39a8,0x3b648000,0xb61f39a8,0x3bf6361f,0xbb0e323e,0xae463b64,0xb78bbbd9
.long 0x3aa739a8,0xbbd9b61f,0xbaa7b9a8,0x3bd9361f,0x378b3b64,0xb913baa7,0x3b0eb61f,0xba2f3872
.long 0x3c003c00,0x3c003c00,0x3c003c00,0x3c003c00,0x391339a8,0x378b3872,0xba2fb9a8,0xbb0ebaa7
.long 0xb23e0000,0xb872b61f,0x323e8000,0x3872361f,0xbb0eb9a8,0xbbf6bbd9,0x378b39a8,0xae46323e
.long 0xbb64bc00,0xb61fb9a8,0xbb64bc00,0xb61fb9a8,0xb4a5b9a8,0x3913323e,0x3ba839a8,0x3a2f3bd9
.long 0x38728000,0x3bd93b64,0xb8720000,0xbbd9bb64,0x3bf639a8,0x34a53aa7,0xae46b9a8,0x3ba83872
.long 0x39a83c00,0xb9a80000,0x39a83c00,0xb9a80000,0xae4639a8,0xbba8baa7,0xbbf6b9a8,0x34a5b872
.long 0xbaa70000,0xb23ebb64,0x3aa78000,0x323e3b64,0xbba8b9a8,0x3a2fb23e,0xb4a539a8,0xb913bbd9
.long 0xb61fbc00,0x3b6439a8,0xb61fbc00,0x3b6439a8,0x378bb9a8,0x2e463bd9,0x3b0e39a8,0xbbf6b23e
.long 0x3bd98000,0xbaa7361f,0xbbd90000,0x3aa7b61f,0x3a2f39a8,0xbb0eb872,0x3913b9a8,0xb78b3aa7
.long 0x3c003c00,0x3c003c00,0x3c003c00,0x3c003c00,0x34a5361f,0x2e46323e,0xbba8bb64,0xbbf6bbd9
.long 0xbaa7b9a8,0xbbd9bb64,0x3aa739a8,0x3bd93b64,0xba2fbb64,0xb4a5b872,0xb913b61f,0xbba8baa7
.long 0x361f8000,0x3b6439a8,0x361f8000,0x3b6439a8,0x3bf63b64,0x378b3aa7,0xae46361f,0xbb0eb872
.long 0x323e39a8,0xbaa7b61f,0xb23eb9a8,0x3aa7361f,0xbb0eb61f,0xb913bbd9,0x378b3b64,0xba2fb23e
.long 0xb9a8bc00,0x39a88000,0xb9a8bc00,0x39a88000,0x378bb61f,0x3a2f3bd9,0x3b0e3b64,0xb913323e
.long 0x3bd939a8,0xb872361f,0xbbd9b9a8,0x3872b61f,0x2e463b64,0xbb0ebaa7,0x3bf6361f,0xb78b3872
.long 0xbb640000,0x361fb9a8,0xbb640000,0x361fb9a8,0xb913bb64,0x3ba83872,0x3a2fb61f,0xb4a53aa7
.long 0x3872b9a8,0xb23e3b64,0xb87239a8,0x323ebb64,0x3ba8361f,0xbbf6b23e,0x34a5bb64,0xae463bd9
.long 0x0,0x0,0x0,0x0,0x2e460000,0x34a5323e,0x3bf63c00,0x3ba83bd9
.long 0x323e0000,0x3872361f,0xb23e0000,0xb872b61f,0x34a50000,0x3a2f3872,0xbba8bc00,0xb913baa7
.long 0x361f0000,0x3b6439a8,0x361f0000,0x3b6439a8,0x378b0000,0x3bf63aa7,0x3b0e3c00,0x2e463872
.long 0x38720000,0x3bd93b64,0xb8720000,0xbbd9bb64,0x39130000,0x3b0e3bd9,0xba2fbc00,0x378bb23e
.long 0x39a80000,0x39a83c00,0x39a80000,0x39a83c00,0x3a2f0000,0x378b3bd9,0x39133c00,0xbb0eb23e
.long 0x3aa70000,0x323e3b64,0xbaa70000,0xb23ebb64,0x3b0e0000,0xae463aa7,0xb78bbc00,0x3bf63872
.long 0x3b640000,0xb61f39a8,0x3b640000,0xb61f39a8,0x3ba80000,0xb9133872,0x34a53c00,0xba2fbaa7
.long 0x3bd90000,0xbaa7361f,0xbbd90000,0x3aa7b61f,0x3bf60000,0xbba8323e,0xae46bc00,0x34a53bd9
.long 0x0,0x0,0x0,0x0,0x378b361f,0x39133872,0x3b0e3b64,0x3a2f3aa7
.long 0x3aa739a8,0x3bd93b64,0xbaa7b9a8,0xbbd9bb64,0x3bf63b64,0x3b0e3bd9,0xae46b61f,0x378b323e
.long 0x3b643c00,0x361f39a8,0x3b643c00,0x361f39a8,0x39133b64,0xb4a5323e,0xba2fb61f,0xbba8bbd9
.long 0x323e39a8,0xbaa7b61f,0xb23eb9a8,0x3aa7361f,0xb4a5361f,0xbbf6baa7,0x3ba83b64,0xae463872
.long 0xb9a80000,0xb9a8bc00,0xb9a80000,0xb9a8bc00,0xbba8b61f,0xae46baa7,0xb4a5bb64,0x3bf63872
.long 0xbbd9b9a8,0x3872b61f,0x3bd939a8,0xb872361f,0xba2fbb64,0x3ba8323e,0xb913361f,0xb4a5bbd9
.long 0xb61fbc00,0x3b6439a8,0xb61fbc00,0x3b6439a8,0x2e46bb64,0x378b3bd9,0x3bf6361f,0xbb0e323e
.long 0x3872b9a8,0xb23e3b64,0xb87239a8,0x323ebb64,0x3b0eb61f,0xba2f3872,0xb78bbb64,0x39133aa7
.long 0x0,0x0,0x0,0x0,0x3a2f39a8,0x3b0e3aa7,0x391339a8,0x378b3872
.long 0x3bd93c00,0x3aa73b64,0xbbd9bc00,0xbaa7bb64,0x378b39a8,0xae46323e,0x3b0e39a8,0x3bf63bd9
.long 0xb61f0000,0xbb64b9a8,0xb61f0000,0xbb64b9a8,0xbba8b9a8,0xba2fbbd9,0xb4a5b9a8,0x3913323e
.long 0xbaa7bc00,0x323eb61f,0x3aa73c00,0xb23e361f,0xae46b9a8,0x3ba83872,0xbbf6b9a8,0xb4a5baa7
.long 0x39a80000,0x39a83c00,0x39a80000,0x39a83c00,0x3bf639a8,0xb4a53872,0xae4639a8,0xbba8baa7
.long 0x38723c00,0xbbd9b61f,0xb872bc00,0x3bd9361f,0xb4a539a8,0xb913bbd9,0x3ba839a8,0xba2f323e
.long 0xbb640000,0x361fb9a8,0xbb640000,0x361fb9a8,0xbb0eb9a8,0x3bf6323e,0x378bb9a8,0x2e463bd9
.long 0xb23ebc00,0x38723b64,0x323e3c00,0xb872bb64,0x3913b9a8,0xb78b3aa7,0xba2fb9a8,0x3b0e3872
.long 0x0,0x0,0x0,0x0,0x3ba83b64,0x3bf63bd9,0x34a5361f,0x2e46323e
.long 0x387239a8,0x323e361f,0xb872b9a8,0xb23eb61f,0xb913b61f,0xbba8baa7,0x3a2f3b64,0x34a53872
.long 0xbb64bc00,0xb61fb9a8,0xbb64bc00,0xb61fb9a8,0x2e46b61f,0x3b0e3872,0x3bf63b64,0x378b3aa7
.long 0x3bd939a8,0x38723b64,0xbbd9b9a8,0xb872bb64,0x378b3b64,0xba2fb23e,0x3b0e361f,0x39133bd9
.long 0xb9a80000,0xb9a8bc00,0xb9a80000,0xb9a8bc00,0xbb0ebb64,0x3913b23e,0x378bb61f,0x3a2f3bd9
.long 0x323eb9a8,0x3aa73b64,0xb23e39a8,0xbaa7bb64,0x3bf6361f,0xb78b3872,0xae46bb64,0x3b0e3aa7
.long 0x361f3c00,0xbb64b9a8,0x361f3c00,0xbb64b9a8,0xba2f361f,0x34a5baa7,0xb913bb64,0x3ba83872
.long 0xbaa7b9a8,0x3bd9361f,0x3aa739a8,0xbbd9b61f,0x34a5bb64,0xae463bd9,0xbba8b61f,0x3bf6323e
.long 0x3c00,0x8000bc00,0x3c00,0x8000bc00,0xae463c00,0x34a5bbd9,0xbbf60000,0x3ba8323e
.long 0xb23e3c00,0x3872bb64,0x323ebc00,0xb8723b64,0xb4a53c00,0x3a2fbaa7,0x3ba88000,0xb913b872
.long 0xb61f3c00,0x3b64b9a8,0xb61f3c00,0x3b64b9a8,0xb78b3c00,0x3bf6b872,0xbb0e0000,0x2e463aa7
.long 0xb8723c00,0x3bd9b61f,0x3872bc00,0xbbd9361f,0xb9133c00,0x3b0eb23e,0x3a2f8000,0x378bbbd9
.long 0xb9a83c00,0x39a88000,0xb9a83c00,0x39a88000,0xba2f3c00,0x378b323e,0xb9130000,0xbb0e3bd9
.long 0xbaa73c00,0x323e361f,0x3aa7bc00,0xb23eb61f,0xbb0e3c00,0xae463872,0x378b8000,0x3bf6baa7
.long 0xbb643c00,0xb61f39a8,0xbb643c00,0xb61f39a8,0xbba83c00,0xb9133aa7,0xb4a50000,0xba2f3872
.long 0xbbd93c00,0xbaa73b64,0x3bd9bc00,0x3aa7bb64,0xbbf63c00,0xbba83bd9,0x2e468000,0x34a5b23e
.long 0x3c00,0x8000bc00,0x3c00,0x8000bc00,0xb78b3b64,0x3913baa7,0xbb0eb61f,0x3a2f3872
.long 0xbaa739a8,0x3bd9b61f,0x3aa7b9a8,0xbbd9361f,0xbbf6361f,0x3b0e323e,0x2e463b64,0x378bbbd9
.long 0xbb640000,0x361f39a8,0xbb640000,0x361f39a8,0xb913b61f,0xb4a53bd9,0x3a2fbb64,0xbba8323e
.long 0xb23eb9a8,0xbaa73b64,0x323e39a8,0x3aa7bb64,0x34a5bb64,0xbbf63872,0xbba8361f,0xae463aa7
.long 0x39a8bc00,0xb9a80000,0x39a8bc00,0xb9a80000,0x3ba8bb64,0xae46b872,0x34a5361f,0x3bf6baa7
.long 0x3bd9b9a8,0x3872bb64,0xbbd939a8,0xb8723b64,0x3a2fb61f,0x3ba8bbd9,0x3913bb64,0xb4a5b23e
.long 0x361f8000,0x3b64b9a8,0x361f8000,0x3b64b9a8,0xae46361f,0x378bb23e,0xbbf63b64,0xbb0e3bd9
.long 0xb87239a8,0xb23e361f,0x3872b9a8,0x323eb61f,0xbb0e3b64,0xba2f3aa7,0x378bb61f,0x3913b872
.long 0x3c00,0x8000bc00,0x3c00,0x8000bc00,0xba2f39a8,0x3b0eb872,0xb913b9a8,0x378b3aa7
.long 0xbbd90000,0x3aa7361f,0x3bd98000,0xbaa7b61f,0xb78bb9a8,0xae463bd9,0xbb0e39a8,0x3bf6b23e
.long 0x361fbc00,0xbb6439a8,0x361fbc00,0xbb6439a8,0x3ba8b9a8,0xba2fb23e,0x34a539a8,0x3913bbd9
.long 0x3aa78000,0x323ebb64,0xbaa70000,0xb23e3b64,0x2e4639a8,0x3ba8baa7,0x3bf6b9a8,0xb4a5b872
.long 0xb9a83c00,0x39a88000,0xb9a83c00,0x39a88000,0xbbf639a8,0xb4a53aa7,0x2e46b9a8,0xbba83872
.long 0xb8720000,0xbbd93b64,0x38728000,0x3bd9bb64,0x34a5b9a8,0xb913323e,0xbba839a8,0xba2f3bd9
.long 0x3b64bc00,0x361fb9a8,0x3b64bc00,0x361fb9a8,0x3b0eb9a8,0x3bf6bbd9,0xb78b39a8,0x2e46323e
.long 0x323e8000,0x3872b61f,0xb23e0000,0xb872361f,0xb91339a8,0xb78b3872,0x3a2fb9a8,0x3b0ebaa7
.long 0x3c00,0x8000bc00,0x3c00,0x8000bc00,0xbba8361f,0x3bf6b23e,0xb4a5bb64,0x2e463bd9
.long 0xb872b9a8,0x323e3b64,0x387239a8,0xb23ebb64,0x3913bb64,0xbba83872,0xba2fb61f,0x34a53aa7
.long 0x3b648000,0xb61fb9a8,0x3b648000,0xb61fb9a8,0xae463b64,0x3b0ebaa7,0xbbf6361f,0x378b3872
.long 0xbbd939a8,0x3872361f,0x3bd9b9a8,0xb872b61f,0xb78bb61f,0xba2f3bd9,0xbb0e3b64,0x3913323e
.long 0x39a8bc00,0xb9a80000,0x39a8bc00,0xb9a80000,0x3b0eb61f,0x3913bbd9,0xb78b3b64,0x3a2fb23e
.long 0xb23e39a8,0x3aa7b61f,0x323eb9a8,0xbaa7361f,0xbbf63b64,0xb78b3aa7,0x2e46361f,0x3b0eb872
.long 0xb61f0000,0xbb6439a8,0xb61f0000,0xbb6439a8,0x3a2fbb64,0x34a5b872,0x3913b61f,0x3ba8baa7
.long 0x3aa7b9a8,0x3bd9bb64,0xbaa739a8,0xbbd93b64,0xb4a5361f,0xae46323e,0x3ba8bb64,0x3bf6bbd9
.long 0x3c000000,0xbc000000,0x3c000000,0xbc000000,0x3bf60000,0xbba8b23e,0xae463c00,0x34a5bbd9
.long 0x3bd90000,0xbaa7b61f,0xbbd90000,0x3aa7361f,0x3ba80000,0xb913b872,0x34a5bc00,0xba2f3aa7
.long 0x3b640000,0xb61fb9a8,0x3b640000,0xb61fb9a8,0x3b0e0000,0xae46baa7,0xb78b3c00,0x3bf6b872
.long 0x3aa70000,0x323ebb64,0xbaa70000,0xb23e3b64,0x3a2f0000,0x378bbbd9,0x3913bc00,0xbb0e323e
.long 0x39a80000,0x39a8bc00,0x39a80000,0x39a8bc00,0x39130000,0x3b0ebbd9,0xba2f3c00,0x378b323e
.long 0x38720000,0x3bd9bb64,0xb8720000,0xbbd93b64,0x378b0000,0x3bf6baa7,0x3b0ebc00,0x2e46b872
.long 0x361f0000,0x3b64b9a8,0x361f0000,0x3b64b9a8,0x34a50000,0x3a2fb872,0xbba83c00,0xb9133aa7
.long 0x323e0000,0x3872b61f,0xb23e0000,0xb872361f,0x2e460000,0x34a5b23e,0x3bf6bc00,0x3ba8bbd9
.long 0x3c000000,0xbc000000,0x3c000000,0xbc000000,0x3b0e361f,0xba2fb872,0xb78b3b64,0x3913baa7
.long 0x387239a8,0xb23ebb64,0xb872b9a8,0x323e3b64,0x2e463b64,0x378bbbd9,0x3bf6b61f,0xbb0eb23e
.long 0xb61f3c00,0x3b64b9a8,0xb61f3c00,0x3b64b9a8,0xba2f3b64,0x3ba8b23e,0xb913b61f,0xb4a53bd9
.long 0xbbd939a8,0x3872361f,0x3bd9b9a8,0xb872b61f,0xbba8361f,0xae463aa7,0xb4a53b64,0x3bf6b872
.long 0xb9a80000,0xb9a83c00,0xb9a80000,0xb9a83c00,0xb4a5b61f,0xbbf63aa7,0x3ba8bb64,0xae46b872
.long 0x323eb9a8,0xbaa7361f,0xb23e39a8,0x3aa7b61f,0x3913bb64,0xb4a5b23e,0xba2f361f,0xbba83bd9
.long 0x3b64bc00,0x361fb9a8,0x3b64bc00,0x361fb9a8,0x3bf6bb64,0x3b0ebbd9,0xae46361f,0x378bb23e
.long 0x3aa7b9a8,0x3bd9bb64,0xbaa739a8,0xbbd93b64,0x378bb61f,0x3913b872,0x3b0ebb64,0x3a2fbaa7
.long 0x3c000000,0xbc000000,0x3c000000,0xbc000000,0x391339a8,0xb78bbaa7,0xba2f39a8,0x3b0eb872
.long 0xb23e3c00,0x3872bb64,0x323ebc00,0xb8723b64,0xbb0e39a8,0x3bf6b23e,0x378b39a8,0x2e46bbd9
.long 0xbb640000,0x361f39a8,0xbb640000,0x361f39a8,0xb4a5b9a8,0xb9133bd9,0x3ba8b9a8,0xba2fb23e
.long 0x3872bc00,0xbbd9361f,0xb8723c00,0x3bd9b61f,0x3bf6b9a8,0xb4a5b872,0xae46b9a8,0xbba83aa7
.long 0x39a80000,0x39a8bc00,0x39a80000,0x39a8bc00,0xae4639a8,0x3ba8b872,0xbbf639a8,0xb4a53aa7
.long 0xbaa73c00,0x323e361f,0x3aa7bc00,0xb23eb61f,0xbba839a8,0xba2f3bd9,0xb4a539a8,0x3913b23e
.long 0xb61f0000,0xbb6439a8,0xb61f0000,0xbb6439a8,0x378bb9a8,0xae46b23e,0x3b0eb9a8,0x3bf6bbd9
.long 0x3bd9bc00,0x3aa7bb64,0xbbd93c00,0xbaa73b64,0x3a2fb9a8,0x3b0ebaa7,0x3913b9a8,0x378bb872
.long 0x3c000000,0xbc000000,0x3c000000,0xbc000000,0x34a53b64,0xae46bbd9,0xbba8361f,0x3bf6b23e
.long 0xbaa739a8,0x3bd9b61f,0x3aa7b9a8,0xbbd9361f,0xba2fb61f,0x34a53aa7,0xb9133b64,0x3ba8b872
.long 0x361fbc00,0xbb6439a8,0x361fbc00,0xbb6439a8,0x3bf6b61f,0xb78bb872,0xae463b64,0x3b0ebaa7
.long 0x323e39a8,0x3aa7bb64,0xb23eb9a8,0xbaa73b64,0xbb0e3b64,0x3913323e,0x378b361f,0x3a2fbbd9
.long 0xb9a80000,0xb9a83c00,0xb9a80000,0xb9a83c00,0x378bbb64,0xba2f323e,0x3b0eb61f,0x3913bbd9
.long 0x3bd9b9a8,0x3872bb64,0xbbd939a8,0xb8723b64,0x2e46361f,0x3b0eb872,0x3bf6bb64,0x378bbaa7
.long 0xbb643c00,0xb61f39a8,0xbb643c00,0xb61f39a8,0xb913361f,0xbba83aa7,0x3a2fbb64,0x34a5b872
.long 0x3872b9a8,0x323eb61f,0xb87239a8,0xb23e361f,0x3ba8bb64,0x3bf6bbd9,0x34a5b61f,0x2e46b23e
.long 0xbc003c00,0xbc003c00,0xbc003c00,0xbc003c00,0xbbf63c00,0xbba83bd9,0x2e460000,0x34a5b23e
.long 0xbbd93c00,0xbaa73b64,0x3bd9bc00,0x3aa7bb64,0xbba83c00,0xb9133aa7,0xb4a58000,0xba2f3872
.long 0xbb643c00,0xb61f39a8,0xbb643c00,0xb61f39a8,0xbb0e3c00,0xae463872,0x378b0000,0x3bf6baa7
.long 0xbaa73c00,0x323e361f,0x3aa7bc00,0xb23eb61f,0xba2f3c00,0x378b323e,0xb9138000,0xbb0e3bd9
.long 0xb9a83c00,0x39a80000,0xb9a83c00,0x39a80000,0xb9133c00,0x3b0eb23e,0x3a2f0000,0x378bbbd9
.long 0xb8723c00,0x3bd9b61f,0x3872bc00,0xbbd9361f,0xb78b3c00,0x3bf6b872,0xbb0e8000,0x2e463aa7
.long 0xb61f3c00,0x3b64b9a8,0xb61f3c00,0x3b64b9a8,0xb4a53c00,0x3a2fbaa7,0x3ba80000,0xb913b872
.long 0xb23e3c00,0x3872bb64,0x323ebc00,0xb8723b64,0xae463c00,0x34a5bbd9,0xbbf68000,0x3ba8323e
.long 0xbc003c00,0xbc003c00,0xbc003c00,0xbc003c00,0xbb0e3b64,0xba2f3aa7,0x378bb61f,0x3913b872
.long 0xb87239a8,0xb23e361f,0x3872b9a8,0x323eb61f,0xae46361f,0x378bb23e,0xbbf63b64,0xbb0e3bd9
.long 0x361f0000,0x3b64b9a8,0x361f0000,0x3b64b9a8,0x3a2fb61f,0x3ba8bbd9,0x3913bb64,0xb4a5b23e
.long 0x3bd9b9a8,0x3872bb64,0xbbd939a8,0xb8723b64,0x3ba8bb64,0xae46b872,0x34a5361f,0x3bf6baa7
.long 0x39a8bc00,0xb9a88000,0x39a8bc00,0xb9a88000,0x34a5bb64,0xbbf63872,0xbba8361f,0xae463aa7
.long 0xb23eb9a8,0xbaa73b64,0x323e39a8,0x3aa7bb64,0xb913b61f,0xb4a53bd9,0x3a2fbb64,0xbba8323e
.long 0xbb648000,0x361f39a8,0xbb648000,0x361f39a8,0xbbf6361f,0x3b0e323e,0x2e463b64,0x378bbbd9
.long 0xbaa739a8,0x3bd9b61f,0x3aa7b9a8,0xbbd9361f,0xb78b3b64,0x3913baa7,0xbb0eb61f,0x3a2f3872
.long 0xbc003c00,0xbc003c00,0xbc003c00,0xbc003c00,0xb91339a8,0xb78b3872,0x3a2fb9a8,0x3b0ebaa7
.long 0x323e0000,0x3872b61f,0xb23e8000,0xb872361f,0x3b0eb9a8,0x3bf6bbd9,0xb78b39a8,0x2e46323e
.long 0x3b64bc00,0x361fb9a8,0x3b64bc00,0x361fb9a8,0x34a5b9a8,0xb913323e,0xbba839a8,0xba2f3bd9
.long 0xb8728000,0xbbd93b64,0x38720000,0x3bd9bb64,0xbbf639a8,0xb4a53aa7,0x2e46b9a8,0xbba83872
.long 0xb9a83c00,0x39a80000,0xb9a83c00,0x39a80000,0x2e4639a8,0x3ba8baa7,0x3bf6b9a8,0xb4a5b872
.long 0x3aa70000,0x323ebb64,0xbaa78000,0xb23e3b64,0x3ba8b9a8,0xba2fb23e,0x34a539a8,0x3913bbd9
.long 0x361fbc00,0xbb6439a8,0x361fbc00,0xbb6439a8,0xb78bb9a8,0xae463bd9,0xbb0e39a8,0x3bf6b23e
.long 0xbbd98000,0x3aa7361f,0x3bd90000,0xbaa7b61f,0xba2f39a8,0x3b0eb872,0xb913b9a8,0x378b3aa7
.long 0xbc003c00,0xbc003c00,0xbc003c00,0xbc003c00,0xb4a5361f,0xae46323e,0x3ba8bb64,0x3bf6bbd9
.long 0x3aa7b9a8,0x3bd9bb64,0xbaa739a8,0xbbd93b64,0x3a2fbb64,0x34a5b872,0x3913b61f,0x3ba8baa7
.long 0xb61f8000,0xbb6439a8,0xb61f8000,0xbb6439a8,0xbbf63b64,0xb78b3aa7,0x2e46361f,0x3b0eb872
.long 0xb23e39a8,0x3aa7b61f,0x323eb9a8,0xbaa7361f,0x3b0eb61f,0x3913bbd9,0xb78b3b64,0x3a2fb23e
.long 0x39a8bc00,0xb9a88000,0x39a8bc00,0xb9a88000,0xb78bb61f,0xba2f3bd9,0xbb0e3b64,0x3913323e
.long 0xbbd939a8,0x3872361f,0x3bd9b9a8,0xb872b61f,0xae463b64,0x3b0ebaa7,0xbbf6361f,0x378b3872
.long 0x3b640000,0xb61fb9a8,0x3b640000,0xb61fb9a8,0x3913bb64,0xbba83872,0xba2fb61f,0x34a53aa7
.long 0xb872b9a8,0x323e3b64,0x387239a8,0xb23ebb64,0xbba8361f,0x3bf6b23e,0xb4a5bb64,0x2e463bd9
.long 0x0,0x0,0x0,0x0,0xae460000,0xb4a5323e,0xbbf63c00,0xbba83bd9
.long 0xb23e0000,0xb872361f,0x323e0000,0x3872b61f,0xb4a50000,0xba2f3872,0x3ba8bc00,0x3913baa7
.long 0xb61f0000,0xbb6439a8,0xb61f0000,0xbb6439a8,0xb78b0000,0xbbf63aa7,0xbb0e3c00,0xae463872
.long 0xb8720000,0xbbd93b64,0x38720000,0x3bd9bb64,0xb9130000,0xbb0e3bd9,0x3a2fbc00,0xb78bb23e
.long 0xb9a80000,0xb9a83c00,0xb9a80000,0xb9a83c00,0xba2f0000,0xb78b3bd9,0xb9133c00,0x3b0eb23e
.long 0xbaa70000,0xb23e3b64,0x3aa70000,0x323ebb64,0xbb0e0000,0x2e463aa7,0x378bbc00,0xbbf63872
.long 0xbb640000,0x361f39a8,0xbb640000,0x361f39a8,0xbba80000,0x39133872,0xb4a53c00,0x3a2fbaa7
.long 0xbbd90000,0x3aa7361f,0x3bd90000,0xbaa7b61f,0xbbf60000,0x3ba8323e,0x2e46bc00,0xb4a53bd9
.long 0x0,0x0,0x0,0x0,0xb78b361f,0xb9133872,0xbb0e3b64,0xba2f3aa7
.long 0xbaa739a8,0xbbd93b64,0x3aa7b9a8,0x3bd9bb64,0xbbf63b64,0xbb0e3bd9,0x2e46b61f,0xb78b323e
.long 0xbb643c00,0xb61f39a8,0xbb643c00,0xb61f39a8,0xb9133b64,0x34a5323e,0x3a2fb61f,0x3ba8bbd9
.long 0xb23e39a8,0x3aa7b61f,0x323eb9a8,0xbaa7361f,0x34a5361f,0x3bf6baa7,0xbba83b64,0x2e463872
.long 0x39a80000,0x39a8bc00,0x39a80000,0x39a8bc00,0x3ba8b61f,0x2e46baa7,0x34a5bb64,0xbbf63872
.long 0x3bd9b9a8,0xb872b61f,0xbbd939a8,0x3872361f,0x3a2fbb64,0xbba8323e,0x3913361f,0x34a5bbd9
.long 0x361fbc00,0xbb6439a8,0x361fbc00,0xbb6439a8,0xae46bb64,0xb78b3bd9,0xbbf6361f,0x3b0e323e
.long 0xb872b9a8,0x323e3b64,0x387239a8,0xb23ebb64,0xbb0eb61f,0x3a2f3872,0x378bbb64,0xb9133aa7
.long 0x0,0x0,0x0,0x0,0xba2f39a8,0xbb0e3aa7,0xb91339a8,0xb78b3872
.long 0xbbd93c00,0xbaa73b64,0x3bd9bc00,0x3aa7bb64,0xb78b39a8,0x2e46323e,0xbb0e39a8,0xbbf63bd9
.long 0x361f0000,0x3b64b9a8,0x361f0000,0x3b64b9a8,0x3ba8b9a8,0x3a2fbbd9,0x34a5b9a8,0xb913323e
.long 0x3aa7bc00,0xb23eb61f,0xbaa73c00,0x323e361f,0x2e46b9a8,0xbba83872,0x3bf6b9a8,0x34a5baa7
.long 0xb9a80000,0xb9a83c00,0xb9a80000,0xb9a83c00,0xbbf639a8,0x34a53872,0x2e4639a8,0x3ba8baa7
.long 0xb8723c00,0x3bd9b61f,0x3872bc00,0xbbd9361f,0x34a539a8,0x3913bbd9,0xbba839a8,0x3a2f323e
.long 0x3b640000,0xb61fb9a8,0x3b640000,0xb61fb9a8,0x3b0eb9a8,0xbbf6323e,0xb78bb9a8,0xae463bd9
.long 0x323ebc00,0xb8723b64,0xb23e3c00,0x3872bb64,0xb913b9a8,0x378b3aa7,0x3a2fb9a8,0xbb0e3872
.long 0x0,0x0,0x0,0x0,0xbba83b64,0xbbf63bd9,0xb4a5361f,0xae46323e
.long 0xb87239a8,0xb23e361f,0x3872b9a8,0x323eb61f,0x3913b61f,0x3ba8baa7,0xba2f3b64,0xb4a53872
.long 0x3b64bc00,0x361fb9a8,0x3b64bc00,0x361fb9a8,0xae46b61f,0xbb0e3872,0xbbf63b64,0xb78b3aa7
.long 0xbbd939a8,0xb8723b64,0x3bd9b9a8,0x3872bb64,0xb78b3b64,0x3a2fb23e,0xbb0e361f,0xb9133bd9
.long 0x39a80000,0x39a8bc00,0x39a80000,0x39a8bc00,0x3b0ebb64,0xb913b23e,0xb78bb61f,0xba2f3bd9
.long 0xb23eb9a8,0xbaa73b64,0x323e39a8,0x3aa7bb64,0xbbf6361f,0x378b3872,0x2e46bb64,0xbb0e3aa7
.long 0xb61f3c00,0x3b64b9a8,0xb61f3c00,0x3b64b9a8,0x3a2f361f,0xb4a5baa7,0x3913bb64,0xbba83872
.long 0x3aa7b9a8,0xbbd9361f,0xbaa739a8,0x3bd9b61f,0xb4a5bb64,0x2e463bd9,0x3ba8b61f,0xbbf6323e
.long 0x80003c00,0xbc00,0x80003c00,0xbc00,0x2e463c00,0xb4a5bbd9,0x3bf60000,0xbba8323e
.long 0x323e3c00,0xb872bb64,0xb23ebc00,0x38723b64,0x34a53c00,0xba2fbaa7,0xbba88000,0x3913b872
.long 0x361f3c00,0xbb64b9a8,0x361f3c00,0xbb64b9a8,0x378b3c00,0xbbf6b872,0x3b0e0000,0xae463aa7
.long 0x38723c00,0xbbd9b61f,0xb872bc00,0x3bd9361f,0x39133c00,0xbb0eb23e,0xba2f8000,0xb78bbbd9
.long 0x39a83c00,0xb9a88000,0x39a83c00,0xb9a88000,0x3a2f3c00,0xb78b323e,0x39130000,0x3b0e3bd9
.long 0x3aa73c00,0xb23e361f,0xbaa7bc00,0x323eb61f,0x3b0e3c00,0x2e463872,0xb78b8000,0xbbf6baa7
.long 0x3b643c00,0x361f39a8,0x3b643c00,0x361f39a8,0x3ba83c00,0x39133aa7,0x34a50000,0x3a2f3872
.long 0x3bd93c00,0x3aa73b64,0xbbd9bc00,0xbaa7bb64,0x3bf63c00,0x3ba83bd9,0xae468000,0xb4a5b23e
.long 0x80003c00,0xbc00,0x80003c00,0xbc00,0x378b3b64,0xb913baa7,0x3b0eb61f,0xba2f3872
.long 0x3aa739a8,0xbbd9b61f,0xbaa7b9a8,0x3bd9361f,0x3bf6361f,0xbb0e323e,0xae463b64,0xb78bbbd9
.long 0x3b640000,0xb61f39a8,0x3b640000,0xb61f39a8,0x3913b61f,0x34a53bd9,0xba2fbb64,0x3ba8323e
.long 0x323eb9a8,0x3aa73b64,0xb23e39a8,0xbaa7bb64,0xb4a5bb64,0x3bf63872,0x3ba8361f,0x2e463aa7
.long 0xb9a8bc00,0x39a80000,0xb9a8bc00,0x39a80000,0xbba8bb64,0x2e46b872,0xb4a5361f,0xbbf6baa7
.long 0xbbd9b9a8,0xb872bb64,0x3bd939a8,0x38723b64,0xba2fb61f,0xbba8bbd9,0xb913bb64,0x34a5b23e
.long 0xb61f8000,0xbb64b9a8,0xb61f8000,0xbb64b9a8,0x2e46361f,0xb78bb23e,0x3bf63b64,0x3b0e3bd9
.long 0x387239a8,0x323e361f,0xb872b9a8,0xb23eb61f,0x3b0e3b64,0x3a2f3aa7,0xb78bb61f,0xb913b872
.long 0x80003c00,0xbc00,0x80003c00,0xbc00,0x3a2f39a8,0xbb0eb872,0x3913b9a8,0xb78b3aa7
.long 0x3bd90000,0xbaa7361f,0xbbd98000,0x3aa7b61f,0x378bb9a8,0x2e463bd9,0x3b0e39a8,0xbbf6b23e
.long 0xb61fbc00,0x3b6439a8,0xb61fbc00,0x3b6439a8,0xbba8b9a8,0x3a2fb23e,0xb4a539a8,0xb913bbd9
.long 0xbaa78000,0xb23ebb64,0x3aa70000,0x323e3b64,0xae4639a8,0xbba8baa7,0xbbf6b9a8,0x34a5b872
.long 0x39a83c00,0xb9a88000,0x39a83c00,0xb9a88000,0x3bf639a8,0x34a53aa7,0xae46b9a8,0x3ba83872
.long 0x38720000,0x3bd93b64,0xb8728000,0xbbd9bb64,0xb4a5b9a8,0x3913323e,0x3ba839a8,0x3a2f3bd9
.long 0xbb64bc00,0xb61fb9a8,0xbb64bc00,0xb61fb9a8,0xbb0eb9a8,0xbbf6bbd9,0x378b39a8,0xae46323e
.long 0xb23e8000,0xb872b61f,0x323e0000,0x3872361f,0x391339a8,0x378b3872,0xba2fb9a8,0xbb0ebaa7
.long 0x80003c00,0xbc00,0x80003c00,0xbc00,0x3ba8361f,0xbbf6b23e,0x34a5bb64,0xae463bd9
.long 0x3872b9a8,0xb23e3b64,0xb87239a8,0x323ebb64,0xb913bb64,0x3ba83872,0x3a2fb61f,0xb4a53aa7
.long 0xbb648000,0x361fb9a8,0xbb648000,0x361fb9a8,0x2e463b64,0xbb0ebaa7,0x3bf6361f,0xb78b3872
.long 0x3bd939a8,0xb872361f,0xbbd9b9a8,0x3872b61f,0x378bb61f,0x3a2f3bd9,0x3b0e3b64,0xb913323e
.long 0xb9a8bc00,0x39a80000,0xb9a8bc00,0x39a80000,0xbb0eb61f,0xb913bbd9,0x378b3b64,0xba2fb23e
.long 0x323e39a8,0xbaa7b61f,0xb23eb9a8,0x3aa7361f,0x3bf63b64,0x378b3aa7,0xae46361f,0xbb0eb872
.long 0x361f0000,0x3b6439a8,0x361f0000,0x3b6439a8,0xba2fbb64,0xb4a5b872,0xb913b61f,0xbba8baa7
.long 0xbaa7b9a8,0xbbd9bb64,0x3aa739a8,0x3bd93b64,0x34a5361f,0x2e46323e,0xbba8bb64,0xbbf6bbd9
.long 0xbc000000,0x3c000000,0xbc000000,0x3c000000,0xbbf60000,0x3ba8b23e,0x2e463c00,0xb4a5bbd9
.long 0xbbd90000,0x3aa7b61f,0x3bd90000,0xbaa7361f,0xbba80000,0x3913b872,0xb4a5bc00,0x3a2f3aa7
.long 0xbb640000,0x361fb9a8,0xbb640000,0x361fb9a8,0xbb0e0000,0x2e46baa7,0x378b3c00,0xbbf6b872
.long 0xbaa70000,0xb23ebb64,0x3aa70000,0x323e3b64,0xba2f0000,0xb78bbbd9,0xb913bc00,0x3b0e323e
.long 0xb9a80000,0xb9a8bc00,0xb9a80000,0xb9a8bc00,0xb9130000,0xbb0ebbd9,0x3a2f3c00,0xb78b323e
.long 0xb8720000,0xbbd9bb64,0x38720000,0x3bd93b64,0xb78b0000,0xbbf6baa7,0xbb0ebc00,0xae46b872
.long 0xb61f0000,0xbb64b9a8,0xb61f0000,0xbb64b9a8,0xb4a50000,0xba2fb872,0x3ba83c00,0x39133aa7
.long 0xb23e0000,0xb872b61f,0x323e0000,0x3872361f,0xae460000,0xb4a5b23e,0xbbf6bc00,0xbba8bbd9
.long 0xbc000000,0x3c000000,0xbc000000,0x3c000000,0xbb0e361f,0x3a2fb872,0x378b3b64,0xb913baa7
.long 0xb87239a8,0x323ebb64,0x3872b9a8,0xb23e3b64,0xae463b64,0xb78bbbd9,0xbbf6b61f,0x3b0eb23e
.long 0x361f3c00,0xbb64b9a8,0x361f3c00,0xbb64b9a8,0x3a2f3b64,0xbba8b23e,0x3913b61f,0x34a53bd9
.long 0x3bd939a8,0xb872361f,0xbbd9b9a8,0x3872b61f,0x3ba8361f,0x2e463aa7,0x34a53b64,0xbbf6b872
.long 0x39a80000,0x39a83c00,0x39a80000,0x39a83c00,0x34a5b61f,0x3bf63aa7,0xbba8bb64,0x2e46b872
.long 0xb23eb9a8,0x3aa7361f,0x323e39a8,0xbaa7b61f,0xb913bb64,0x34a5b23e,0x3a2f361f,0x3ba83bd9
.long 0xbb64bc00,0xb61fb9a8,0xbb64bc00,0xb61fb9a8,0xbbf6bb64,0xbb0ebbd9,0x2e46361f,0xb78bb23e
.long 0xbaa7b9a8,0xbbd9bb64,0x3aa739a8,0x3bd93b64,0xb78bb61f,0xb913b872,0xbb0ebb64,0xba2fbaa7
.long 0xbc000000,0x3c000000,0xbc000000,0x3c000000,0xb91339a8,0x378bbaa7,0x3a2f39a8,0xbb0eb872
.long 0x323e3c00,0xb872bb64,0xb23ebc00,0x38723b64,0x3b0e39a8,0xbbf6b23e,0xb78b39a8,0xae46bbd9
.long 0x3b640000,0xb61f39a8,0x3b640000,0xb61f39a8,0x34a5b9a8,0x39133bd9,0xbba8b9a8,0x3a2fb23e
.long 0xb872bc00,0x3bd9361f,0x38723c00,0xbbd9b61f,0xbbf6b9a8,0x34a5b872,0x2e46b9a8,0x3ba83aa7
.long 0xb9a80000,0xb9a8bc00,0xb9a80000,0xb9a8bc00,0x2e4639a8,0xbba8b872,0x3bf639a8,0x34a53aa7
.long 0x3aa73c00,0xb23e361f,0xbaa7bc00,0x323eb61f,0x3ba839a8,0x3a2f3bd9,0x34a539a8,0xb913b23e
.long 0x361f0000,0x3b6439a8,0x361f0000,0x3b6439a8,0xb78bb9a8,0x2e46b23e,0xbb0eb9a8,0xbbf6bbd9
.long 0xbbd9bc00,0xbaa7bb64,0x3bd93c00,0x3aa73b64,0xba2fb9a8,0xbb0ebaa7,0xb913b9a8,0xb78bb872
.long 0xbc000000,0x3c000000,0xbc000000,0x3c000000,0xb4a53b64,0x2e46bbd9,0x3ba8361f,0xbbf6b23e
.long 0x3aa739a8,0xbbd9b61f,0xbaa7b9a8,0x3bd9361f,0x3a2fb61f,0xb4a53aa7,0x39133b64,0xbba8b872
.long 0xb61fbc00,0x3b6439a8,0xb61fbc00,0x3b6439a8,0xbbf6b61f,0x378bb872,0x2e463b64,0xbb0ebaa7
.long 0xb23e39a8,0xbaa7bb64,0x323eb9a8,0x3aa73b64,0x3b0e3b64,0xb913323e,0xb78b361f,0xba2fbbd9
.long 0x39a80000,0x39a83c00,0x39a80000,0x39a83c00,0xb78bbb64,0x3a2f323e,0xbb0eb61f,0xb913bbd9
.long 0xbbd9b9a8,0xb872bb64,0x3bd939a8,0x38723b64,0xae46361f,0xbb0eb872,0xbbf6bb64,0xb78bbaa7
.long 0x3b643c00,0x361f39a8,0x3b643c00,0x361f39a8,0x3913361f,0x3ba83aa7,0xba2fbb64,0xb4a5b872
.long 0xb872b9a8,0xb23eb61f,0x387239a8,0x323e361f,0xbba8bb64,0xbbf6bbd9,0xb4a5b61f,0xae46b23e
.long 0x3c003c00,0x3c003c00,0x3c003c00,0x3c003c00,0xbbf6bc00,0xbba8bbd9,0x2e468000,0x34a5323e
.long 0x3bd93c00,0x3aa73b64,0xbbd9bc00,0xbaa7bb64,0xbba8bc00,0xb913baa7,0xb4a50000,0xba2fb872
.long 0x3b643c00,0x361f39a8,0x3b643c00,0x361f39a8,0xbb0ebc00,0xae46b872,0x378b8000,0x3bf63aa7
.long 0x3aa73c00,0xb23e361f,0xbaa7bc00,0x323eb61f,0xba2fbc00,0x378bb23e,0xb9130000,0xbb0ebbd9
.long 0x39a83c00,0xb9a80000,0x39a83c00,0xb9a80000,0xb913bc00,0x3b0e323e,0x3a2f8000,0x378b3bd9
.long 0x38723c00,0xbbd9b61f,0xb872bc00,0x3bd9361f,0xb78bbc00,0x3bf63872,0xbb0e0000,0x2e46baa7
.long 0x361f3c00,0xbb64b9a8,0x361f3c00,0xbb64b9a8,0xb4a5bc00,0x3a2f3aa7,0x3ba88000,0xb9133872
.long 0x323e3c00,0xb872bb64,0xb23ebc00,0x38723b64,0xae46bc00,0x34a53bd9,0xbbf60000,0x3ba8b23e
.long 0x3c003c00,0x3c003c00,0x3c003c00,0x3c003c00,0xbb0ebb64,0xba2fbaa7,0x378b361f,0x39133872
.long 0x387239a8,0x323e361f,0xb872b9a8,0xb23eb61f,0xae46b61f,0x378b323e,0xbbf6bb64,0xbb0ebbd9
.long 0xb61f0000,0xbb64b9a8,0xb61f0000,0xbb64b9a8,0x3a2f361f,0x3ba83bd9,0x39133b64,0xb4a5323e
.long 0xbbd9b9a8,0xb872bb64,0x3bd939a8,0x38723b64,0x3ba83b64,0xae463872,0x34a5b61f,0x3bf63aa7
.long 0xb9a8bc00,0x39a88000,0xb9a8bc00,0x39a88000,0x34a53b64,0xbbf6b872,0xbba8b61f,0xae46baa7
.long 0x323eb9a8,0x3aa73b64,0xb23e39a8,0xbaa7bb64,0xb913361f,0xb4a5bbd9,0x3a2f3b64,0xbba8b23e
.long 0x3b648000,0xb61f39a8,0x3b648000,0xb61f39a8,0xbbf6b61f,0x3b0eb23e,0x2e46bb64,0x378b3bd9
.long 0x3aa739a8,0xbbd9b61f,0xbaa7b9a8,0x3bd9361f,0xb78bbb64,0x39133aa7,0xbb0e361f,0x3a2fb872
.long 0x3c003c00,0x3c003c00,0x3c003c00,0x3c003c00,0xb913b9a8,0xb78bb872,0x3a2f39a8,0x3b0e3aa7
.long 0xb23e0000,0xb872b61f,0x323e8000,0x3872361f,0x3b0e39a8,0x3bf63bd9,0xb78bb9a8,0x2e46b23e
.long 0xbb64bc00,0xb61fb9a8,0xbb64bc00,0xb61fb9a8,0x34a539a8,0xb913b23e,0xbba8b9a8,0xba2fbbd9
.long 0x38728000,0x3bd93b64,0xb8720000,0xbbd9bb64,0xbbf6b9a8,0xb4a5baa7,0x2e4639a8,0xbba8b872
.long 0x39a83c00,0xb9a80000,0x39a83c00,0xb9a80000,0x2e46b9a8,0x3ba83aa7,0x3bf639a8,0xb4a53872
.long 0xbaa70000,0xb23ebb64,0x3aa78000,0x323e3b64,0x3ba839a8,0xba2f323e,0x34a5b9a8,0x39133bd9
.long 0xb61fbc00,0x3b6439a8,0xb61fbc00,0x3b6439a8,0xb78b39a8,0xae46bbd9,0xbb0eb9a8,0x3bf6323e
.long 0x3bd98000,0xbaa7361f,0xbbd90000,0x3aa7b61f,0xba2fb9a8,0x3b0e3872,0xb91339a8,0x378bbaa7
.long 0x3c003c00,0x3c003c00,0x3c003c00,0x3c003c00,0xb4a5b61f,0xae46b23e,0x3ba83b64,0x3bf63bd9
.long 0xbaa7b9a8,0xbbd9bb64,0x3aa739a8,0x3bd93b64,0x3a2f3b64,0x34a53872,0x3913361f,0x3ba83aa7
.long 0x361f8000,0x3b6439a8,0x361f8000,0x3b6439a8,0xbbf6bb64,0xb78bbaa7,0x2e46b61f,0x3b0e3872
.long 0x323e39a8,0xbaa7b61f,0xb23eb9a8,0x3aa7361f,0x3b0e361f,0x39133bd9,0xb78bbb64,0x3a2f323e
.long 0xb9a8bc00,0x39a88000,0xb9a8bc00,0x39a88000,0xb78b361f,0xba2fbbd9,0xbb0ebb64,0x3913b23e
.long 0x3bd939a8,0xb872361f,0xbbd9b9a8,0x3872b61f,0xae46bb64,0x3b0e3aa7,0xbbf6b61f,0x378bb872
.long 0xbb640000,0x361fb9a8,0xbb640000,0x361fb9a8,0x39133b64,0xbba8b872,0xba2f361f,0x34a5baa7
.long 0x3872b9a8,0xb23e3b64,0xb87239a8,0x323ebb64,0xbba8b61f,0x3bf6323e,0xb4a53b64,0x2e46bbd9
.long 0x0,0x0,0x0,0x0,0xae460000,0xb4a5b23e,0xbbf6bc00,0xbba8bbd9
.long 0x323e0000,0x3872361f,0xb23e0000,0xb872b61f,0xb4a50000,0xba2fb872,0x3ba83c00,0x39133aa7
.long 0x361f0000,0x3b6439a8,0x361f0000,0x3b6439a8,0xb78b0000,0xbbf6baa7,0xbb0ebc00,0xae46b872
.long 0x38720000,0x3bd93b64,0xb8720000,0xbbd9bb64,0xb9130000,0xbb0ebbd9,0x3a2f3c00,0xb78b323e
.long 0x39a80000,0x39a83c00,0x39a80000,0x39a83c00,0xba2f0000,0xb78bbbd9,0xb913bc00,0x3b0e323e
.long 0x3aa70000,0x323e3b64,0xbaa70000,0xb23ebb64,0xbb0e0000,0x2e46baa7,0x378b3c00,0xbbf6b872
.long 0x3b640000,0xb61f39a8,0x3b640000,0xb61f39a8,0xbba80000,0x3913b872,0xb4a5bc00,0x3a2f3aa7
.long 0x3bd90000,0xbaa7361f,0xbbd90000,0x3aa7b61f,0xbbf60000,0x3ba8b23e,0x2e463c00,0xb4a5bbd9
.long 0x0,0x0,0x0,0x0,0xb78bb61f,0xb913b872,0xbb0ebb64,0xba2fbaa7
.long 0x3aa739a8,0x3bd93b64,0xbaa7b9a8,0xbbd9bb64,0xbbf6bb64,0xbb0ebbd9,0x2e46361f,0xb78bb23e
.long 0x3b643c00,0x361f39a8,0x3b643c00,0x361f39a8,0xb913bb64,0x34a5b23e,0x3a2f361f,0x3ba83bd9
.long 0x323e39a8,0xbaa7b61f,0xb23eb9a8,0x3aa7361f,0x34a5b61f,0x3bf63aa7,0xbba8bb64,0x2e46b872
.long 0xb9a80000,0xb9a8bc00,0xb9a80000,0xb9a8bc00,0x3ba8361f,0x2e463aa7,0x34a53b64,0xbbf6b872
.long 0xbbd9b9a8,0x3872b61f,0x3bd939a8,0xb872361f,0x3a2f3b64,0xbba8b23e,0x3913b61f,0x34a53bd9
.long 0xb61fbc00,0x3b6439a8,0xb61fbc00,0x3b6439a8,0xae463b64,0xb78bbbd9,0xbbf6b61f,0x3b0eb23e
.long 0x3872b9a8,0xb23e3b64,0xb87239a8,0x323ebb64,0xbb0e361f,0x3a2fb872,0x378b3b64,0xb913baa7
.long 0x0,0x0,0x0,0x0,0xba2fb9a8,0xbb0ebaa7,0xb913b9a8,0xb78bb872
.long 0x3bd93c00,0x3aa73b64,0xbbd9bc00,0xbaa7bb64,0xb78bb9a8,0x2e46b23e,0xbb0eb9a8,0xbbf6bbd9
.long 0xb61f0000,0xbb64b9a8,0xb61f0000,0xbb64b9a8,0x3ba839a8,0x3a2f3bd9,0x34a539a8,0xb913b23e
.long 0xbaa7bc00,0x323eb61f,0x3aa73c00,0xb23e361f,0x2e4639a8,0xbba8b872,0x3bf639a8,0x34a53aa7
.long 0x39a80000,0x39a83c00,0x39a80000,0x39a83c00,0xbbf6b9a8,0x34a5b872,0x2e46b9a8,0x3ba83aa7
.long 0x38723c00,0xbbd9b61f,0xb872bc00,0x3bd9361f,0x34a5b9a8,0x39133bd9,0xbba8b9a8,0x3a2fb23e
.long 0xbb640000,0x361fb9a8,0xbb640000,0x361fb9a8,0x3b0e39a8,0xbbf6b23e,0xb78b39a8,0xae46bbd9
.long 0xb23ebc00,0x38723b64,0x323e3c00,0xb872bb64,0xb91339a8,0x378bbaa7,0x3a2f39a8,0xbb0eb872
.long 0x0,0x0,0x0,0x0,0xbba8bb64,0xbbf6bbd9,0xb4a5b61f,0xae46b23e
.long 0x387239a8,0x323e361f,0xb872b9a8,0xb23eb61f,0x3913361f,0x3ba83aa7,0xba2fbb64,0xb4a5b872
.long 0xbb64bc00,0xb61fb9a8,0xbb64bc00,0xb61fb9a8,0xae46361f,0xbb0eb872,0xbbf6bb64,0xb78bbaa7
.long 0x3bd939a8,0x38723b64,0xbbd9b9a8,0xb872bb64,0xb78bbb64,0x3a2f323e,0xbb0eb61f,0xb913bbd9
.long 0xb9a80000,0xb9a8bc00,0xb9a80000,0xb9a8bc00,0x3b0e3b64,0xb913323e,0xb78b361f,0xba2fbbd9
.long 0x323eb9a8,0x3aa73b64,0xb23e39a8,0xbaa7bb64,0xbbf6b61f,0x378bb872,0x2e463b64,0xbb0ebaa7
.long 0x361f3c00,0xbb64b9a8,0x361f3c00,0xbb64b9a8,0x3a2fb61f,0xb4a53aa7,0x39133b64,0xbba8b872
.long 0xbaa7b9a8,0x3bd9361f,0x3aa739a8,0xbbd9b61f,0xb4a53b64,0x2e46bbd9,0x3ba8361f,0xbbf6b23e
.long 0x3c00,0x8000bc00,0x3c00,0x8000bc00,0x2e46bc00,0xb4a53bd9,0x3bf68000,0xbba8b23e
.long 0xb23e3c00,0x3872bb64,0x323ebc00,0xb8723b64,0x34a5bc00,0xba2f3aa7,0xbba80000,0x39133872
.long 0xb61f3c00,0x3b64b9a8,0xb61f3c00,0x3b64b9a8,0x378bbc00,0xbbf63872,0x3b0e8000,0xae46baa7
.long 0xb8723c00,0x3bd9b61f,0x3872bc00,0xbbd9361f,0x3913bc00,0xbb0e323e,0xba2f0000,0xb78b3bd9
.long 0xb9a83c00,0x39a88000,0xb9a83c00,0x39a88000,0x3a2fbc00,0xb78bb23e,0x39138000,0x3b0ebbd9
.long 0xbaa73c00,0x323e361f,0x3aa7bc00,0xb23eb61f,0x3b0ebc00,0x2e46b872,0xb78b0000,0xbbf63aa7
.long 0xbb643c00,0xb61f39a8,0xbb643c00,0xb61f39a8,0x3ba8bc00,0x3913baa7,0x34a58000,0x3a2fb872
.long 0xbbd93c00,0xbaa73b64,0x3bd9bc00,0x3aa7bb64,0x3bf6bc00,0x3ba8bbd9,0xae460000,0xb4a5323e
.long 0x3c00,0x8000bc00,0x3c00,0x8000bc00,0x378bbb64,0xb9133aa7,0x3b0e361f,0xba2fb872
.long 0xbaa739a8,0x3bd9b61f,0x3aa7b9a8,0xbbd9361f,0x3bf6b61f,0xbb0eb23e,0xae46bb64,0xb78b3bd9
.long 0xbb640000,0x361f39a8,0xbb640000,0x361f39a8,0x3913361f,0x34a5bbd9,0xba2f3b64,0x3ba8b23e
.long 0xb23eb9a8,0xbaa73b64,0x323e39a8,0x3aa7bb64,0xb4a53b64,0x3bf6b872,0x3ba8b61f,0x2e46baa7
.long 0x39a8bc00,0xb9a80000,0x39a8bc00,0xb9a80000,0xbba83b64,0x2e463872,0xb4a5b61f,0xbbf63aa7
.long 0x3bd9b9a8,0x3872bb64,0xbbd939a8,0xb8723b64,0xba2f361f,0xbba83bd9,0xb9133b64,0x34a5323e
.long 0x361f8000,0x3b64b9a8,0x361f8000,0x3b64b9a8,0x2e46b61f,0xb78b323e,0x3bf6bb64,0x3b0ebbd9
.long 0xb87239a8,0xb23e361f,0x3872b9a8,0x323eb61f,0x3b0ebb64,0x3a2fbaa7,0xb78b361f,0xb9133872
.long 0x3c00,0x8000bc00,0x3c00,0x8000bc00,0x3a2fb9a8,0xbb0e3872,0x391339a8,0xb78bbaa7
.long 0xbbd90000,0x3aa7361f,0x3bd98000,0xbaa7b61f,0x378b39a8,0x2e46bbd9,0x3b0eb9a8,0xbbf6323e
.long 0x361fbc00,0xbb6439a8,0x361fbc00,0xbb6439a8,0xbba839a8,0x3a2f323e,0xb4a5b9a8,0xb9133bd9
.long 0x3aa78000,0x323ebb64,0xbaa70000,0xb23e3b64,0xae46b9a8,0xbba83aa7,0xbbf639a8,0x34a53872
.long 0xb9a83c00,0x39a88000,0xb9a83c00,0x39a88000,0x3bf6b9a8,0x34a5baa7,0xae4639a8,0x3ba8b872
.long 0xb8720000,0xbbd93b64,0x38728000,0x3bd9bb64,0xb4a539a8,0x3913b23e,0x3ba8b9a8,0x3a2fbbd9
.long 0x3b64bc00,0x361fb9a8,0x3b64bc00,0x361fb9a8,0xbb0e39a8,0xbbf63bd9,0x378bb9a8,0xae46b23e
.long 0x323e8000,0x3872b61f,0xb23e0000,0xb872361f,0x3913b9a8,0x378bb872,0xba2f39a8,0xbb0e3aa7
.long 0x3c00,0x8000bc00,0x3c00,0x8000bc00,0x3ba8b61f,0xbbf6323e,0x34a53b64,0xae46bbd9
.long 0xb872b9a8,0x323e3b64,0x387239a8,0xb23ebb64,0xb9133b64,0x3ba8b872,0x3a2f361f,0xb4a5baa7
.long 0x3b648000,0xb61fb9a8,0x3b648000,0xb61fb9a8,0x2e46bb64,0xbb0e3aa7,0x3bf6b61f,0xb78bb872
.long 0xbbd939a8,0x3872361f,0x3bd9b9a8,0xb872b61f,0x378b361f,0x3a2fbbd9,0x3b0ebb64,0xb913b23e
.long 0x39a8bc00,0xb9a80000,0x39a8bc00,0xb9a80000,0xbb0e361f,0xb9133bd9,0x378bbb64,0xba2f323e
.long 0xb23e39a8,0x3aa7b61f,0x323eb9a8,0xbaa7361f,0x3bf6bb64,0x378bbaa7,0xae46b61f,0xbb0e3872
.long 0xb61f0000,0xbb6439a8,0xb61f0000,0xbb6439a8,0xba2f3b64,0xb4a53872,0xb913361f,0xbba83aa7
.long 0x3aa7b9a8,0x3bd9bb64,0xbaa739a8,0xbbd93b64,0x34a5b61f,0x2e46b23e,0xbba83b64,0xbbf63bd9
.long 0x3c000000,0xbc000000,0x3c000000,0xbc000000,0xbbf60000,0x3ba8323e,0x2e46bc00,0xb4a53bd9
.long 0x3bd90000,0xbaa7b61f,0xbbd90000,0x3aa7361f,0xbba80000,0x39133872,0xb4a53c00,0x3a2fbaa7
.long 0x3b640000,0xb61fb9a8,0x3b640000,0xb61fb9a8,0xbb0e0000,0x2e463aa7,0x378bbc00,0xbbf63872
.long 0x3aa70000,0x323ebb64,0xbaa70000,0xb23e3b64,0xba2f0000,0xb78b3bd9,0xb9133c00,0x3b0eb23e
.long 0x39a80000,0x39a8bc00,0x39a80000,0x39a8bc00,0xb9130000,0xbb0e3bd9,0x3a2fbc00,0xb78bb23e
.long 0x38720000,0x3bd9bb64,0xb8720000,0xbbd93b64,0xb78b0000,0xbbf63aa7,0xbb0e3c00,0xae463872
.long 0x361f0000,0x3b64b9a8,0x361f0000,0x3b64b9a8,0xb4a50000,0xba2f3872,0x3ba8bc00,0x3913baa7
.long 0x323e0000,0x3872b61f,0xb23e0000,0xb872361f,0xae460000,0xb4a5323e,0xbbf63c00,0xbba83bd9
.long 0x3c000000,0xbc000000,0x3c000000,0xbc000000,0xbb0eb61f,0x3a2f3872,0x378bbb64,0xb9133aa7
.long 0x387239a8,0xb23ebb64,0xb872b9a8,0x323e3b64,0xae46bb64,0xb78b3bd9,0xbbf6361f,0x3b0e323e
.long 0xb61f3c00,0x3b64b9a8,0xb61f3c00,0x3b64b9a8,0x3a2fbb64,0xbba8323e,0x3913361f,0x34a5bbd9
.long 0xbbd939a8,0x3872361f,0x3bd9b9a8,0xb872b61f,0x3ba8b61f,0x2e46baa7,0x34a5bb64,0xbbf63872
.long 0xb9a80000,0xb9a83c00,0xb9a80000,0xb9a83c00,0x34a5361f,0x3bf6baa7,0xbba83b64,0x2e463872
.long 0x323eb9a8,0xbaa7361f,0xb23e39a8,0x3aa7b61f,0xb9133b64,0x34a5323e,0x3a2fb61f,0x3ba8bbd9
.long 0x3b64bc00,0x361fb9a8,0x3b64bc00,0x361fb9a8,0xbbf63b64,0xbb0e3bd9,0x2e46b61f,0xb78b323e
.long 0x3aa7b9a8,0x3bd9bb64,0xbaa739a8,0xbbd93b64,0xb78b361f,0xb9133872,0xbb0e3b64,0xba2f3aa7
.long 0x3c000000,0xbc000000,0x3c000000,0xbc000000,0xb913b9a8,0x378b3aa7,0x3a2fb9a8,0xbb0e3872
.long 0xb23e3c00,0x3872bb64,0x323ebc00,0xb8723b64,0x3b0eb9a8,0xbbf6323e,0xb78bb9a8,0xae463bd9
.long 0xbb640000,0x361f39a8,0xbb640000,0x361f39a8,0x34a539a8,0x3913bbd9,0xbba839a8,0x3a2f323e
.long 0x3872bc00,0xbbd9361f,0xb8723c00,0x3bd9b61f,0xbbf639a8,0x34a53872,0x2e4639a8,0x3ba8baa7
.long 0x39a80000,0x39a8bc00,0x39a80000,0x39a8bc00,0x2e46b9a8,0xbba83872,0x3bf6b9a8,0x34a5baa7
.long 0xbaa73c00,0x323e361f,0x3aa7bc00,0xb23eb61f,0x3ba8b9a8,0x3a2fbbd9,0x34a5b9a8,0xb913323e
.long 0xb61f0000,0xbb6439a8,0xb61f0000,0xbb6439a8,0xb78b39a8,0x2e46323e,0xbb0e39a8,0xbbf63bd9
.long 0x3bd9bc00,0x3aa7bb64,0xbbd93c00,0xbaa73b64,0xba2f39a8,0xbb0e3aa7,0xb91339a8,0xb78b3872
.long 0x3c000000,0xbc000000,0x3c000000,0xbc000000,0xb4a5bb64,0x2e463bd9,0x3ba8b61f,0xbbf6323e
.long 0xbaa739a8,0x3bd9b61f,0x3aa7b9a8,0xbbd9361f,0x3a2f361f,0xb4a5baa7,0x3913bb64,0xbba83872
.long 0x361fbc00,0xbb6439a8,0x361fbc00,0xbb6439a8,0xbbf6361f,0x378b3872,0x2e46bb64,0xbb0e3aa7
.long 0x323e39a8,0x3aa7bb64,0xb23eb9a8,0xbaa73b64,0x3b0ebb64,0xb913b23e,0xb78bb61f,0xba2f3bd9
.long 0xb9a80000,0xb9a83c00,0xb9a80000,0xb9a83c00,0xb78b3b64,0x3a2fb23e,0xbb0e361f,0xb9133bd9
.long 0x3bd9b9a8,0x3872bb64,0xbbd939a8,0xb8723b64,0xae46b61f,0xbb0e3872,0xbbf63b64,0xb78b3aa7
.long 0xbb643c00,0xb61f39a8,0xbb643c00,0xb61f39a8,0x3913b61f,0x3ba8baa7,0xba2f3b64,0xb4a53872
.long 0x3872b9a8,0x323eb61f,0xb87239a8,0xb23e361f,0xbba83b64,0xbbf63bd9,0xb4a5361f,0xae46323e
.long 0xbc003c00,0xbc003c00,0xbc003c00,0xbc003c00,0x3bf6bc00,0x3ba8bbd9,0xae468000,0xb4a5323e
.long 0xbbd93c00,0xbaa73b64,0x3bd9bc00,0x3aa7bb64,0x3ba8bc00,0x3913baa7,0x34a50000,0x3a2fb872
.long 0xbb643c00,0xb61f39a8,0xbb643c00,0xb61f39a8,0x3b0ebc00,0x2e46b872,0xb78b8000,0xbbf63aa7
.long 0xbaa73c00,0x323e361f,0x3aa7bc00,0xb23eb61f,0x3a2fbc00,0xb78bb23e,0x39130000,0x3b0ebbd9
.long 0xb9a83c00,0x39a80000,0xb9a83c00,0x39a80000,0x3913bc00,0xbb0e323e,0xba2f8000,0xb78b3bd9
.long 0xb8723c00,0x3bd9b61f,0x3872bc00,0xbbd9361f,0x378bbc00,0xbbf63872,0x3b0e0000,0xae46baa7
.long 0xb61f3c00,0x3b64b9a8,0xb61f3c00,0x3b64b9a8,0x34a5bc00,0xba2f3aa7,0xbba88000,0x39133872
.long 0xb23e3c00,0x3872bb64,0x323ebc00,0xb8723b64,0x2e46bc00,0xb4a53bd9,0x3bf60000,0xbba8b23e
.long 0xbc003c00,0xbc003c00,0xbc003c00,0xbc003c00,0x3b0ebb64,0x3a2fbaa7,0xb78b361f,0xb9133872
.long 0xb87239a8,0xb23e361f,0x3872b9a8,0x323eb61f,0x2e46b61f,0xb78b323e,0x3bf6bb64,0x3b0ebbd9
.long 0x361f0000,0x3b64b9a8,0x361f0000,0x3b64b9a8,0xba2f361f,0xbba83bd9,0xb9133b64,0x34a5323e
.long 0x3bd9b9a8,0x3872bb64,0xbbd939a8,0xb8723b64,0xbba83b64,0x2e463872,0xb4a5b61f,0xbbf63aa7
.long 0x39a8bc00,0xb9a88000,0x39a8bc00,0xb9a88000,0xb4a53b64,0x3bf6b872,0x3ba8b61f,0x2e46baa7
.long 0xb23eb9a8,0xbaa73b64,0x323e39a8,0x3aa7bb64,0x3913361f,0x34a5bbd9,0xba2f3b64,0x3ba8b23e
.long 0xbb648000,0x361f39a8,0xbb648000,0x361f39a8,0x3bf6b61f,0xbb0eb23e,0xae46bb64,0xb78b3bd9
.long 0xbaa739a8,0x3bd9b61f,0x3aa7b9a8,0xbbd9361f,0x378bbb64,0xb9133aa7,0x3b0e361f,0xba2fb872
.long 0xbc003c00,0xbc003c00,0xbc003c00,0xbc003c00,0x3913b9a8,0x378bb872,0xba2f39a8,0xbb0e3aa7
.long 0x323e0000,0x3872b61f,0xb23e8000,0xb872361f,0xbb0e39a8,0xbbf63bd9,0x378bb9a8,0xae46b23e
.long 0x3b64bc00,0x361fb9a8,0x3b64bc00,0x361fb9a8,0xb4a539a8,0x3913b23e,0x3ba8b9a8,0x3a2fbbd9
.long 0xb8728000,0xbbd93b64,0x38720000,0x3bd9bb64,0x3bf6b9a8,0x34a5baa7,0xae4639a8,0x3ba8b872
.long 0xb9a83c00,0x39a80000,0xb9a83c00,0x39a80000,0xae46b9a8,0xbba83aa7,0xbbf639a8,0x34a53872
.long 0x3aa70000,0x323ebb64,0xbaa78000,0xb23e3b64,0xbba839a8,0x3a2f323e,0xb4a5b9a8,0xb9133bd9
.long 0x361fbc00,0xbb6439a8,0x361fbc00,0xbb6439a8,0x378b39a8,0x2e46bbd9,0x3b0eb9a8,0xbbf6323e
.long 0xbbd98000,0x3aa7361f,0x3bd90000,0xbaa7b61f,0x3a2fb9a8,0xbb0e3872,0x391339a8,0xb78bbaa7
.long 0xbc003c00,0xbc003c00,0xbc003c00,0xbc003c00,0x34a5b61f,0x2e46b23e,0xbba83b64,0xbbf63bd9
.long 0x3aa7b9a8,0x3bd9bb64,0xbaa739a8,0xbbd93b64,0xba2f3b64,0xb4a53872,0xb913361f,0xbba83aa7
.long 0xb61f8000,0xbb6439a8,0xb61f8000,0xbb6439a8,0x3bf6bb64,0x378bbaa7,0xae46b61f,0xbb0e3872
.long 0xb23e39a8,0x3aa7b61f,0x323eb9a8,0xbaa7361f,0xbb0e361f,0xb9133bd9,0x378bbb64,0xba2f323e
.long 0x39a8bc00,0xb9a88000,0x39a8bc00,0xb9a88000,0x378b361f,0x3a2fbbd9,0x3b0ebb64,0xb913b23e
.long 0xbbd939a8,0x3872361f,0x3bd9b9a8,0xb872b61f,0x2e46bb64,0xbb0e3aa7,0x3bf6b61f,0xb78bb872
.long 0x3b640000,0xb61fb9a8,0x3b640000,0xb61fb9a8,0xb9133b64,0x3ba8b872,0x3a2f361f,0xb4a5baa7
.long 0xb872b9a8,0x323e3b64,0x387239a8,0xb23ebb64,0x3ba8b61f,0xbbf6323e,0x34a53b64,0xae46bbd9
.long 0x0,0x0,0x0,0x0,0x2e460000,0x34a5b23e,0x3bf6bc00,0x3ba8bbd9
.long 0xb23e0000,0xb872361f,0x323e0000,0x3872b61f,0x34a50000,0x3a2fb872,0xbba83c00,0xb9133aa7
.long 0xb61f0000,0xbb6439a8,0xb61f0000,0xbb6439a8,0x378b0000,0x3bf6baa7,0x3b0ebc00,0x2e46b872
.long 0xb8720000,0xbbd93b64,0x38720000,0x3bd9bb64,0x39130000,0x3b0ebbd9,0xba2f3c00,0x378b323e
.long 0xb9a80000,0xb9a83c00,0xb9a80000,0xb9a83c00,0x3a2f0000,0x378bbbd9,0x3913bc00,0xbb0e323e
.long 0xbaa70000,0xb23e3b64,0x3aa70000,0x323ebb64,0x3b0e0000,0xae46baa7,0xb78b3c00,0x3bf6b872
.long 0xbb640000,0x361f39a8,0xbb640000,0x361f39a8,0x3ba80000,0xb913b872,0x34a5bc00,0xba2f3aa7
.long 0xbbd90000,0x3aa7361f,0x3bd90000,0xbaa7b61f,0x3bf60000,0xbba8b23e,0xae463c00,0x34a5bbd9
.long 0x0,0x0,0x0,0x0,0x378bb61f,0x3913b872,0x3b0ebb64,0x3a2fbaa7
.long 0xbaa739a8,0xbbd93b64,0x3aa7b9a8,0x3bd9bb64,0x3bf6bb64,0x3b0ebbd9,0xae46361f,0x378bb23e
.long 0xbb643c00,0xb61f39a8,0xbb643c00,0xb61f39a8,0x3913bb64,0xb4a5b23e,0xba2f361f,0xbba83bd9
.long 0xb23e39a8,0x3aa7b61f,0x323eb9a8,0xbaa7361f,0xb4a5b61f,0xbbf63aa7,0x3ba8bb64,0xae46b872
.long 0x39a80000,0x39a8bc00,0x39a80000,0x39a8bc00,0xbba8361f,0xae463aa7,0xb4a53b64,0x3bf6b872
.long 0x3bd9b9a8,0xb872b61f,0xbbd939a8,0x3872361f,0xba2f3b64,0x3ba8b23e,0xb913b61f,0xb4a53bd9
.long 0x361fbc00,0xbb6439a8,0x361fbc00,0xbb6439a8,0x2e463b64,0x378bbbd9,0x3bf6b61f,0xbb0eb23e
.long 0xb872b9a8,0x323e3b64,0x387239a8,0xb23ebb64,0x3b0e361f,0xba2fb872,0xb78b3b64,0x3913baa7
.long 0x0,0x0,0x0,0x0,0x3a2fb9a8,0x3b0ebaa7,0x3913b9a8,0x378bb872
.long 0xbbd93c00,0xbaa73b64,0x3bd9bc00,0x3aa7bb64,0x378bb9a8,0xae46b23e,0x3b0eb9a8,0x3bf6bbd9
.long 0x361f0000,0x3b64b9a8,0x361f0000,0x3b64b9a8,0xbba839a8,0xba2f3bd9,0xb4a539a8,0x3913b23e
.long 0x3aa7bc00,0xb23eb61f,0xbaa73c00,0x323e361f,0xae4639a8,0x3ba8b872,0xbbf639a8,0xb4a53aa7
.long 0xb9a80000,0xb9a83c00,0xb9a80000,0xb9a83c00,0x3bf6b9a8,0xb4a5b872,0xae46b9a8,0xbba83aa7
.long 0xb8723c00,0x3bd9b61f,0x3872bc00,0xbbd9361f,0xb4a5b9a8,0xb9133bd9,0x3ba8b9a8,0xba2fb23e
.long 0x3b640000,0xb61fb9a8,0x3b640000,0xb61fb9a8,0xbb0e39a8,0x3bf6b23e,0x378b39a8,0x2e46bbd9
.long 0x323ebc00,0xb8723b64,0xb23e3c00,0x3872bb64,0x391339a8,0xb78bbaa7,0xba2f39a8,0x3b0eb872
.long 0x0,0x0,0x0,0x0,0x3ba8bb64,0x3bf6bbd9,0x34a5b61f,0x2e46b23e
.long 0xb87239a8,0xb23e361f,0x3872b9a8,0x323eb61f,0xb913361f,0xbba83aa7,0x3a2fbb64,0x34a5b872
.long 0x3b64bc00,0x361fb9a8,0x3b64bc00,0x361fb9a8,0x2e46361f,0x3b0eb872,0x3bf6bb64,0x378bbaa7
.long 0xbbd939a8,0xb8723b64,0x3bd9b9a8,0x3872bb64,0x378bbb64,0xba2f323e,0x3b0eb61f,0x3913bbd9
.long 0x39a80000,0x39a8bc00,0x39a80000,0x39a8bc00,0xbb0e3b64,0x3913323e,0x378b361f,0x3a2fbbd9
.long 0xb23eb9a8,0xbaa73b64,0x323e39a8,0x3aa7bb64,0x3bf6b61f,0xb78bb872,0xae463b64,0x3b0ebaa7
.long 0xb61f3c00,0x3b64b9a8,0xb61f3c00,0x3b64b9a8,0xba2fb61f,0x34a53aa7,0xb9133b64,0x3ba8b872
.long 0x3aa7b9a8,0xbbd9361f,0xbaa739a8,0x3bd9b61f,0x34a53b64,0xae46bbd9,0xbba8361f,0x3bf6b23e
.long 0x80003c00,0xbc00,0x80003c00,0xbc00,0xae46bc00,0x34a53bd9,0xbbf68000,0x3ba8b23e
.long 0x323e3c00,0xb872bb64,0xb23ebc00,0x38723b64,0xb4a5bc00,0x3a2f3aa7,0x3ba80000,0xb9133872
.long 0x361f3c00,0xbb64b9a8,0x361f3c00,0xbb64b9a8,0xb78bbc00,0x3bf63872,0xbb0e8000,0x2e46baa7
.long 0x38723c00,0xbbd9b61f,0xb872bc00,0x3bd9361f,0xb913bc00,0x3b0e323e,0x3a2f0000,0x378b3bd9
.long 0x39a83c00,0xb9a88000,0x39a83c00,0xb9a88000,0xba2fbc00,0x378bb23e,0xb9138000,0xbb0ebbd9
.long 0x3aa73c00,0xb23e361f,0xbaa7bc00,0x323eb61f,0xbb0ebc00,0xae46b872,0x378b0000,0x3bf63aa7
.long 0x3b643c00,0x361f39a8,0x3b643c00,0x361f39a8,0xbba8bc00,0xb913baa7,0xb4a58000,0xba2fb872
.long 0x3bd93c00,0x3aa73b64,0xbbd9bc00,0xbaa7bb64,0xbbf6bc00,0xbba8bbd9,0x2e460000,0x34a5323e
.long 0x80003c00,0xbc00,0x80003c00,0xbc00,0xb78bbb64,0x39133aa7,0xbb0e361f,0x3a2fb872
.long 0x3aa739a8,0xbbd9b61f,0xbaa7b9a8,0x3bd9361f,0xbbf6b61f,0x3b0eb23e,0x2e46bb64,0x378b3bd9
.long 0x3b640000,0xb61f39a8,0x3b640000,0xb61f39a8,0xb913361f,0xb4a5bbd9,0x3a2f3b64,0xbba8b23e
.long 0x323eb9a8,0x3aa73b64,0xb23e39a8,0xbaa7bb64,0x34a53b64,0xbbf6b872,0xbba8b61f,0xae46baa7
.long 0xb9a8bc00,0x39a80000,0xb9a8bc00,0x39a80000,0x3ba83b64,0xae463872,0x34a5b61f,0x3bf63aa7
.long 0xbbd9b9a8,0xb872bb64,0x3bd939a8,0x38723b64,0x3a2f361f,0x3ba83bd9,0x39133b64,0xb4a5323e
.long 0xb61f8000,0xbb64b9a8,0xb61f8000,0xbb64b9a8,0xae46b61f,0x378b323e,0xbbf6bb64,0xbb0ebbd9
.long 0x387239a8,0x323e361f,0xb872b9a8,0xb23eb61f,0xbb0ebb64,0xba2fbaa7,0x378b361f,0x39133872
.long 0x80003c00,0xbc00,0x80003c00,0xbc00,0xba2fb9a8,0x3b0e3872,0xb91339a8,0x378bbaa7
.long 0x3bd90000,0xbaa7361f,0xbbd98000,0x3aa7b61f,0xb78b39a8,0xae46bbd9,0xbb0eb9a8,0x3bf6323e
.long 0xb61fbc00,0x3b6439a8,0xb61fbc00,0x3b6439a8,0x3ba839a8,0xba2f323e,0x34a5b9a8,0x39133bd9
.long 0xbaa78000,0xb23ebb64,0x3aa70000,0x323e3b64,0x2e46b9a8,0x3ba83aa7,0x3bf639a8,0xb4a53872
.long 0x39a83c00,0xb9a88000,0x39a83c00,0xb9a88000,0xbbf6b9a8,0xb4a5baa7,0x2e4639a8,0xbba8b872
.long 0x38720000,0x3bd93b64,0xb8728000,0xbbd9bb64,0x34a539a8,0xb913b23e,0xbba8b9a8,0xba2fbbd9
.long 0xbb64bc00,0xb61fb9a8,0xbb64bc00,0xb61fb9a8,0x3b0e39a8,0x3bf63bd9,0xb78bb9a8,0x2e46b23e
.long 0xb23e8000,0xb872b61f,0x323e0000,0x3872361f,0xb913b9a8,0xb78bb872,0x3a2f39a8,0x3b0e3aa7
.long 0x80003c00,0xbc00,0x80003c00,0xbc00,0xbba8b61f,0x3bf6323e,0xb4a53b64,0x2e46bbd9
.long 0x3872b9a8,0xb23e3b64,0xb87239a8,0x323ebb64,0x39133b64,0xbba8b872,0xba2f361f,0x34a5baa7
.long 0xbb648000,0x361fb9a8,0xbb648000,0x361fb9a8,0xae46bb64,0x3b0e3aa7,0xbbf6b61f,0x378bb872
.long 0x3bd939a8,0xb872361f,0xbbd9b9a8,0x3872b61f,0xb78b361f,0xba2fbbd9,0xbb0ebb64,0x3913b23e
.long 0xb9a8bc00,0x39a80000,0xb9a8bc00,0x39a80000,0x3b0e361f,0x39133bd9,0xb78bbb64,0x3a2f323e
.long 0x323e39a8,0xbaa7b61f,0xb23eb9a8,0x3aa7361f,0xbbf6bb64,0xb78bbaa7,0x2e46b61f,0x3b0e3872
.long 0x361f0000,0x3b6439a8,0x361f0000,0x3b6439a8,0x3a2f3b64,0x34a53872,0x3913361f,0x3ba83aa7
.long 0xbaa7b9a8,0xbbd9bb64,0x3aa739a8,0x3bd93b64,0xb4a5b61f,0xae46b23e,0x3ba83b64,0x3bf63bd9
.long 0xbc000000,0x3c000000,0xbc000000,0x3c000000,0x3bf60000,0xbba8323e,0xae46bc00,0x34a53bd9
.long 0xbbd90000,0x3aa7b61f,0x3bd90000,0xbaa7361f,0x3ba80000,0xb9133872,0x34a53c00,0xba2fbaa7
.long 0xbb640000,0x361fb9a8,0xbb640000,0x361fb9a8,0x3b0e0000,0xae463aa7,0xb78bbc00,0x3bf63872
.long 0xbaa70000,0xb23ebb64,0x3aa70000,0x323e3b64,0x3a2f0000,0x378b3bd9,0x39133c00,0xbb0eb23e
.long 0xb9a80000,0xb9a8bc00,0xb9a80000,0xb9a8bc00,0x39130000,0x3b0e3bd9,0xba2fbc00,0x378bb23e
.long 0xb8720000,0xbbd9bb64,0x38720000,0x3bd93b64,0x378b0000,0x3bf63aa7,0x3b0e3c00,0x2e463872
.long 0xb61f0000,0xbb64b9a8,0xb61f0000,0xbb64b9a8,0x34a50000,0x3a2f3872,0xbba8bc00,0xb913baa7
.long 0xb23e0000,0xb872b61f,0x323e0000,0x3872361f,0x2e460000,0x34a5323e,0x3bf63c00,0x3ba83bd9
.long 0xbc000000,0x3c000000,0xbc000000,0x3c000000,0x3b0eb61f,0xba2f3872,0xb78bbb64,0x39133aa7
.long 0xb87239a8,0x323ebb64,0x3872b9a8,0xb23e3b64,0x2e46bb64,0x378b3bd9,0x3bf6361f,0xbb0e323e
.long 0x361f3c00,0xbb64b9a8,0x361f3c00,0xbb64b9a8,0xba2fbb64,0x3ba8323e,0xb913361f,0xb4a5bbd9
.long 0x3bd939a8,0xb872361f,0xbbd9b9a8,0x3872b61f,0xbba8b61f,0xae46baa7,0xb4a5bb64,0x3bf63872
.long 0x39a80000,0x39a83c00,0x39a80000,0x39a83c00,0xb4a5361f,0xbbf6baa7,0x3ba83b64,0xae463872
.long 0xb23eb9a8,0x3aa7361f,0x323e39a8,0xbaa7b61f,0x39133b64,0xb4a5323e,0xba2fb61f,0xbba8bbd9
.long 0xbb64bc00,0xb61fb9a8,0xbb64bc00,0xb61fb9a8,0x3bf63b64,0x3b0e3bd9,0xae46b61f,0x378b323e
.long 0xbaa7b9a8,0xbbd9bb64,0x3aa739a8,0x3bd93b64,0x378b361f,0x39133872,0x3b0e3b64,0x3a2f3aa7
.long 0xbc000000,0x3c000000,0xbc000000,0x3c000000,0x3913b9a8,0xb78b3aa7,0xba2fb9a8,0x3b0e3872
.long 0x323e3c00,0xb872bb64,0xb23ebc00,0x38723b64,0xbb0eb9a8,0x3bf6323e,0x378bb9a8,0x2e463bd9
.long 0x3b640000,0xb61f39a8,0x3b640000,0xb61f39a8,0xb4a539a8,0xb913bbd9,0x3ba839a8,0xba2f323e
.long 0xb872bc00,0x3bd9361f,0x38723c00,0xbbd9b61f,0x3bf639a8,0xb4a53872,0xae4639a8,0xbba8baa7
.long 0xb9a80000,0xb9a8bc00,0xb9a80000,0xb9a8bc00,0xae46b9a8,0x3ba83872,0xbbf6b9a8,0xb4a5baa7
.long 0x3aa73c00,0xb23e361f,0xbaa7bc00,0x323eb61f,0xbba8b9a8,0xba2fbbd9,0xb4a5b9a8,0x3913323e
.long 0x361f0000,0x3b6439a8,0x361f0000,0x3b6439a8,0x378b39a8,0xae46323e,0x3b0e39a8,0x3bf63bd9
.long 0xbbd9bc00,0xbaa7bb64,0x3bd93c00,0x3aa73b64,0x3a2f39a8,0x3b0e3aa7,0x391339a8,0x378b3872
.long 0xbc000000,0x3c000000,0xbc000000,0x3c000000,0x34a5bb64,0xae463bd9,0xbba8b61f,0x3bf6323e
.long 0x3aa739a8,0xbbd9b61f,0xbaa7b9a8,0x3bd9361f,0xba2f361f,0x34a5baa7,0xb913bb64,0x3ba83872
.long 0xb61fbc00,0x3b6439a8,0xb61fbc00,0x3b6439a8,0x3bf6361f,0xb78b3872,0xae46bb64,0x3b0e3aa7
.long 0xb23e39a8,0xbaa7bb64,0x323eb9a8,0x3aa73b64,0xbb0ebb64,0x3913b23e,0x378bb61f,0x3a2f3bd9
.long 0x39a80000,0x39a83c00,0x39a80000,0x39a83c00,0x378b3b64,0xba2fb23e,0x3b0e361f,0x39133bd9
.long 0xbbd9b9a8,0xb872bb64,0x3bd939a8,0x38723b64,0x2e46b61f,0x3b0e3872,0x3bf63b64,0x378b3aa7
.long 0x3b643c00,0x361f39a8,0x3b643c00,0x361f39a8,0xb913b61f,0xbba8baa7,0x3a2f3b64,0x34a53872
.long 0xb872b9a8,0xb23eb61f,0x387239a8,0x323e361f,0x3ba83b64,0x3bf63bd9,0x34a5361f,0x2e46323e
.section .rodata,"a"
.p2align 6
.amdhsa_kernel recurrent_scan__spectral_fnet__swiglu_ffn__prompt_kernel
  .amdhsa_next_free_vgpr 256
  .amdhsa_next_free_sgpr 102
  .amdhsa_accum_offset 224
  .amdhsa_group_segment_fixed_size 0
  .amdhsa_kernarg_size 96
  .amdhsa_user_sgpr_count 2
  .amdhsa_user_sgpr_kernarg_segment_ptr 1
  .amdhsa_system_sgpr_workgroup_id_x 1
.end_amdhsa_kernel
```
